```python
import torch

def _softmax(x, axis=-1):
    return torch.softmax(x, dim=axis)
def _gelu(x):
    return torch.nn.functional.gelu(x, approximate="tanh")
def _silu(x):
    return torch.nn.functional.silu(x)
def _sigmoid(x):
    return torch.sigmoid(x)
def _layernorm(x, axis=-1, eps=1e-5):
    m = x.mean(dim=axis, keepdim=True)
    v = x.var(dim=axis, keepdim=True, unbiased=False)
    return (x - m) / torch.sqrt(v + eps)
def _scatter_add(tgt, idx, src, axis=0):
    return tgt.clone().index_add_(axis, idx, src)
def _segment_sum(src, seg, n):
    out = torch.zeros((n,) + src.shape[1:], dtype=src.dtype)
    return out.index_add_(0, seg, src)
def _pad(x, pw):
    flat = tuple(v for pair in reversed(pw) for v in pair)
    return torch.nn.functional.pad(x, flat)

kernel_name = 'gated_mix__spectral_gfnet__glu_gated_reglu__prompt'

def setup_inputs():

    _w = (lambda a: (lambda t: t.to(torch.bfloat16) if t.is_floating_point() else t)(torch.as_tensor(a)))
    def _A_setup():
        B, S, D = 1, 2048, 512
        Df = D // 2 + 1
        return {
            "x": _w((lambda *s: torch.randn(*s, dtype=torch.bfloat16) * 0.05)(B, S, D)),
            "w_r": _w((lambda *s: torch.randn(*s, dtype=torch.bfloat16) * 0.05)(S, Df) * 0.02),
            "w_i": _w((lambda *s: torch.randn(*s, dtype=torch.bfloat16) * 0.05)(S, Df) * 0.02),
        }
    _A_in = _A_setup()

    def _B_setup():
        B, S, D, F = 1, 2048, 512, 1792
        return {
            "x": _w((lambda *s: torch.randn(*s, dtype=torch.bfloat16) * 0.05)(B, S, D)),
            "W_gate": _w((lambda *s: torch.randn(*s, dtype=torch.bfloat16) * 0.2)(D, F) * (2.0 / D) ** 0.5),
            "W_up": _w((lambda *s: torch.randn(*s, dtype=torch.bfloat16) * 0.2)(D, F) * (2.0 / D) ** 0.5),
            "W_down": _w((lambda *s: torch.randn(*s, dtype=torch.bfloat16) * 0.2)(F, D) * (1.0 / F) ** 0.5),
        }
    _B_in = _B_setup()

    return {
        "A_x": _A_in["x"],
        "A_w_r": _A_in["w_r"],
        "A_w_i": _A_in["w_i"],
        "B_x": _B_in["x"],
        "B_W_gate": _B_in["W_gate"],
        "B_W_up": _B_in["W_up"],
        "B_W_down": _B_in["W_down"],
        "gate_w": _w((lambda *s: torch.randn(*s, dtype=torch.bfloat16) * 0.05)(512) * 16.0),
    }

def reference(A_x, A_w_r, A_w_i, B_x, B_W_gate, B_W_up, B_W_down, gate_w):
    def _A_ref(x, w_r, w_i):
        B, S, D = x.shape
        X = (lambda x, axes=(-2,-1): torch.fft.rfft2(x.float(), dim=axes))(x, axes=(-2, -1))
        W = w_r + 1j * w_i
        X = X * W
        y = (lambda x, s, axes=(-2,-1): torch.fft.irfft2(x, s=s, dim=axes).to(torch.bfloat16))(X, (S, D), axes=(-2, -1))
        return y

    def _B_ref(x, W_gate, W_up, W_down):
        gate = torch.einsum("bsd,df->bsf", x, W_gate)
        up = torch.einsum("bsd,df->bsf", x, W_up)
        gate = gate * (lambda x, dt: x.to(dt))(gate > 0, gate.dtype)
        h = gate * up
        return torch.einsum("bsf,fd->bsd", h, W_down)

    x = A_x
    g = _sigmoid((x * gate_w).sum(-1, keepdims=True))
    a = _A_ref(x, A_w_r, A_w_i)
    b = _B_ref(x, B_W_gate, B_W_up, B_W_down)
    return g * a + (1 - g) * b
```

```asm
; @launch grid=(256,1,1) block=(256,1,1) lds=163840
.amdgcn_target "amdgcn-amd-amdhsa--gfx950"
.text
.globl gated_mix__spectral_gfnet__glu_gated_reglu__prompt_kernel
.p2align 8
.type gated_mix__spectral_gfnet__glu_gated_reglu__prompt_kernel,@function
gated_mix__spectral_gfnet__glu_gated_reglu__prompt_kernel:
    s_load_dwordx16 s[48:63], s[0:1], 0
    s_cmp_ge_u32 s2, 256
    s_cbranch_scc1 L_end
    s_load_dwordx4 s[64:67], s[0:1], 64
    s_load_dwordx2 s[68:69], s[0:1], 80
    s_getpc_b64 s[96:97]
L_pc:
    v_lshlrev_b32 v24, 3, v0
    v_readfirstlane_b32 s4, v0
    s_lshr_b32 s71, s2, 3
    v_lshl_add_u32 v24, s71, 11, v24
    v_min_u32 v24, L_end-L_pc, v24
    global_load_dword v31, v24, s[96:97]
    v_and_b32 v0, 63, v0
    v_and_b32 v1, 15, v0
    v_lshrrev_b32 v2, 4, v0
    s_lshr_b32 s4, s4, 6
    s_and_b32 s70, s2, 7
    s_and_b32 s72, s71, 3
    s_lshr_b32 s73, s71, 2
    s_lshr_b32 s75, s70, 1
    s_lshl_b32 s74, s70, 2
    s_add_u32 s74, s74, s72
    s_and_b32 s5, s74, 7
    s_lshl_b32 s5, s5, 2
    s_add_u32 s5, s5, s4
    s_lshl_b32 s76, s5, 10
    v_lshrrev_b32 v25, 3, v0
    v_and_b32 v24, 7, v0
    v_xor_b32 v24, v24, v2
    v_lshlrev_b32 v24, 4, v24
    v_lshl_add_u32 v3, v25, 15, v24
    v_xor_b32 v18, 0x40040, v3
    v_subrev_u32 v18, 0x400, v18
    s_lshl_b32 s93, s4, 14
    s_add_u32 s93, s93, 0x10000
    s_mov_b32 s10, 0x200800
    s_mov_b32 s11, 0x20000
    s_cmp_eq_u32 s73, 7
    s_cbranch_scc1 L_dft
    s_bfe_u32 s86, s73, 131073
    s_lshl_b32 s86, s86, 19
    s_add_u32 s76, s76, s86
    s_xor_b32 s77, s76, 0x80000
    s_xor_b32 s79, s76, 0x180000
    s_xor_b32 s78, s76, 0x100000
    s_add_u32 s76, s76, 0x800
    s_add_u32 s78, s78, 0x800
    s_lshl_b32 s94, s70, 2
    s_add_u32 s94, s94, s70
    s_and_b32 s94, s94, 6
    s_mul_i32 s6, s75, 7
    s_add_u32 s6, s6, s73
    s_mul_i32 s83, s4, 28672
    s_lshl_b32 s86, s6, 7
    s_add_u32 s83, s83, s86
    v_mul_u32_u24 v24, 3584, v25
    s_and_b32 s86, s4, 1
    s_lshl_b32 s86, s86, 1
    v_and_or_b32 v25, v2, 1, s86
    v_bfe_u32 v26, v0, 1, 2
    v_xor_b32 v25, v25, v26
    v_lshl_add_u32 v24, v25, 5, v24
    v_and_b32 v25, 1, v0
    v_lshl_add_u32 v5, v25, 4, v24
    s_lshl_b32 s80, s4, 12
    s_xor_b32 s86, s72, s73
    s_and_b32 s86, s86, 1
    s_lshl_b32 s94, s70, 2
    s_lshr_b32 s94, 302125600, s94
    s_and_b32 s94, s94, 3
    s_lshl2_add_u32 s94, s86, s94
    s_mov_b32 s14, 0x1c0000
    s_mov_b32 s15, 0x20000
    s_mov_b32 s18, 0x1c0400
    s_mov_b32 s19, 0x20000
    s_mul_i32 s81, s94, 229376
    s_add_u32 s81, s81, s83
    s_add_u32 s82, s81, 112640
    s_add_u32 m0, s80, 0
    v_lshl_add_u32 v4, s94, 7, v3
    v_lshl_add_u32 v16, s94, 7, v18
    s_waitcnt lgkmcnt(0)
    s_mov_b64 s[12:13], s[56:57]
    s_sub_u32 s16, s58, 1024
    s_subb_u32 s17, s59, 0
    s_sub_u32 s8, s48, 2048
    s_subb_u32 s9, s49, 0
    buffer_load_dwordx4 v5, s[12:15], s81 offen offset:0 lds
    buffer_load_dwordx4 v5, s[16:19], s81 offen offset:1024 lds
    buffer_load_dwordx4 v5, s[12:15], s82 offen offset:2048 lds
    buffer_load_dwordx4 v5, s[16:19], s82 offen offset:3072 lds
    s_add_u32 m0, s93, 0
    s_nop 0
    buffer_load_dwordx4 v4, s[8:11], s76 offen offset:0 lds
    buffer_load_dwordx4 v16, s[8:11], s76 offen offset:1024 lds
    buffer_load_dwordx4 v4, s[8:11], s77 offen offset:2048 lds
    buffer_load_dwordx4 v16, s[8:11], s77 offen offset:3072 lds
    s_add_u32 m0, s93, 4096
    s_nop 0
    buffer_load_dwordx4 v4, s[8:11], s78 offen offset:0 lds
    buffer_load_dwordx4 v16, s[8:11], s78 offen offset:1024 lds
    buffer_load_dwordx4 v4, s[8:11], s79 offen offset:2048 lds
    buffer_load_dwordx4 v16, s[8:11], s79 offen offset:3072 lds
    v_lshlrev_b32 v14, 4, v0
    s_lshl_b32 s84, s71, 2
    s_add_u32 s84, s84, s4
    s_mul_i32 s3, s70, 112
    s_add_u32 s84, s84, s3
    s_lshl_b32 s84, s84, 11
    s_mov_b32 s92, 0xffff0000
    s_add_u32 s0, s73, 1
    s_and_b32 s0, s0, 7
    s_and_b32 s1, s74, 1
    s_lshl_b32 s1, s1, 1
    s_mov_b64 s[24:25], s[68:69]
    s_mov_b32 s26, 0x10000000
    s_mov_b32 s27, 0x20000
    s_mov_b64 s[44:45], s[66:67]
    s_mov_b32 s46, 0x100
    s_mov_b32 s47, 0x20000
    s_mov_b64 s[20:21], s[60:61]
    s_mov_b32 s22, 0x1c0000
    s_mov_b32 s23, 0x20000
    s_mov_b64 s[28:29], s[64:65]
    s_mov_b32 s30, 0x200000
    s_mov_b32 s31, 0x20000
    s_mov_b64 s[32:33], s[50:51]
    s_mov_b32 s34, 0x101000
    s_mov_b32 s35, 0x20000
    s_mov_b64 s[36:37], s[52:53]
    s_mov_b32 s38, 0x101000
    s_mov_b32 s39, 0x20000
    s_mov_b64 s[40:41], s[62:63]
    s_mov_b32 s42, 0x400
    s_mov_b32 s43, 0x20000
    s_sub_u32 s3, s2, 128
    s_cmp_lt_u32 s3, 50
    s_cselect_b32 s95, s4, 4
    v_accvgpr_write_b32 a180, 0
    v_accvgpr_write_b32 a181, 0
    v_accvgpr_write_b32 a182, 0
    v_accvgpr_write_b32 a183, 0
    v_lshrrev_b32 v24, 1, v1
    v_xor_b32 v24, v24, v2
    v_lshlrev_b32 v24, 4, v24
    v_lshl_add_u32 v24, v1, 7, v24
    v_add_u32 v22, s93, v24
    v_xor_b32 v23, 64, v22
    v_lshlrev_b32 v24, 12, v2
    v_bfe_u32 v25, v0, 2, 2
    v_lshl_add_u32 v24, v25, 7, v24
    v_and_b32 v25, 3, v0
    v_lshl_add_u32 v24, v25, 3, v24
    v_bfe_u32 v25, v0, 3, 2
    v_lshl_add_u32 v6, v25, 5, v24
    v_xor_b32 v7, 32, v6
    v_xor_b32 v8, 64, v6
    v_xor_b32 v9, 0x60, v6
    s_cmp_eq_u32 s74, 0
    s_cselect_b32 s87, 32, 64
    s_cselect_b64 s[90:91], 0xffff, 0
    s_and_b32 s86, s4, 1
    s_lshl_b32 s86, s86, 4
    v_lshrrev_b32 v27, 2, v0
    v_add_u32 v27, s86, v27
    v_mul_u32_u24 v27, s87, v27
    v_add_u32 v27, s74, v27
    v_cmp_eq_u32 vcc, 0, v27
    v_sub_u32 v28, 0x800, v27
    v_mov_b32 v26, 0x400
    s_cmp_lt_u32 s4, 2
    s_cselect_b64 s[96:97], -1, 0
    v_cndmask_b32 v28, v28, v26, vcc
    v_cndmask_b32 v27, v28, v27, s[96:97]
    v_mul_u32_u24 v27, 514, v27
    v_and_b32 v28, 48, v14
    s_lshl_b32 s88, s0, 6
    s_sub_u32 s88, s88, s1
    v_add3_u32 v20, v28, v27, s88
    s_lshl_b32 s86, s4, 11
    s_add_u32 s86, s86, 131072
    v_add_u32 v149, s86, v14
    v_cvt_f32_u32 v148, v2
    v_mov_b32 v146, 0x3e800000
    s_cmp_eq_u32 s74, 0
    s_cselect_b64 s[96:97], -1, 0
    s_cselect_b32 s87, 32, 64
    s_and_b32 s86, s4, 1
    s_lshl_b32 s86, s86, 4
    v_add_u32 v136, s86, v1
    v_mul_u32_u24 v137, s87, v136
    v_add_u32 v137, s74, v137
    s_lshr_b32 s88, s4, 1
    s_cselect_b64 s[98:99], -1, 0
    v_cmp_eq_u32 vcc, 0, v137
    v_cvt_f32_u32 v138, s88
    v_mul_f32 v138, 0xbe800000, v138
    v_cvt_f32_u32 v139, v137
    v_mul_f32 v139, 0x3a000000, v139
    s_and_b64 vcc, vcc, s[98:99]
    v_cndmask_b32 v139, v139, 0.5, vcc
    v_cndmask_b32 v138, v138, 0, vcc
    v_add_f32 v147, v148, v148
    v_fma_f32 v140, v139, v147, v138
    v_add_f32 v141, v146, v140
    v_cndmask_b32 v141, v141, v140, s[96:97]
    s_and_b32 vcc_lo, s96, 0xaaaaaaaa
    s_mov_b32 vcc_hi, vcc_lo
    s_andn2_b64 s[98:99], s[96:97], vcc
    v_cndmask_b32 v142, v139, 0, vcc
    v_cndmask_b32 v140, v140, v146, vcc
    v_cndmask_b32 v143, v139, 0, s[98:99]
    v_cndmask_b32 v141, v141, v146, s[98:99]
    v_fmamk_f32 v130, v142, 0x3f800000, v140
    v_fmamk_f32 v131, v143, 0x3f800000, v141
    v_fmamk_f32 v132, v142, 0x41000000, v140
    v_fmamk_f32 v133, v143, 0x41000000, v141
    v_fmamk_f32 v134, v142, 0x41100000, v140
    v_fmamk_f32 v135, v143, 0x41100000, v141
    v_cos_f32 v128, v140
    v_cos_f32 v129, v141
    v_cos_f32 v130, v130
    v_cos_f32 v131, v131
    v_cos_f32 v132, v132
    v_cos_f32 v133, v133
    v_cos_f32 v134, v134
    v_cos_f32 v135, v135
    v_cvt_pk_bf16_f32 v128, v128, v129
    v_cvt_pk_bf16_f32 v129, v130, v131
    v_cvt_pk_bf16_f32 v130, v132, v133
    v_cvt_pk_bf16_f32 v131, v134, v135
    ds_write_b128 v149, v[128:131] offset:0
    v_fmamk_f32 v128, v142, 0x41800000, v140
    v_fmamk_f32 v129, v143, 0x41800000, v141
    v_fmamk_f32 v130, v142, 0x41880000, v140
    v_fmamk_f32 v131, v143, 0x41880000, v141
    v_fmamk_f32 v132, v142, 0x41c00000, v140
    v_fmamk_f32 v133, v143, 0x41c00000, v141
    v_fmamk_f32 v134, v142, 0x41c80000, v140
    v_fmamk_f32 v135, v143, 0x41c80000, v141
    v_cos_f32 v128, v128
    v_cos_f32 v129, v129
    v_cos_f32 v130, v130
    v_cos_f32 v131, v131
    v_cos_f32 v132, v132
    v_cos_f32 v133, v133
    v_cos_f32 v134, v134
    v_cos_f32 v135, v135
    v_cvt_pk_bf16_f32 v128, v128, v129
    v_cvt_pk_bf16_f32 v129, v130, v131
    v_cvt_pk_bf16_f32 v130, v132, v133
    v_cvt_pk_bf16_f32 v131, v134, v135
    ds_write_b128 v149, v[128:131] offset:1024
    s_lshl_b32 s86, s4, 11
    s_add_u32 s86, s86, 139264
    v_add_u32 v181, s86, v14
    v_cvt_f32_u32 v180, v2
    v_mov_b32 v178, 0x3e800000
    s_cmp_eq_u32 s74, 0
    s_cselect_b64 s[96:97], -1, 0
    s_cselect_b32 s87, 32, 64
    s_and_b32 vcc_lo, s96, 0xaaaaaaaa
    s_mov_b32 vcc_hi, vcc_lo
    s_andn2_b64 s[98:99], s[96:97], vcc
    s_lshl_b32 s86, s4, 3
    v_lshrrev_b32 v168, 1, v1
    v_add_u32 v168, s86, v168
    v_cvt_f32_u32 v169, v168
    v_mul_f32 v169, 0x3a000000, v169
    v_cvt_f32_u32 v170, s87
    v_mul_f32 v171, v169, v170
    v_cvt_f32_u32 v170, s74
    v_mul_f32 v172, v169, v170
    v_and_b32 v168, 1, v0
    v_cvt_f32_u32 v170, v168
    v_cndmask_b32 v170, v170, 0, s[96:97]
    v_fmac_f32 v172, v178, v170
    v_mul_f32 v170, 4.0, v180
    v_fmac_f32 v172, v171, v170
    v_sub_f32 v173, v172, v178
    v_cndmask_b32 v175, v171, 0, s[98:99]
    s_add_u32 s94, s94, 1
    v_cndmask_b32 v176, v172, v178, s[98:99]
    v_cndmask_b32 v177, v173, v178, s[98:99]
    s_and_b64 s[98:99], s[98:99], 0xffff
    s_and_b32 s94, s94, 7
    v_cndmask_b32 v174, v171, 0, vcc
    v_cndmask_b32 v172, v172, v178, vcc
    v_cndmask_b32 v173, v173, v178, vcc
    s_mul_i32 s81, s94, 229376
    v_mul_f32 v169, 0x44800000, v169
    v_cndmask_b32 v169, v173, v169, s[98:99]
    v_fmamk_f32 v161, v175, 0x3f800000, v176
    s_add_u32 s81, s81, s83
    v_fmamk_f32 v162, v174, 0x40000000, v172
    v_fmamk_f32 v163, v175, 0x40400000, v176
    v_fmamk_f32 v164, v174, 0x41800000, v172
    v_fmamk_f32 v165, v175, 0x41880000, v176
    s_add_u32 s82, s81, 112640
    v_fmamk_f32 v166, v174, 0x41900000, v172
    v_fmamk_f32 v167, v175, 0x41980000, v176
    v_cos_f32 v160, v172
    s_add_u32 m0, s80, 16384
    v_cos_f32 v161, v161
    v_cos_f32 v162, v162
    v_cos_f32 v163, v163
    buffer_load_dwordx4 v5, s[12:15], s81 offen offset:0 lds
    v_cos_f32 v164, v164
    v_cos_f32 v165, v165
    v_cos_f32 v166, v166
    buffer_load_dwordx4 v5, s[16:19], s81 offen offset:1024 lds
    v_cos_f32 v167, v167
    v_cvt_pk_bf16_f32 v160, v160, v161
    v_cvt_pk_bf16_f32 v161, v162, v163
    v_cvt_pk_bf16_f32 v162, v164, v165
    buffer_load_dwordx4 v5, s[12:15], s82 offen offset:2048 lds
    v_cvt_pk_bf16_f32 v163, v166, v167
    ds_write_b128 v181, v[160:163] offset:0
    v_fmamk_f32 v161, v175, 0x3f800000, v177
    buffer_load_dwordx4 v5, s[16:19], s82 offen offset:3072 lds
    v_fmamk_f32 v162, v174, 0x40000000, v173
    v_fmamk_f32 v163, v175, 0x40400000, v177
    v_fmamk_f32 v164, v174, 0x41800000, v173
    v_lshl_add_u32 v4, s94, 7, v3
    v_fmamk_f32 v165, v175, 0x41880000, v177
    v_fmamk_f32 v166, v174, 0x41900000, v173
    v_fmamk_f32 v167, v175, 0x41980000, v177
    v_lshl_add_u32 v16, s94, 7, v18
    v_cos_f32 v160, v169
    v_cos_f32 v161, v161
    v_cos_f32 v162, v162
    v_cos_f32 v163, v163
    s_add_u32 m0, s93, 8192
    v_cos_f32 v164, v164
    v_cos_f32 v165, v165
    v_cos_f32 v166, v166
    buffer_load_dwordx4 v4, s[8:11], s76 offen offset:0 lds
    v_cos_f32 v167, v167
    v_cvt_pk_bf16_f32 v160, v160, v161
    v_cvt_pk_bf16_f32 v161, v162, v163
    buffer_load_dwordx4 v16, s[8:11], s76 offen offset:1024 lds
    v_cvt_pk_bf16_f32 v162, v164, v165
    v_cvt_pk_bf16_f32 v163, v166, v167
    ds_write_b128 v181, v[160:163] offset:1024
    s_waitcnt vmcnt(6)
    s_barrier
    ds_read_b64_tr_b16 a[128:129], v6 offset:0
    ds_read_b64_tr_b16 a[130:131], v6 offset:512
    ds_read_b128 a[0:3], v22 offset:0
    ds_read_b128 a[4:7], v22 offset:2048
    ds_read_b128 a[8:11], v22 offset:4096
    ds_read_b128 a[12:15], v22 offset:6144
    ds_read_b64_tr_b16 a[132:133], v6 offset:1024
    ds_read_b64_tr_b16 a[134:135], v6 offset:1536
    ds_read_b64_tr_b16 a[136:137], v7 offset:0
    ds_read_b64_tr_b16 a[138:139], v7 offset:512
    ds_read_b128 a[16:19], v23 offset:0
    ds_read_b128 a[20:23], v23 offset:2048
    ds_read_b128 a[24:27], v23 offset:4096
    ds_read_b128 a[28:31], v23 offset:6144
    ds_read_b64_tr_b16 a[140:141], v7 offset:1024
    ds_read_b64_tr_b16 a[142:143], v7 offset:1536
    ds_read_b64_tr_b16 a[144:145], v6 offset:2048
    ds_read_b64_tr_b16 a[146:147], v6 offset:2560
    s_waitcnt lgkmcnt(14)
    v_mfma_f32_16x16x32_bf16 v[128:131], a[128:131], a[0:3], 0
    ds_read_b64_tr_b16 a[148:149], v6 offset:3072
    buffer_load_dwordx4 v4, s[8:11], s77 offen offset:2048 lds
    v_mfma_f32_16x16x32_bf16 v[132:135], a[128:131], a[4:7], 0
    buffer_load_dwordx4 v16, s[8:11], s77 offen offset:3072 lds
    s_add_u32 m0, s93, 12288
    s_waitcnt lgkmcnt(14)
    v_mfma_f32_16x16x32_bf16 v[136:139], a[128:131], a[8:11], 0
    ds_read_b64_tr_b16 a[150:151], v6 offset:3584
    buffer_load_dwordx4 v4, s[8:11], s78 offen offset:0 lds
    s_waitcnt lgkmcnt(14)
    v_mfma_f32_16x16x32_bf16 v[140:143], a[128:131], a[12:15], 0
    buffer_load_dwordx4 v16, s[8:11], s78 offen offset:1024 lds
    buffer_load_dwordx4 v4, s[8:11], s79 offen offset:2048 lds
    s_waitcnt lgkmcnt(12)
    v_mfma_f32_16x16x32_bf16 v[144:147], a[132:135], a[0:3], 0
    ds_read_b64_tr_b16 a[152:153], v7 offset:2048
    buffer_load_dwordx4 v16, s[8:11], s79 offen offset:3072 lds
    v_mfma_f32_16x16x32_bf16 v[148:151], a[132:135], a[4:7], 0
    s_cmp_eq_u32 s95, 4
    s_cbranch_scc1 Lnoclr_1
    s_lshl2_add_u32 s3, s2, s4
    s_lshl_b32 s3, s3, 10
    s_add_u32 s3, s3, 12124160
    buffer_store_dwordx4 a[180:183], v14, s[24:27], s3 offen sc1
Lnoclr_1:
    v_lshrrev_b32 v24, 3, v0
    v_mfma_f32_16x16x32_bf16 v[152:155], a[132:135], a[8:11], 0
    ds_read_b64_tr_b16 a[154:155], v7 offset:2560
    v_bfe_u32 v25, v0, 1, 2
    v_mfma_f32_16x16x32_bf16 v[156:159], a[132:135], a[12:15], 0
    s_waitcnt lgkmcnt(6)
    s_add_u32 s94, s94, 1
    v_mfma_f32_16x16x32_bf16 v[160:163], a[136:139], a[0:3], 0
    ds_read_b64_tr_b16 a[156:157], v7 offset:3072
    v_xor_b32 v25, v25, v2
    v_mfma_f32_16x16x32_bf16 v[164:167], a[136:139], a[4:7], 0
    s_and_b32 s94, s94, 7
    v_lshlrev_b32 v25, 5, v25
    v_mfma_f32_16x16x32_bf16 v[168:171], a[136:139], a[8:11], 0
    ds_read_b64_tr_b16 a[158:159], v7 offset:3584
    v_lshl_add_u32 v25, v24, 10, v25
    v_mfma_f32_16x16x32_bf16 v[172:175], a[136:139], a[12:15], 0
    v_and_b32 v24, 1, v0
    v_lshl_add_u32 v15, v24, 4, v25
    v_mfma_f32_16x16x32_bf16 v[176:179], a[140:143], a[0:3], 0
    ds_read_b64_tr_b16 a[128:129], v8 offset:0
    v_lshl_add_u32 v4, s94, 7, v3
    v_mfma_f32_16x16x32_bf16 v[180:183], a[140:143], a[4:7], 0
    v_add_u32 v29, 7168, v15
    v_add_u32 v30, 7168, v29
    v_mfma_f32_16x16x32_bf16 v[184:187], a[140:143], a[8:11], 0
    ds_read_b64_tr_b16 a[130:131], v8 offset:512
    v_lshl_add_u32 v16, s94, 7, v18
    v_mfma_f32_16x16x32_bf16 v[188:191], a[140:143], a[12:15], 0
    s_waitcnt lgkmcnt(6)
    v_add_u32 v31, 7168, v30
    v_mfma_f32_16x16x32_bf16 v[128:131], a[144:147], a[16:19], v[128:131]
    ds_read_b64_tr_b16 a[132:133], v8 offset:1024
    v_bfe_u32 v24, v0, 2, 3
    v_mfma_f32_16x16x32_bf16 v[132:135], a[144:147], a[20:23], v[132:135]
    s_add_u32 m0, s93, 0
    v_lshrrev_b32 v25, 5, v0
    v_mfma_f32_16x16x32_bf16 v[136:139], a[144:147], a[24:27], v[136:139]
    ds_read_b64_tr_b16 a[134:135], v8 offset:1536
    v_lshlrev_b32 v25, 10, v25
    v_mfma_f32_16x16x32_bf16 v[140:143], a[144:147], a[28:31], v[140:143]
    buffer_load_dwordx4 v4, s[8:11], s76 offen offset:0 lds
    v_lshl_add_u32 v25, v24, 7, v25
    v_mfma_f32_16x16x32_bf16 v[144:147], a[148:151], a[16:19], v[144:147]
    ds_read_b64_tr_b16 a[136:137], v9 offset:0
    v_and_b32 v26, 3, v0
    v_mfma_f32_16x16x32_bf16 v[148:151], a[148:151], a[20:23], v[148:151]
    buffer_load_dwordx4 v16, s[8:11], s76 offen offset:1024 lds
    v_lshl_add_u32 v25, v26, 3, v25
    v_mfma_f32_16x16x32_bf16 v[152:155], a[148:151], a[24:27], v[152:155]
    ds_read_b64_tr_b16 a[138:139], v9 offset:512
    v_add_u32 v25, s93, v25
    v_mfma_f32_16x16x32_bf16 v[156:159], a[148:151], a[28:31], v[156:159]
    s_waitcnt lgkmcnt(6)
    v_lshrrev_b32 v24, 1, v24
    v_mfma_f32_16x16x32_bf16 v[160:163], a[152:155], a[16:19], v[160:163]
    ds_read_b64_tr_b16 a[140:141], v9 offset:1024
    buffer_load_dwordx4 v4, s[8:11], s77 offen offset:2048 lds
    v_mfma_f32_16x16x32_bf16 v[164:167], a[152:155], a[20:23], v[164:167]
    v_xor_b32 v24, s4, v24
    v_lshl_add_u32 v10, v24, 5, v25
    v_mfma_f32_16x16x32_bf16 v[168:171], a[152:155], a[24:27], v[168:171]
    ds_read_b64_tr_b16 a[142:143], v9 offset:1536
    buffer_load_dwordx4 v16, s[8:11], s77 offen offset:3072 lds
    v_mfma_f32_16x16x32_bf16 v[172:175], a[152:155], a[28:31], v[172:175]
    v_xor_b32 v11, 32, v10
    v_xor_b32 v12, 64, v10
    v_mfma_f32_16x16x32_bf16 v[176:179], a[156:159], a[16:19], v[176:179]
    ds_read_b64_tr_b16 a[144:145], v8 offset:2048
    v_xor_b32 v13, 0x60, v10
    v_mfma_f32_16x16x32_bf16 v[180:183], a[156:159], a[20:23], v[180:183]
    s_add_u32 m0, s93, 4096
    s_and_b32 s86, s74, 4
    s_cselect_b32 s86, 28, 0
    v_mfma_f32_16x16x32_bf16 v[184:187], a[156:159], a[24:27], v[184:187]
    ds_read_b64_tr_b16 a[146:147], v8 offset:2560
    s_mul_i32 s7, s4, 7
    v_mfma_f32_16x16x32_bf16 v[188:191], a[156:159], a[28:31], v[188:191]
    s_waitcnt lgkmcnt(6)
    buffer_load_dwordx4 v4, s[8:11], s78 offen offset:0 lds
    v_mfma_f32_16x16x32_bf16 v[192:195], a[128:131], a[0:3], 0
    ds_read_b64_tr_b16 a[148:149], v8 offset:3072
    s_add_u32 s7, s7, s86
    v_mfma_f32_16x16x32_bf16 v[196:199], a[128:131], a[4:7], 0
    buffer_load_dwordx4 v16, s[8:11], s78 offen offset:1024 lds
    s_lshl_b32 s70, s7, 8
    v_mfma_f32_16x16x32_bf16 v[200:203], a[128:131], a[8:11], 0
    ds_read_b64_tr_b16 a[150:151], v8 offset:3584
    s_add_u32 s70, s70, s73
    v_mfma_f32_16x16x32_bf16 v[204:207], a[128:131], a[12:15], 0
    s_lshl_b32 s70, s70, 7
    s_and_b32 s71, s7, 1
    s_lshl_b32 s71, s71, 15
    v_mfma_f32_16x16x32_bf16 v[208:211], a[132:135], a[0:3], 0
    ds_read_b64_tr_b16 a[152:153], v9 offset:2048
    buffer_load_dwordx4 v4, s[8:11], s79 offen offset:2048 lds
    v_mfma_f32_16x16x32_bf16 v[212:215], a[132:135], a[4:7], 0
    s_lshl_b32 s86, s73, 6
    s_lshl_b32 s87, s4, 4
    s_add_u32 s86, s86, s87
    v_mfma_f32_16x16x32_bf16 v[216:219], a[132:135], a[8:11], 0
    ds_read_b64_tr_b16 a[154:155], v9 offset:2560
    buffer_load_dwordx4 v16, s[8:11], s79 offen offset:3072 lds
    v_mfma_f32_16x16x32_bf16 v[220:223], a[132:135], a[12:15], 0
    s_waitcnt lgkmcnt(6)
    s_mul_i32 s81, s94, 229376
    v_mfma_f32_16x16x32_bf16 v[224:227], a[136:139], a[0:3], 0
    ds_read_b64_tr_b16 a[156:157], v9 offset:3072
    s_add_u32 s81, s81, s83
    v_mfma_f32_16x16x32_bf16 v[228:231], a[136:139], a[4:7], 0
    s_add_u32 s82, s81, 112640
    v_add_u32 v60, s86, v1
    v_mfma_f32_16x16x32_bf16 v[232:235], a[136:139], a[8:11], 0
    ds_read_b64_tr_b16 a[158:159], v9 offset:3584
    v_cvt_f32_u32 v60, v60
    v_mfma_f32_16x16x32_bf16 v[236:239], a[136:139], a[12:15], 0
    s_waitcnt vmcnt(16)
    s_barrier
    s_add_u32 m0, s80, 32768
    v_mfma_f32_16x16x32_bf16 v[240:243], a[140:143], a[0:3], 0
    ds_read_b64_tr_b16 a[128:129], v6 offset:16384
    s_waitcnt vmcnt(8)
    v_mfma_f32_16x16x32_bf16 v[244:247], a[140:143], a[4:7], 0
    buffer_load_dwordx4 v5, s[12:15], s81 offen offset:0 lds
    v_mul_f32 v60, 0x3b000000, v60
    v_mfma_f32_16x16x32_bf16 v[248:251], a[140:143], a[8:11], 0
    ds_read_b64_tr_b16 a[130:131], v6 offset:16896
    buffer_load_dwordx4 v5, s[16:19], s81 offen offset:1024 lds
    v_mfma_f32_16x16x32_bf16 v[252:255], a[140:143], a[12:15], 0
    s_waitcnt lgkmcnt(6)
    ds_read_b128 a[32:35], v22 offset:8192
    v_mfma_f32_16x16x32_bf16 v[192:195], a[144:147], a[16:19], v[192:195]
    ds_read_b64_tr_b16 a[132:133], v6 offset:17408
    buffer_load_dwordx4 v5, s[12:15], s82 offen offset:2048 lds
    v_mfma_f32_16x16x32_bf16 v[196:199], a[144:147], a[20:23], v[196:199]
    ds_read_b128 a[36:39], v22 offset:10240
    buffer_load_dwordx4 v5, s[16:19], s82 offen offset:3072 lds
    v_mfma_f32_16x16x32_bf16 v[200:203], a[144:147], a[24:27], v[200:203]
    ds_read_b64_tr_b16 a[134:135], v6 offset:17920
    s_cmp_eq_u32 s1, 0
    s_cbranch_scc1 Lev_2
    buffer_load_dword v40, v20, s[32:35], 0 offen offset:16
Lev_2:
    v_mfma_f32_16x16x32_bf16 v[204:207], a[144:147], a[28:31], v[204:207]
    ds_read_b128 a[40:43], v22 offset:12288
    v_mul_f32 v58, 0x41800000, v60
    v_mfma_f32_16x16x32_bf16 v[208:211], a[148:151], a[16:19], v[208:211]
    ds_read_b64_tr_b16 a[136:137], v7 offset:16384
    buffer_load_dwordx4 v[32:35], v20, s[32:35], 0 offen
    v_mfma_f32_16x16x32_bf16 v[212:215], a[148:151], a[20:23], v[212:215]
    ds_read_b128 a[44:47], v22 offset:14336
    buffer_load_dword a171, v14, s[40:43], 0 offen
    v_mfma_f32_16x16x32_bf16 v[216:219], a[148:151], a[24:27], v[216:219]
    ds_read_b64_tr_b16 a[138:139], v7 offset:16896
    v_cos_f32 v58, v58
    v_mfma_f32_16x16x32_bf16 v[220:223], a[148:151], a[28:31], v[220:223]
    s_waitcnt lgkmcnt(10)
    ds_read_b128 a[48:51], v23 offset:8192
    v_mfma_f32_16x16x32_bf16 v[224:227], a[152:155], a[16:19], v[224:227]
    ds_read_b64_tr_b16 a[140:141], v7 offset:17408
    v_and_b32 v62, 2, v2
    v_mfma_f32_16x16x32_bf16 v[228:231], a[152:155], a[20:23], v[228:231]
    ds_read_b128 a[52:55], v23 offset:10240
    v_lshlrev_b32 v62, 2, v62
    v_mfma_f32_16x16x32_bf16 v[232:235], a[152:155], a[24:27], v[232:235]
    ds_read_b64_tr_b16 a[142:143], v7 offset:17920
    v_cvt_f32_u32 v62, v62
    v_mfma_f32_16x16x32_bf16 v[236:239], a[152:155], a[28:31], v[236:239]
    ds_read_b128 a[56:59], v23 offset:12288
    v_and_b32 v63, 1, v2
    v_mfma_f32_16x16x32_bf16 v[240:243], a[156:159], a[16:19], v[240:243]
    ds_read_b64_tr_b16 a[144:145], v6 offset:18432
    v_cvt_f32_u32 v61, v63
    v_mfma_f32_16x16x32_bf16 v[244:247], a[156:159], a[20:23], v[244:247]
    ds_read_b128 a[60:63], v23 offset:14336
    v_mul_f32 v61, 0x3e800000, v61
    v_mfma_f32_16x16x32_bf16 v[248:251], a[156:159], a[24:27], v[248:251]
    ds_read_b64_tr_b16 a[146:147], v6 offset:18944
    v_fmac_f32 v61, v60, v62
    v_mfma_f32_16x16x32_bf16 v[252:255], a[156:159], a[28:31], v[252:255]
    s_waitcnt lgkmcnt(12)
    v_add_f32 v58, v58, v58
    v_mfma_f32_16x16x32_bf16 v[128:131], a[128:131], a[32:35], v[128:131]
    ds_read_b64_tr_b16 a[148:149], v6 offset:19456
    s_add_u32 s94, s94, 1
    v_mfma_f32_16x16x32_bf16 v[132:135], a[128:131], a[36:39], v[132:135]
    s_and_b32 s94, s94, 7
    v_and_b32 v62, v63, v0
    s_waitcnt lgkmcnt(12)
    v_mfma_f32_16x16x32_bf16 v[136:139], a[128:131], a[40:43], v[136:139]
    ds_read_b64_tr_b16 a[150:151], v6 offset:19968
    v_lshl_add_u32 v4, s94, 7, v3
    s_waitcnt lgkmcnt(11)
    v_mfma_f32_16x16x32_bf16 v[140:143], a[128:131], a[44:47], v[140:143]
    v_lshl_add_u32 v16, s94, 7, v18
    v_mov_b32 v59, v58
    v_mfma_f32_16x16x32_bf16 v[144:147], a[132:135], a[32:35], v[144:147]
    ds_read_b64_tr_b16 a[152:153], v7 offset:18432
    s_add_u32 m0, s93, 8192
    v_mfma_f32_16x16x32_bf16 v[148:151], a[132:135], a[36:39], v[148:151]
    s_waitcnt lgkmcnt(4)
    buffer_load_dwordx4 v4, s[8:11], s76 offen offset:0 lds
    v_lshl_or_b32 v62, v62, 31, 0.5
    v_mfma_f32_16x16x32_bf16 v[152:155], a[132:135], a[40:43], v[152:155]
    ds_read_b64_tr_b16 a[154:155], v7 offset:18944
    buffer_load_dwordx4 v16, s[8:11], s76 offen offset:1024 lds
    v_mfma_f32_16x16x32_bf16 v[156:159], a[132:135], a[44:47], v[156:159]
    v_fmamk_f32 v43, v60, 0x40000000, v61
    v_mfma_f32_16x16x32_bf16 v[160:163], a[136:139], a[32:35], v[160:163]
    ds_read_b64_tr_b16 a[156:157], v7 offset:19456
    buffer_load_dwordx4 v4, s[8:11], s77 offen offset:2048 lds
    v_mfma_f32_16x16x32_bf16 v[164:167], a[136:139], a[36:39], v[164:167]
    buffer_load_dwordx4 v16, s[8:11], s77 offen offset:3072 lds
    v_fmamk_f32 v44, v60, 0x40800000, v61
    v_mfma_f32_16x16x32_bf16 v[168:171], a[136:139], a[40:43], v[168:171]
    ds_read_b64_tr_b16 a[158:159], v7 offset:19968
    s_add_u32 m0, s93, 12288
    v_mfma_f32_16x16x32_bf16 v[172:175], a[136:139], a[44:47], v[172:175]
    buffer_load_dwordx4 v4, s[8:11], s78 offen offset:0 lds
    v_fmamk_f32 v45, v60, 0x40c00000, v61
    v_mfma_f32_16x16x32_bf16 v[176:179], a[140:143], a[32:35], v[176:179]
    ds_read_b64_tr_b16 a[128:129], v8 offset:16384
    buffer_load_dwordx4 v16, s[8:11], s78 offen offset:1024 lds
    v_mfma_f32_16x16x32_bf16 v[180:183], a[140:143], a[36:39], v[180:183]
    buffer_load_dwordx4 v4, s[8:11], s79 offen offset:2048 lds
    v_fmamk_f32 v46, v60, 0x3f800000, v61
    v_mfma_f32_16x16x32_bf16 v[184:187], a[140:143], a[40:43], v[184:187]
    ds_read_b64_tr_b16 a[130:131], v8 offset:16896
    buffer_load_dwordx4 v16, s[8:11], s79 offen offset:3072 lds
    v_mfma_f32_16x16x32_bf16 v[188:191], a[140:143], a[44:47], v[188:191]
    s_waitcnt lgkmcnt(6)
    s_mul_i32 s81, s94, 229376
    v_mfma_f32_16x16x32_bf16 v[128:131], a[144:147], a[48:51], v[128:131]
    ds_read_b64_tr_b16 a[132:133], v8 offset:17408
    s_add_u32 s81, s81, s83
    v_mfma_f32_16x16x32_bf16 v[132:135], a[144:147], a[52:55], v[132:135]
    s_add_u32 s82, s81, 112640
    v_fmamk_f32 v47, v60, 0x40400000, v61
    v_mfma_f32_16x16x32_bf16 v[136:139], a[144:147], a[56:59], v[136:139]
    ds_read_b64_tr_b16 a[134:135], v8 offset:17920
    s_add_u32 m0, s80, 49152
    v_mfma_f32_16x16x32_bf16 v[140:143], a[144:147], a[60:63], v[140:143]
    buffer_load_dwordx4 v5, s[12:15], s81 offen offset:0 lds
    v_fmamk_f32 v48, v60, 0x40a00000, v61
    v_mfma_f32_16x16x32_bf16 v[144:147], a[148:151], a[48:51], v[144:147]
    ds_read_b64_tr_b16 a[136:137], v9 offset:16384
    buffer_load_dwordx4 v5, s[16:19], s81 offen offset:1024 lds
    v_mfma_f32_16x16x32_bf16 v[148:151], a[148:151], a[52:55], v[148:151]
    buffer_load_dwordx4 v5, s[12:15], s82 offen offset:2048 lds
    v_fmamk_f32 v49, v60, 0x40e00000, v61
    v_mfma_f32_16x16x32_bf16 v[152:155], a[148:151], a[56:59], v[152:155]
    ds_read_b64_tr_b16 a[138:139], v9 offset:16896
    buffer_load_dwordx4 v5, s[16:19], s82 offen offset:3072 lds
    v_mfma_f32_16x16x32_bf16 v[156:159], a[148:151], a[60:63], v[156:159]
    s_waitcnt lgkmcnt(6)
    s_cmp_eq_u32 s1, 0
    s_cbranch_scc1 Lev_3
    buffer_load_dword v41, v20, s[36:39], 0 offen offset:16
Lev_3:
    v_mfma_f32_16x16x32_bf16 v[160:163], a[152:155], a[48:51], v[160:163]
    ds_read_b64_tr_b16 a[140:141], v9 offset:17408
    buffer_load_dwordx4 v[36:39], v20, s[36:39], 0 offen
    v_mfma_f32_16x16x32_bf16 v[164:167], a[152:155], a[52:55], v[164:167]
    v_cos_f32 v42, v61
    v_mfma_f32_16x16x32_bf16 v[168:171], a[152:155], a[56:59], v[168:171]
    ds_read_b64_tr_b16 a[142:143], v9 offset:17920
    v_mfma_f32_16x16x32_bf16 v[172:175], a[152:155], a[60:63], v[172:175]
    v_cos_f32 v43, v43
    v_mfma_f32_16x16x32_bf16 v[176:179], a[156:159], a[48:51], v[176:179]
    ds_read_b64_tr_b16 a[144:145], v8 offset:18432
    v_mfma_f32_16x16x32_bf16 v[180:183], a[156:159], a[52:55], v[180:183]
    v_cos_f32 v44, v44
    v_mfma_f32_16x16x32_bf16 v[184:187], a[156:159], a[56:59], v[184:187]
    ds_read_b64_tr_b16 a[146:147], v8 offset:18944
    v_mfma_f32_16x16x32_bf16 v[188:191], a[156:159], a[60:63], v[188:191]
    s_waitcnt lgkmcnt(6)
    v_mfma_f32_16x16x32_bf16 v[192:195], a[128:131], a[32:35], v[192:195]
    ds_read_b64_tr_b16 a[148:149], v8 offset:19456
    v_mfma_f32_16x16x32_bf16 v[196:199], a[128:131], a[36:39], v[196:199]
    v_cos_f32 v45, v45
    v_mfma_f32_16x16x32_bf16 v[200:203], a[128:131], a[40:43], v[200:203]
    ds_read_b64_tr_b16 a[150:151], v8 offset:19968
    v_mfma_f32_16x16x32_bf16 v[204:207], a[128:131], a[44:47], v[204:207]
    v_cos_f32 v46, v46
    v_mfma_f32_16x16x32_bf16 v[208:211], a[132:135], a[32:35], v[208:211]
    ds_read_b64_tr_b16 a[152:153], v9 offset:18432
    v_mfma_f32_16x16x32_bf16 v[212:215], a[132:135], a[36:39], v[212:215]
    v_cos_f32 v47, v47
    v_mfma_f32_16x16x32_bf16 v[216:219], a[132:135], a[40:43], v[216:219]
    ds_read_b64_tr_b16 a[154:155], v9 offset:18944
    v_mfma_f32_16x16x32_bf16 v[220:223], a[132:135], a[44:47], v[220:223]
    s_waitcnt lgkmcnt(6)
    v_mfma_f32_16x16x32_bf16 v[224:227], a[136:139], a[32:35], v[224:227]
    ds_read_b64_tr_b16 a[156:157], v9 offset:19456
    s_waitcnt vmcnt(19)
    v_mfma_f32_16x16x32_bf16 v[228:231], a[136:139], a[36:39], v[228:231]
    v_cos_f32 v48, v48
    v_mfma_f32_16x16x32_bf16 v[232:235], a[136:139], a[40:43], v[232:235]
    ds_read_b64_tr_b16 a[158:159], v9 offset:19968
    v_cos_f32 v49, v49
    v_mfma_f32_16x16x32_bf16 v[236:239], a[136:139], a[44:47], v[236:239]
    s_waitcnt vmcnt(15)
    s_barrier
    v_mfma_f32_16x16x32_bf16 v[240:243], a[140:143], a[32:35], v[240:243]
    ds_read_b64_tr_b16 a[128:129], v6 offset:32768
    v_fmamk_f32 v50, v60, 0x41800000, v61
    v_mfma_f32_16x16x32_bf16 v[244:247], a[140:143], a[36:39], v[244:247]
    ds_read_b128 a[64:67], v22 offset:0
    s_cmp_lg_u32 s95, 0
    s_cbranch_scc1 Lnoann_5
    v_mov_b32 v27, 1
    s_lshl_b32 s3, s2, 2
    s_sub_u32 s3, s3, 512
    s_mov_b64 exec, 1
    buffer_store_dword v27, v0, s[44:47], s3 offen sc1
    s_mov_b64 exec, -1
Lnoann_5:
    v_mfma_f32_16x16x32_bf16 v[248:251], a[140:143], a[40:43], v[248:251]
    ds_read_b64_tr_b16 a[130:131], v6 offset:33280
    v_fmamk_f32 v51, v60, 0x41900000, v61
    v_mfma_f32_16x16x32_bf16 v[252:255], a[140:143], a[44:47], v[252:255]
    s_waitcnt lgkmcnt(7)
    ds_read_b128 a[68:71], v22 offset:2048
    v_mfma_f32_16x16x32_bf16 v[192:195], a[144:147], a[48:51], v[192:195]
    ds_read_b64_tr_b16 a[132:133], v6 offset:33792
    v_fmamk_f32 v52, v60, 0x41a00000, v61
    v_mfma_f32_16x16x32_bf16 v[196:199], a[144:147], a[52:55], v[196:199]
    ds_read_b128 a[72:75], v22 offset:4096
    v_fmamk_f32 v53, v60, 0x41b00000, v61
    v_mfma_f32_16x16x32_bf16 v[200:203], a[144:147], a[56:59], v[200:203]
    ds_read_b64_tr_b16 a[134:135], v6 offset:34304
    v_fmamk_f32 v54, v60, 0x41880000, v61
    v_mfma_f32_16x16x32_bf16 v[204:207], a[144:147], a[60:63], v[204:207]
    ds_read_b128 a[76:79], v22 offset:6144
    v_fmamk_f32 v55, v60, 0x41980000, v61
    v_mfma_f32_16x16x32_bf16 v[208:211], a[148:151], a[48:51], v[208:211]
    ds_read_b64_tr_b16 a[136:137], v7 offset:32768
    v_fmamk_f32 v56, v60, 0x41a80000, v61
    v_mfma_f32_16x16x32_bf16 v[212:215], a[148:151], a[52:55], v[212:215]
    ds_read_b128 a[80:83], v23 offset:0
    v_fmamk_f32 v57, v60, 0x41b80000, v61
    v_mfma_f32_16x16x32_bf16 v[216:219], a[148:151], a[56:59], v[216:219]
    ds_read_b64_tr_b16 a[138:139], v7 offset:33280
    v_mfma_f32_16x16x32_bf16 v[220:223], a[148:151], a[60:63], v[220:223]
    s_waitcnt lgkmcnt(11)
    ds_read_b128 a[84:87], v23 offset:2048
    v_mfma_f32_16x16x32_bf16 v[224:227], a[152:155], a[48:51], v[224:227]
    ds_read_b64_tr_b16 a[140:141], v7 offset:33792
    v_mfma_f32_16x16x32_bf16 v[228:231], a[152:155], a[52:55], v[228:231]
    ds_read_b128 a[88:91], v23 offset:4096
    ds_read_b128 a[92:95], v23 offset:6144
    v_mfma_f32_16x16x32_bf16 v[232:235], a[152:155], a[56:59], v[232:235]
    ds_read_b64_tr_b16 a[142:143], v7 offset:34304
    v_mfma_f32_16x16x32_bf16 v[236:239], a[152:155], a[60:63], v[236:239]
    v_cos_f32 v50, v50
    v_mfma_f32_16x16x32_bf16 v[240:243], a[156:159], a[48:51], v[240:243]
    ds_read_b64_tr_b16 a[144:145], v6 offset:34816
    s_add_u32 s94, s94, 1
    v_mfma_f32_16x16x32_bf16 v[244:247], a[156:159], a[52:55], v[244:247]
    s_and_b32 s94, s94, 7
    v_cos_f32 v51, v51
    v_mfma_f32_16x16x32_bf16 v[248:251], a[156:159], a[56:59], v[248:251]
    ds_read_b64_tr_b16 a[146:147], v6 offset:35328
    v_lshl_add_u32 v4, s94, 7, v3
    v_mfma_f32_16x16x32_bf16 v[252:255], a[156:159], a[60:63], v[252:255]
    s_waitcnt lgkmcnt(11)
    v_lshl_add_u32 v16, s94, 7, v18
    v_mfma_f32_16x16x32_bf16 v[128:131], a[128:131], a[64:67], v[128:131]
    ds_read_b64_tr_b16 a[148:149], v6 offset:35840
    s_add_u32 m0, s93, 0
    v_mfma_f32_16x16x32_bf16 v[132:135], a[128:131], a[68:71], v[132:135]
    s_waitcnt lgkmcnt(4)
    buffer_load_dwordx4 v4, s[8:11], s76 offen offset:0 lds
    v_cos_f32 v52, v52
    v_mfma_f32_16x16x32_bf16 v[136:139], a[128:131], a[72:75], v[136:139]
    ds_read_b64_tr_b16 a[150:151], v6 offset:36352
    buffer_load_dwordx4 v16, s[8:11], s76 offen offset:1024 lds
    v_mfma_f32_16x16x32_bf16 v[140:143], a[128:131], a[76:79], v[140:143]
    v_add_u32 v19, 131072, v14
    v_cos_f32 v53, v53
    v_mfma_f32_16x16x32_bf16 v[144:147], a[132:135], a[64:67], v[144:147]
    ds_read_b64_tr_b16 a[152:153], v7 offset:34816
    buffer_load_dwordx4 v4, s[8:11], s77 offen offset:2048 lds
    v_mfma_f32_16x16x32_bf16 v[148:151], a[132:135], a[68:71], v[148:151]
    buffer_load_dwordx4 v16, s[8:11], s77 offen offset:3072 lds
    v_cos_f32 v54, v54
    v_mfma_f32_16x16x32_bf16 v[152:155], a[132:135], a[72:75], v[152:155]
    ds_read_b64_tr_b16 a[154:155], v7 offset:35328
    s_add_u32 m0, s93, 4096
    v_mfma_f32_16x16x32_bf16 v[156:159], a[132:135], a[76:79], v[156:159]
    s_waitcnt lgkmcnt(6)
    buffer_load_dwordx4 v4, s[8:11], s78 offen offset:0 lds
    v_mfma_f32_16x16x32_bf16 v[160:163], a[136:139], a[64:67], v[160:163]
    ds_read_b64_tr_b16 a[156:157], v7 offset:35840
    buffer_load_dwordx4 v16, s[8:11], s78 offen offset:1024 lds
    v_mfma_f32_16x16x32_bf16 v[164:167], a[136:139], a[68:71], v[164:167]
    buffer_load_dwordx4 v4, s[8:11], s79 offen offset:2048 lds
    ds_read_b128 a[224:227], v19 offset:0
    v_mfma_f32_16x16x32_bf16 v[168:171], a[136:139], a[72:75], v[168:171]
    ds_read_b64_tr_b16 a[158:159], v7 offset:36352
    buffer_load_dwordx4 v16, s[8:11], s79 offen offset:3072 lds
    v_mfma_f32_16x16x32_bf16 v[172:175], a[136:139], a[76:79], v[172:175]
    s_mul_i32 s81, s94, 229376
    v_mfma_f32_16x16x32_bf16 v[176:179], a[140:143], a[64:67], v[176:179]
    ds_read_b64_tr_b16 a[128:129], v8 offset:32768
    s_add_u32 s81, s81, s83
    v_mfma_f32_16x16x32_bf16 v[180:183], a[140:143], a[68:71], v[180:183]
    s_add_u32 s82, s81, 112640
    ds_read_b128 a[228:231], v19 offset:1024
    v_mfma_f32_16x16x32_bf16 v[184:187], a[140:143], a[72:75], v[184:187]
    ds_read_b64_tr_b16 a[130:131], v8 offset:33280
    v_mfma_f32_16x16x32_bf16 v[188:191], a[140:143], a[76:79], v[188:191]
    s_waitcnt lgkmcnt(8)
    s_add_u32 m0, s80, 0
    v_mfma_f32_16x16x32_bf16 v[128:131], a[144:147], a[80:83], v[128:131]
    ds_read_b64_tr_b16 a[132:133], v8 offset:33792
    buffer_load_dwordx4 v5, s[12:15], s81 offen offset:0 lds
    v_mfma_f32_16x16x32_bf16 v[132:135], a[144:147], a[84:87], v[132:135]
    v_cos_f32 v55, v55
    v_mfma_f32_16x16x32_bf16 v[136:139], a[144:147], a[88:91], v[136:139]
    ds_read_b64_tr_b16 a[134:135], v8 offset:34304
    buffer_load_dwordx4 v5, s[16:19], s81 offen offset:1024 lds
    v_mfma_f32_16x16x32_bf16 v[140:143], a[144:147], a[92:95], v[140:143]
    buffer_load_dwordx4 v5, s[12:15], s82 offen offset:2048 lds
    ds_read_b128 a[232:235], v19 offset:2048
    v_mfma_f32_16x16x32_bf16 v[144:147], a[148:151], a[80:83], v[144:147]
    ds_read_b64_tr_b16 a[136:137], v9 offset:32768
    buffer_load_dwordx4 v5, s[16:19], s82 offen offset:3072 lds
    v_mfma_f32_16x16x32_bf16 v[148:151], a[148:151], a[84:87], v[148:151]
    v_cos_f32 v56, v56
    v_mfma_f32_16x16x32_bf16 v[152:155], a[148:151], a[88:91], v[152:155]
    ds_read_b64_tr_b16 a[138:139], v9 offset:33280
    v_lshlrev_b32 v17, 5, v0
    v_mfma_f32_16x16x32_bf16 v[156:159], a[148:151], a[92:95], v[156:159]
    s_waitcnt lgkmcnt(8)
    buffer_load_dword a160, v17, s[20:23], s84 offen
    v_mfma_f32_16x16x32_bf16 v[160:163], a[152:155], a[80:83], v[160:163]
    ds_read_b64_tr_b16 a[140:141], v9 offset:33792
    v_mfma_f32_16x16x32_bf16 v[164:167], a[152:155], a[84:87], v[164:167]
    ds_read_b128 a[236:239], v19 offset:3072
    v_mfma_f32_16x16x32_bf16 v[168:171], a[152:155], a[88:91], v[168:171]
    ds_read_b64_tr_b16 a[142:143], v9 offset:34304
    v_mfma_f32_16x16x32_bf16 v[172:175], a[152:155], a[92:95], v[172:175]
    v_cos_f32 v57, v57
    v_mfma_f32_16x16x32_bf16 v[176:179], a[156:159], a[80:83], v[176:179]
    ds_read_b64_tr_b16 a[144:145], v8 offset:34816
    v_cmp_gt_u32 vcc, 2, v2
    v_mfma_f32_16x16x32_bf16 v[180:183], a[156:159], a[84:87], v[180:183]
    v_cvt_pk_bf16_f32 v68, v50, v51
    v_cvt_pk_bf16_f32 v69, v52, v53
    v_mfma_f32_16x16x32_bf16 v[184:187], a[156:159], a[88:91], v[184:187]
    ds_read_b64_tr_b16 a[146:147], v8 offset:35328
    v_cvt_pk_bf16_f32 v70, v54, v55
    v_mfma_f32_16x16x32_bf16 v[188:191], a[156:159], a[92:95], v[188:191]
    s_waitcnt lgkmcnt(8)
    ds_read_b128 a[240:243], v19 offset:4096
    v_mfma_f32_16x16x32_bf16 v[192:195], a[128:131], a[64:67], v[192:195]
    ds_read_b64_tr_b16 a[148:149], v8 offset:35840
    s_waitcnt vmcnt(18)
    v_mfma_f32_16x16x32_bf16 v[196:199], a[128:131], a[68:71], v[196:199]
    v_cvt_pk_bf16_f32 v71, v56, v57
    v_cndmask_b32 v62, v42, v62, vcc
    v_mfma_f32_16x16x32_bf16 v[200:203], a[128:131], a[72:75], v[200:203]
    ds_read_b64_tr_b16 a[150:151], v8 offset:36352
    v_cvt_pk_bf16_f32 v64, v62, v43
    v_mfma_f32_16x16x32_bf16 v[204:207], a[128:131], a[76:79], v[204:207]
    ds_read_b128 a[96:99], v22 offset:8192
    v_cvt_pk_bf16_f32 v65, v44, v45
    v_mfma_f32_16x16x32_bf16 v[208:211], a[132:135], a[64:67], v[208:211]
    ds_read_b64_tr_b16 a[152:153], v9 offset:34816
    v_cvt_pk_bf16_f32 v66, v46, v47
    v_mfma_f32_16x16x32_bf16 v[212:215], a[132:135], a[68:71], v[212:215]
    ds_read_b128 a[100:103], v22 offset:10240
    ds_read_b128 a[244:247], v19 offset:5120
    v_cvt_pk_bf16_f32 v67, v48, v49
    v_mfma_f32_16x16x32_bf16 v[216:219], a[132:135], a[72:75], v[216:219]
    ds_read_b64_tr_b16 a[154:155], v9 offset:35328
    v_fma_f32 v42, v58, v50, -v42
    v_mfma_f32_16x16x32_bf16 v[220:223], a[132:135], a[76:79], v[220:223]
    s_waitcnt lgkmcnt(10)
    ds_read_b128 a[104:107], v22 offset:12288
    v_mfma_f32_16x16x32_bf16 v[224:227], a[136:139], a[64:67], v[224:227]
    ds_read_b64_tr_b16 a[156:157], v9 offset:35840
    v_fma_f32 v43, v58, v51, -v43
    v_mfma_f32_16x16x32_bf16 v[228:231], a[136:139], a[68:71], v[228:231]
    ds_read_b128 a[108:111], v22 offset:14336
    v_fma_f32 v44, v58, v52, -v44
    v_mfma_f32_16x16x32_bf16 v[232:235], a[136:139], a[72:75], v[232:235]
    ds_read_b64_tr_b16 a[158:159], v9 offset:36352
    v_fma_f32 v45, v58, v53, -v45
    v_mfma_f32_16x16x32_bf16 v[236:239], a[136:139], a[76:79], v[236:239]
    s_waitcnt vmcnt(14)
    s_barrier
    v_mfma_f32_16x16x32_bf16 v[240:243], a[140:143], a[64:67], v[240:243]
    ds_read_b64_tr_b16 a[128:129], v6 offset:49152
    v_fma_f32 v46, v58, v54, -v46
    v_mfma_f32_16x16x32_bf16 v[244:247], a[140:143], a[68:71], v[244:247]
    ds_read_b128 a[112:115], v23 offset:8192
    v_fma_f32 v47, v58, v55, -v47
    v_mfma_f32_16x16x32_bf16 v[248:251], a[140:143], a[72:75], v[248:251]
    ds_read_b64_tr_b16 a[130:131], v6 offset:49664
    v_fma_f32 v48, v58, v56, -v48
    v_mfma_f32_16x16x32_bf16 v[252:255], a[140:143], a[76:79], v[252:255]
    s_waitcnt lgkmcnt(12)
    ds_read_b128 a[116:119], v23 offset:10240
    v_mfma_f32_16x16x32_bf16 v[192:195], a[144:147], a[80:83], v[192:195]
    ds_read_b64_tr_b16 a[132:133], v6 offset:50176
    v_fma_f32 v49, v58, v57, -v49
    v_mfma_f32_16x16x32_bf16 v[196:199], a[144:147], a[84:87], v[196:199]
    ds_read_b128 a[120:123], v23 offset:12288
    ds_read_b128 a[124:127], v23 offset:14336
    v_cvt_pk_bf16_f32 v72, v42, v43
    v_mfma_f32_16x16x32_bf16 v[200:203], a[144:147], a[88:91], v[200:203]
    ds_read_b64_tr_b16 a[134:135], v6 offset:50688
    v_cvt_pk_bf16_f32 v73, v44, v45
    v_mfma_f32_16x16x32_bf16 v[204:207], a[144:147], a[92:95], v[204:207]
    ds_read_b128 a[248:251], v19 offset:6144
    v_cvt_pk_bf16_f32 v74, v46, v47
    v_mfma_f32_16x16x32_bf16 v[208:211], a[148:151], a[80:83], v[208:211]
    ds_read_b64_tr_b16 a[136:137], v7 offset:49152
    s_add_u32 s94, s94, 1
    v_mfma_f32_16x16x32_bf16 v[212:215], a[148:151], a[84:87], v[212:215]
    ds_read_b128 a[252:255], v19 offset:7168
    v_cvt_pk_bf16_f32 v75, v48, v49
    v_mfma_f32_16x16x32_bf16 v[216:219], a[148:151], a[88:91], v[216:219]
    ds_read_b64_tr_b16 a[138:139], v7 offset:49664
    s_and_b32 s94, s94, 7
    v_mfma_f32_16x16x32_bf16 v[220:223], a[148:151], a[92:95], v[220:223]
    s_waitcnt lgkmcnt(12)
    ds_read_b128 a[192:195], v19 offset:8192
    v_mfma_f32_16x16x32_bf16 v[224:227], a[152:155], a[80:83], v[224:227]
    ds_read_b64_tr_b16 a[140:141], v7 offset:50176
    v_fma_f32 v50, v58, v42, -v50
    v_mfma_f32_16x16x32_bf16 v[228:231], a[152:155], a[84:87], v[228:231]
    v_lshl_add_u32 v4, s94, 7, v3
    v_fma_f32 v51, v58, v43, -v51
    v_mfma_f32_16x16x32_bf16 v[232:235], a[152:155], a[88:91], v[232:235]
    ds_read_b64_tr_b16 a[142:143], v7 offset:50688
    v_fma_f32 v52, v58, v44, -v52
    v_mfma_f32_16x16x32_bf16 v[236:239], a[152:155], a[92:95], v[236:239]
    v_lshl_add_u32 v16, s94, 7, v18
    v_fma_f32 v53, v58, v45, -v53
    v_mfma_f32_16x16x32_bf16 v[240:243], a[156:159], a[80:83], v[240:243]
    ds_read_b64_tr_b16 a[144:145], v6 offset:51200
    v_fma_f32 v54, v58, v46, -v54
    v_mfma_f32_16x16x32_bf16 v[244:247], a[156:159], a[84:87], v[244:247]
    ds_read_b128 a[196:199], v19 offset:9216
    v_fma_f32 v55, v58, v47, -v55
    v_mfma_f32_16x16x32_bf16 v[248:251], a[156:159], a[88:91], v[248:251]
    ds_read_b64_tr_b16 a[146:147], v6 offset:51712
    s_add_u32 m0, s93, 8192
    v_mfma_f32_16x16x32_bf16 v[252:255], a[156:159], a[92:95], v[252:255]
    s_waitcnt lgkmcnt(10)
    v_fma_f32 v56, v58, v48, -v56
    v_mfma_f32_16x16x32_bf16 v[128:131], a[128:131], a[96:99], v[128:131]
    ds_read_b64_tr_b16 a[148:149], v6 offset:52224
    buffer_load_dwordx4 v4, s[8:11], s76 offen offset:0 lds
    v_mfma_f32_16x16x32_bf16 v[132:135], a[128:131], a[100:103], v[132:135]
    v_fma_f32 v57, v58, v49, -v57
    v_cvt_pk_bf16_f32 v76, v50, v51
    v_mfma_f32_16x16x32_bf16 v[136:139], a[128:131], a[104:107], v[136:139]
    ds_read_b64_tr_b16 a[150:151], v6 offset:52736
    v_cvt_pk_bf16_f32 v77, v52, v53
    v_mfma_f32_16x16x32_bf16 v[140:143], a[128:131], a[108:111], v[140:143]
    buffer_load_dwordx4 v16, s[8:11], s76 offen offset:1024 lds
    ds_read_b128 a[200:203], v19 offset:10240
    v_mfma_f32_16x16x32_bf16 v[144:147], a[132:135], a[96:99], v[144:147]
    ds_read_b64_tr_b16 a[152:153], v7 offset:51200
    v_cvt_pk_bf16_f32 v78, v54, v55
    v_mfma_f32_16x16x32_bf16 v[148:151], a[132:135], a[100:103], v[148:151]
    v_cvt_pk_bf16_f32 v79, v56, v57
    v_fma_f32 v42, v58, v50, -v42
    v_mfma_f32_16x16x32_bf16 v[152:155], a[132:135], a[104:107], v[152:155]
    ds_read_b64_tr_b16 a[154:155], v7 offset:51712
    buffer_load_dwordx4 v4, s[8:11], s77 offen offset:2048 lds
    v_mfma_f32_16x16x32_bf16 v[156:159], a[132:135], a[108:111], v[156:159]
    s_waitcnt lgkmcnt(8)
    v_fma_f32 v43, v58, v51, -v43
    v_mfma_f32_16x16x32_bf16 v[160:163], a[136:139], a[96:99], v[160:163]
    ds_read_b64_tr_b16 a[156:157], v7 offset:52224
    buffer_load_dwordx4 v16, s[8:11], s77 offen offset:3072 lds
    v_mfma_f32_16x16x32_bf16 v[164:167], a[136:139], a[100:103], v[164:167]
    ds_read_b128 a[204:207], v19 offset:11264
    v_fma_f32 v44, v58, v52, -v44
    v_mfma_f32_16x16x32_bf16 v[168:171], a[136:139], a[104:107], v[168:171]
    ds_read_b64_tr_b16 a[158:159], v7 offset:52736
    v_fma_f32 v45, v58, v53, -v45
    v_mfma_f32_16x16x32_bf16 v[172:175], a[136:139], a[108:111], v[172:175]
    s_add_u32 m0, s93, 12288
    v_fma_f32 v46, v58, v54, -v46
    v_mfma_f32_16x16x32_bf16 v[176:179], a[140:143], a[96:99], v[176:179]
    ds_read_b64_tr_b16 a[128:129], v8 offset:49152
    v_fma_f32 v47, v58, v55, -v47
    v_mfma_f32_16x16x32_bf16 v[180:183], a[140:143], a[100:103], v[180:183]
    buffer_load_dwordx4 v4, s[8:11], s78 offen offset:0 lds
    v_fma_f32 v48, v58, v56, -v48
    v_mfma_f32_16x16x32_bf16 v[184:187], a[140:143], a[104:107], v[184:187]
    ds_read_b64_tr_b16 a[130:131], v8 offset:49664
    v_fma_f32 v49, v58, v57, -v49
    v_mfma_f32_16x16x32_bf16 v[188:191], a[140:143], a[108:111], v[188:191]
    s_waitcnt lgkmcnt(8)
    ds_read_b128 a[208:211], v19 offset:12288
    v_mfma_f32_16x16x32_bf16 v[128:131], a[144:147], a[112:115], v[128:131]
    ds_read_b64_tr_b16 a[132:133], v8 offset:50176
    buffer_load_dwordx4 v16, s[8:11], s78 offen offset:1024 lds
    v_mfma_f32_16x16x32_bf16 v[132:135], a[144:147], a[116:119], v[132:135]
    v_cvt_pk_bf16_f32 v80, v42, v43
    v_cvt_pk_bf16_f32 v81, v44, v45
    v_mfma_f32_16x16x32_bf16 v[136:139], a[144:147], a[120:123], v[136:139]
    ds_read_b64_tr_b16 a[134:135], v8 offset:50688
    buffer_load_dwordx4 v4, s[8:11], s79 offen offset:2048 lds
    v_mfma_f32_16x16x32_bf16 v[140:143], a[144:147], a[124:127], v[140:143]
    v_cvt_pk_bf16_f32 v82, v46, v47
    v_cvt_pk_bf16_f32 v83, v48, v49
    v_mfma_f32_16x16x32_bf16 v[144:147], a[148:151], a[112:115], v[144:147]
    ds_read_b64_tr_b16 a[136:137], v9 offset:49152
    v_fma_f32 v50, v58, v42, -v50
    v_mfma_f32_16x16x32_bf16 v[148:151], a[148:151], a[116:119], v[148:151]
    buffer_load_dwordx4 v16, s[8:11], s79 offen offset:3072 lds
    ds_read_b128 a[212:215], v19 offset:13312
    v_mfma_f32_16x16x32_bf16 v[152:155], a[148:151], a[120:123], v[152:155]
    ds_read_b64_tr_b16 a[138:139], v9 offset:49664
    s_waitcnt vmcnt(13)
    v_mfma_f32_16x16x32_bf16 v[156:159], a[148:151], a[124:127], v[156:159]
    s_waitcnt lgkmcnt(8)
    s_mul_i32 s81, s94, 229376
    v_mfma_f32_16x16x32_bf16 v[160:163], a[152:155], a[112:115], v[160:163]
    ds_read_b64_tr_b16 a[140:141], v9 offset:50176
    s_add_u32 s81, s81, s83
    v_mfma_f32_16x16x32_bf16 v[164:167], a[152:155], a[116:119], v[164:167]
    ds_read_b128 a[0:3], v22 offset:0
    v_fma_f32 v51, v58, v43, -v51
    v_mfma_f32_16x16x32_bf16 v[168:171], a[152:155], a[120:123], v[168:171]
    ds_read_b64_tr_b16 a[142:143], v9 offset:50688
    s_add_u32 s82, s81, 112640
    ds_read_b128 a[216:219], v19 offset:14336
    v_mfma_f32_16x16x32_bf16 v[172:175], a[152:155], a[124:127], v[172:175]
    ds_read_b128 a[4:7], v22 offset:2048
    v_fma_f32 v52, v58, v44, -v52
    v_mfma_f32_16x16x32_bf16 v[176:179], a[156:159], a[112:115], v[176:179]
    ds_read_b64_tr_b16 a[144:145], v8 offset:51200
    s_add_u32 m0, s80, 16384
    v_mfma_f32_16x16x32_bf16 v[180:183], a[156:159], a[116:119], v[180:183]
    ds_read_b128 a[8:11], v22 offset:4096
    v_fma_f32 v53, v58, v45, -v53
    v_mfma_f32_16x16x32_bf16 v[184:187], a[156:159], a[120:123], v[184:187]
    ds_read_b64_tr_b16 a[146:147], v8 offset:51712
    buffer_load_dwordx4 v5, s[12:15], s81 offen offset:0 lds
    v_mfma_f32_16x16x32_bf16 v[188:191], a[156:159], a[124:127], v[188:191]
    s_waitcnt lgkmcnt(11)
    ds_read_b128 a[12:15], v22 offset:6144
    v_mfma_f32_16x16x32_bf16 v[192:195], a[128:131], a[96:99], v[192:195]
    ds_read_b64_tr_b16 a[148:149], v8 offset:52224
    buffer_load_dwordx4 v5, s[16:19], s81 offen offset:1024 lds
    ds_read_b128 a[220:223], v19 offset:15360
    v_mfma_f32_16x16x32_bf16 v[196:199], a[128:131], a[100:103], v[196:199]
    ds_read_b128 a[16:19], v23 offset:0
    v_fma_f32 v54, v58, v46, -v54
    v_mfma_f32_16x16x32_bf16 v[200:203], a[128:131], a[104:107], v[200:203]
    ds_read_b64_tr_b16 a[150:151], v8 offset:52736
    buffer_load_dwordx4 v5, s[12:15], s82 offen offset:2048 lds
    v_mfma_f32_16x16x32_bf16 v[204:207], a[128:131], a[108:111], v[204:207]
    ds_read_b128 a[20:23], v23 offset:2048
    v_fma_f32 v55, v58, v47, -v55
    v_mfma_f32_16x16x32_bf16 v[208:211], a[132:135], a[96:99], v[208:211]
    ds_read_b64_tr_b16 a[152:153], v9 offset:51200
    buffer_load_dwordx4 v5, s[16:19], s82 offen offset:3072 lds
    v_mfma_f32_16x16x32_bf16 v[212:215], a[132:135], a[100:103], v[212:215]
    ds_read_b128 a[24:27], v23 offset:4096
    v_fma_f32 v56, v58, v48, -v56
    v_mfma_f32_16x16x32_bf16 v[216:219], a[132:135], a[104:107], v[216:219]
    ds_read_b64_tr_b16 a[154:155], v9 offset:51712
    v_fma_f32 v57, v58, v49, -v57
    v_mfma_f32_16x16x32_bf16 v[220:223], a[132:135], a[108:111], v[220:223]
    s_waitcnt lgkmcnt(14)
    ds_read_b128 a[28:31], v23 offset:6144
    v_mfma_f32_16x16x32_bf16 v[224:227], a[136:139], a[96:99], v[224:227]
    ds_read_b64_tr_b16 a[156:157], v9 offset:52224
    v_cvt_pk_bf16_f32 v84, v50, v51
    v_mfma_f32_16x16x32_bf16 v[228:231], a[136:139], a[100:103], v[228:231]
    v_cvt_pk_bf16_f32 v85, v52, v53
    v_cvt_pk_bf16_f32 v86, v54, v55
    v_mfma_f32_16x16x32_bf16 v[232:235], a[136:139], a[104:107], v[232:235]
    ds_read_b64_tr_b16 a[158:159], v9 offset:52736
    s_add_u32 s94, s94, 1
    v_mfma_f32_16x16x32_bf16 v[236:239], a[136:139], a[108:111], v[236:239]
    s_waitcnt vmcnt(13)
    s_barrier
    v_mfma_f32_16x16x32_bf16 v[240:243], a[140:143], a[96:99], v[240:243]
    ds_read_b64_tr_b16 a[128:129], v6 offset:0
    s_and_b32 s94, s94, 7
    v_mfma_f32_16x16x32_bf16 v[244:247], a[140:143], a[100:103], v[244:247]
    v_cvt_pk_bf16_f32 v87, v56, v57
    v_fma_f32 v42, v58, v50, -v42
    v_mfma_f32_16x16x32_bf16 v[248:251], a[140:143], a[104:107], v[248:251]
    ds_read_b64_tr_b16 a[130:131], v6 offset:512
    v_fma_f32 v43, v58, v51, -v43
    v_mfma_f32_16x16x32_bf16 v[252:255], a[140:143], a[108:111], v[252:255]
    s_waitcnt lgkmcnt(9)
    v_lshl_add_u32 v4, s94, 7, v3
    v_mfma_f32_16x16x32_bf16 v[192:195], a[144:147], a[112:115], v[192:195]
    ds_read_b64_tr_b16 a[132:133], v6 offset:1024
    v_fma_f32 v44, v58, v52, -v44
    v_mfma_f32_16x16x32_bf16 v[196:199], a[144:147], a[116:119], v[196:199]
    v_lshl_add_u32 v16, s94, 7, v18
    v_fma_f32 v45, v58, v53, -v45
    v_mfma_f32_16x16x32_bf16 v[200:203], a[144:147], a[120:123], v[200:203]
    ds_read_b64_tr_b16 a[134:135], v6 offset:1536
    v_fma_f32 v46, v58, v54, -v46
    v_mfma_f32_16x16x32_bf16 v[204:207], a[144:147], a[124:127], v[204:207]
    v_fma_f32 v47, v58, v55, -v47
    v_fma_f32 v48, v58, v56, -v48
    v_mfma_f32_16x16x32_bf16 v[208:211], a[148:151], a[112:115], v[208:211]
    ds_read_b64_tr_b16 a[136:137], v7 offset:0
    s_add_u32 m0, s93, 0
    v_mfma_f32_16x16x32_bf16 v[212:215], a[148:151], a[116:119], v[212:215]
    v_fma_f32 v49, v58, v57, -v49
    v_cvt_pk_bf16_f32 v88, v42, v43
    v_mfma_f32_16x16x32_bf16 v[216:219], a[148:151], a[120:123], v[216:219]
    ds_read_b64_tr_b16 a[138:139], v7 offset:512
    s_waitcnt lgkmcnt(8)
    buffer_load_dwordx4 v4, s[8:11], s76 offen offset:0 lds
    v_mfma_f32_16x16x32_bf16 v[220:223], a[148:151], a[124:127], v[220:223]
    s_waitcnt lgkmcnt(6)
    v_cvt_pk_bf16_f32 v89, v44, v45
    v_mfma_f32_16x16x32_bf16 v[224:227], a[152:155], a[112:115], v[224:227]
    ds_read_b64_tr_b16 a[140:141], v7 offset:1024
    v_cvt_pk_bf16_f32 v90, v46, v47
    v_mfma_f32_16x16x32_bf16 v[228:231], a[152:155], a[116:119], v[228:231]
    buffer_load_dwordx4 v16, s[8:11], s76 offen offset:1024 lds
    v_cvt_pk_bf16_f32 v91, v48, v49
    v_mfma_f32_16x16x32_bf16 v[232:235], a[152:155], a[120:123], v[232:235]
    ds_read_b64_tr_b16 a[142:143], v7 offset:1536
    v_fma_f32 v50, v58, v42, -v50
    v_mfma_f32_16x16x32_bf16 v[236:239], a[152:155], a[124:127], v[236:239]
    v_fma_f32 v51, v58, v43, -v51
    v_fma_f32 v52, v58, v44, -v52
    v_mfma_f32_16x16x32_bf16 v[240:243], a[156:159], a[112:115], v[240:243]
    ds_read_b64_tr_b16 a[144:145], v6 offset:2048
    buffer_load_dwordx4 v4, s[8:11], s77 offen offset:2048 lds
    v_mfma_f32_16x16x32_bf16 v[244:247], a[156:159], a[116:119], v[244:247]
    v_fma_f32 v53, v58, v45, -v53
    v_fma_f32 v54, v58, v46, -v54
    v_mfma_f32_16x16x32_bf16 v[248:251], a[156:159], a[120:123], v[248:251]
    ds_read_b64_tr_b16 a[146:147], v6 offset:2560
    buffer_load_dwordx4 v16, s[8:11], s77 offen offset:3072 lds
    v_mfma_f32_16x16x32_bf16 v[252:255], a[156:159], a[124:127], v[252:255]
    s_waitcnt lgkmcnt(6)
    v_fma_f32 v55, v58, v47, -v55
    v_mfma_f32_16x16x32_bf16 v[128:131], a[128:131], a[0:3], v[128:131]
    ds_read_b64_tr_b16 a[148:149], v6 offset:3072
    v_fma_f32 v56, v58, v48, -v56
    v_mfma_f32_16x16x32_bf16 v[132:135], a[128:131], a[4:7], v[132:135]
    s_add_u32 m0, s93, 4096
    v_fma_f32 v57, v58, v49, -v57
    v_mfma_f32_16x16x32_bf16 v[136:139], a[128:131], a[8:11], v[136:139]
    ds_read_b64_tr_b16 a[150:151], v6 offset:3584
    v_cvt_pk_bf16_f32 v92, v50, v51
    v_mfma_f32_16x16x32_bf16 v[140:143], a[128:131], a[12:15], v[140:143]
    buffer_load_dwordx4 v4, s[8:11], s78 offen offset:0 lds
    v_cvt_pk_bf16_f32 v93, v52, v53
    v_mfma_f32_16x16x32_bf16 v[144:147], a[132:135], a[0:3], v[144:147]
    ds_read_b64_tr_b16 a[152:153], v7 offset:2048
    v_cvt_pk_bf16_f32 v94, v54, v55
    v_mfma_f32_16x16x32_bf16 v[148:151], a[132:135], a[4:7], v[148:151]
    v_cvt_pk_bf16_f32 v95, v56, v57
    v_fma_f32 v42, v58, v50, -v42
    v_mfma_f32_16x16x32_bf16 v[152:155], a[132:135], a[8:11], v[152:155]
    ds_read_b64_tr_b16 a[154:155], v7 offset:2560
    buffer_load_dwordx4 v16, s[8:11], s78 offen offset:1024 lds
    v_mfma_f32_16x16x32_bf16 v[156:159], a[132:135], a[12:15], v[156:159]
    s_waitcnt lgkmcnt(6)
    v_fma_f32 v43, v58, v51, -v43
    v_mfma_f32_16x16x32_bf16 v[160:163], a[136:139], a[0:3], v[160:163]
    ds_read_b64_tr_b16 a[156:157], v7 offset:3072
    buffer_load_dwordx4 v4, s[8:11], s79 offen offset:2048 lds
    v_mfma_f32_16x16x32_bf16 v[164:167], a[136:139], a[4:7], v[164:167]
    v_fma_f32 v44, v58, v52, -v44
    v_fma_f32 v45, v58, v53, -v45
    v_mfma_f32_16x16x32_bf16 v[168:171], a[136:139], a[8:11], v[168:171]
    ds_read_b64_tr_b16 a[158:159], v7 offset:3584
    v_fma_f32 v46, v58, v54, -v46
    v_mfma_f32_16x16x32_bf16 v[172:175], a[136:139], a[12:15], v[172:175]
    s_waitcnt vmcnt(7)
    s_barrier
    v_mfma_f32_16x16x32_bf16 v[176:179], a[140:143], a[0:3], v[176:179]
    ds_read_b64_tr_b16 a[128:129], v6 offset:16384
    v_mfma_f32_16x16x32_bf16 v[180:183], a[140:143], a[4:7], v[180:183]
    buffer_load_dwordx4 v16, s[8:11], s79 offen offset:3072 lds
    v_fma_f32 v47, v58, v55, -v47
    v_mfma_f32_16x16x32_bf16 v[184:187], a[140:143], a[8:11], v[184:187]
    ds_read_b64_tr_b16 a[130:131], v6 offset:16896
    s_mul_i32 s81, s94, 229376
    v_mfma_f32_16x16x32_bf16 v[188:191], a[140:143], a[12:15], v[188:191]
    s_waitcnt lgkmcnt(6)
    ds_read_b128 a[32:35], v22 offset:8192
    v_mfma_f32_16x16x32_bf16 v[128:131], a[144:147], a[16:19], v[128:131]
    ds_read_b64_tr_b16 a[132:133], v6 offset:17408
    s_add_u32 s81, s81, s83
    v_mfma_f32_16x16x32_bf16 v[132:135], a[144:147], a[20:23], v[132:135]
    ds_read_b128 a[36:39], v22 offset:10240
    s_add_u32 s82, s81, 112640
    v_mfma_f32_16x16x32_bf16 v[136:139], a[144:147], a[24:27], v[136:139]
    ds_read_b64_tr_b16 a[134:135], v6 offset:17920
    s_add_u32 m0, s80, 32768
    v_mfma_f32_16x16x32_bf16 v[140:143], a[144:147], a[28:31], v[140:143]
    ds_read_b128 a[40:43], v22 offset:12288
    buffer_load_dwordx4 v5, s[12:15], s81 offen offset:0 lds
    v_mfma_f32_16x16x32_bf16 v[144:147], a[148:151], a[16:19], v[144:147]
    ds_read_b64_tr_b16 a[136:137], v7 offset:16384
    buffer_load_dwordx4 v5, s[16:19], s81 offen offset:1024 lds
    v_mfma_f32_16x16x32_bf16 v[148:151], a[148:151], a[20:23], v[148:151]
    ds_read_b128 a[44:47], v22 offset:14336
    v_fma_f32 v48, v58, v56, -v48
    v_mfma_f32_16x16x32_bf16 v[152:155], a[148:151], a[24:27], v[152:155]
    ds_read_b64_tr_b16 a[138:139], v7 offset:16896
    buffer_load_dwordx4 v5, s[12:15], s82 offen offset:2048 lds
    v_mfma_f32_16x16x32_bf16 v[156:159], a[148:151], a[28:31], v[156:159]
    s_waitcnt lgkmcnt(10)
    ds_read_b128 a[48:51], v23 offset:8192
    v_mfma_f32_16x16x32_bf16 v[160:163], a[152:155], a[16:19], v[160:163]
    ds_read_b64_tr_b16 a[140:141], v7 offset:17408
    buffer_load_dwordx4 v5, s[16:19], s82 offen offset:3072 lds
    v_mfma_f32_16x16x32_bf16 v[164:167], a[152:155], a[20:23], v[164:167]
    ds_read_b128 a[52:55], v23 offset:10240
    s_lshr_b32 s3, s2, 3
    s_lshl2_add_u32 s3, s3, s4
    s_lshl_b32 s3, s3, 14
    v_mfma_f32_16x16x32_bf16 v[168:171], a[152:155], a[24:27], v[168:171]
    ds_read_b64_tr_b16 a[142:143], v7 offset:17920
    v_and_b32 v28, 60, v0
    v_mfma_f32_16x16x32_bf16 v[172:175], a[152:155], a[28:31], v[172:175]
    ds_read_b128 a[56:59], v23 offset:12288
    v_lshlrev_b32 v28, 8, v28
    v_mfma_f32_16x16x32_bf16 v[176:179], a[156:159], a[16:19], v[176:179]
    ds_read_b64_tr_b16 a[144:145], v6 offset:18432
    buffer_load_dword a172, v28, s[20:23], s3 offen offset:384
    v_mfma_f32_16x16x32_bf16 v[180:183], a[156:159], a[20:23], v[180:183]
    ds_read_b128 a[60:63], v23 offset:14336
    v_fma_f32 v49, v58, v57, -v49
    v_mfma_f32_16x16x32_bf16 v[184:187], a[156:159], a[24:27], v[184:187]
    ds_read_b64_tr_b16 a[146:147], v6 offset:18944
    v_cvt_pk_bf16_f32 v96, v42, v43
    v_mfma_f32_16x16x32_bf16 v[188:191], a[156:159], a[28:31], v[188:191]
    s_waitcnt lgkmcnt(12)
    v_cvt_pk_bf16_f32 v97, v44, v45
    v_mfma_f32_16x16x32_bf16 v[128:131], a[128:131], a[32:35], v[128:131]
    ds_read_b64_tr_b16 a[148:149], v6 offset:19456
    s_add_u32 s94, s94, 1
    v_mfma_f32_16x16x32_bf16 v[132:135], a[128:131], a[36:39], v[132:135]
    v_cvt_pk_bf16_f32 v98, v46, v47
    v_cvt_pk_bf16_f32 v99, v48, v49
    s_waitcnt lgkmcnt(12)
    v_mfma_f32_16x16x32_bf16 v[136:139], a[128:131], a[40:43], v[136:139]
    ds_read_b64_tr_b16 a[150:151], v6 offset:19968
    s_and_b32 s94, s94, 7
    s_waitcnt lgkmcnt(11)
    v_mfma_f32_16x16x32_bf16 v[140:143], a[128:131], a[44:47], v[140:143]
    v_fma_f32 v50, v58, v42, -v50
    v_fma_f32 v51, v58, v43, -v51
    v_mfma_f32_16x16x32_bf16 v[144:147], a[132:135], a[32:35], v[144:147]
    ds_read_b64_tr_b16 a[152:153], v7 offset:18432
    v_fma_f32 v52, v58, v44, -v52
    v_mfma_f32_16x16x32_bf16 v[148:151], a[132:135], a[36:39], v[148:151]
    v_lshl_add_u32 v4, s94, 7, v3
    v_fma_f32 v53, v58, v45, -v53
    v_mfma_f32_16x16x32_bf16 v[152:155], a[132:135], a[40:43], v[152:155]
    ds_read_b64_tr_b16 a[154:155], v7 offset:18944
    v_fma_f32 v54, v58, v46, -v54
    v_mfma_f32_16x16x32_bf16 v[156:159], a[132:135], a[44:47], v[156:159]
    s_waitcnt lgkmcnt(8)
    v_lshl_add_u32 v16, s94, 7, v18
    v_mfma_f32_16x16x32_bf16 v[160:163], a[136:139], a[32:35], v[160:163]
    ds_read_b64_tr_b16 a[156:157], v7 offset:19456
    v_fma_f32 v55, v58, v47, -v55
    v_mfma_f32_16x16x32_bf16 v[164:167], a[136:139], a[36:39], v[164:167]
    v_fma_f32 v56, v58, v48, -v56
    v_fma_f32 v57, v58, v49, -v57
    v_mfma_f32_16x16x32_bf16 v[168:171], a[136:139], a[40:43], v[168:171]
    ds_read_b64_tr_b16 a[158:159], v7 offset:19968
    s_add_u32 m0, s93, 8192
    v_mfma_f32_16x16x32_bf16 v[172:175], a[136:139], a[44:47], v[172:175]
    v_cvt_pk_bf16_f32 v100, v50, v51
    v_cvt_pk_bf16_f32 v101, v52, v53
    v_mfma_f32_16x16x32_bf16 v[176:179], a[140:143], a[32:35], v[176:179]
    ds_read_b64_tr_b16 a[128:129], v8 offset:0
    s_waitcnt lgkmcnt(8)
    buffer_load_dwordx4 v4, s[8:11], s76 offen offset:0 lds
    v_mfma_f32_16x16x32_bf16 v[180:183], a[140:143], a[36:39], v[180:183]
    v_cvt_pk_bf16_f32 v102, v54, v55
    v_cvt_pk_bf16_f32 v103, v56, v57
    v_mfma_f32_16x16x32_bf16 v[184:187], a[140:143], a[40:43], v[184:187]
    ds_read_b64_tr_b16 a[130:131], v8 offset:512
    v_fma_f32 v42, v58, v50, -v42
    v_mfma_f32_16x16x32_bf16 v[188:191], a[140:143], a[44:47], v[188:191]
    s_waitcnt lgkmcnt(6)
    buffer_load_dwordx4 v16, s[8:11], s76 offen offset:1024 lds
    v_mfma_f32_16x16x32_bf16 v[128:131], a[144:147], a[48:51], v[128:131]
    ds_read_b64_tr_b16 a[132:133], v8 offset:1024
    v_fma_f32 v43, v58, v51, -v43
    v_mfma_f32_16x16x32_bf16 v[132:135], a[144:147], a[52:55], v[132:135]
    v_fma_f32 v44, v58, v52, -v44
    v_fma_f32 v45, v58, v53, -v45
    v_mfma_f32_16x16x32_bf16 v[136:139], a[144:147], a[56:59], v[136:139]
    ds_read_b64_tr_b16 a[134:135], v8 offset:1536
    buffer_load_dwordx4 v4, s[8:11], s77 offen offset:2048 lds
    v_mfma_f32_16x16x32_bf16 v[140:143], a[144:147], a[60:63], v[140:143]
    v_fma_f32 v46, v58, v54, -v46
    v_fma_f32 v47, v58, v55, -v47
    v_mfma_f32_16x16x32_bf16 v[144:147], a[148:151], a[48:51], v[144:147]
    ds_read_b64_tr_b16 a[136:137], v9 offset:0
    buffer_load_dwordx4 v16, s[8:11], s77 offen offset:3072 lds
    v_mfma_f32_16x16x32_bf16 v[148:151], a[148:151], a[52:55], v[148:151]
    v_fma_f32 v48, v58, v56, -v48
    v_fma_f32 v49, v58, v57, -v49
    v_mfma_f32_16x16x32_bf16 v[152:155], a[148:151], a[56:59], v[152:155]
    ds_read_b64_tr_b16 a[138:139], v9 offset:512
    v_cvt_pk_bf16_f32 v104, v42, v43
    v_mfma_f32_16x16x32_bf16 v[156:159], a[148:151], a[60:63], v[156:159]
    s_waitcnt lgkmcnt(6)
    s_add_u32 m0, s93, 12288
    v_mfma_f32_16x16x32_bf16 v[160:163], a[152:155], a[48:51], v[160:163]
    ds_read_b64_tr_b16 a[140:141], v9 offset:1024
    v_cvt_pk_bf16_f32 v105, v44, v45
    v_mfma_f32_16x16x32_bf16 v[164:167], a[152:155], a[52:55], v[164:167]
    buffer_load_dwordx4 v4, s[8:11], s78 offen offset:0 lds
    v_cvt_pk_bf16_f32 v106, v46, v47
    v_mfma_f32_16x16x32_bf16 v[168:171], a[152:155], a[56:59], v[168:171]
    ds_read_b64_tr_b16 a[142:143], v9 offset:1536
    v_cvt_pk_bf16_f32 v107, v48, v49
    v_mfma_f32_16x16x32_bf16 v[172:175], a[152:155], a[60:63], v[172:175]
    v_mfma_f32_16x16x32_bf16 v[176:179], a[156:159], a[48:51], v[176:179]
    ds_read_b64_tr_b16 a[144:145], v8 offset:2048
    buffer_load_dwordx4 v16, s[8:11], s78 offen offset:1024 lds
    v_mfma_f32_16x16x32_bf16 v[180:183], a[156:159], a[52:55], v[180:183]
    v_mfma_f32_16x16x32_bf16 v[184:187], a[156:159], a[56:59], v[184:187]
    ds_read_b64_tr_b16 a[146:147], v8 offset:2560
    buffer_load_dwordx4 v4, s[8:11], s79 offen offset:2048 lds
    v_mfma_f32_16x16x32_bf16 v[188:191], a[156:159], a[60:63], v[188:191]
    s_waitcnt lgkmcnt(6)
    v_mfma_f32_16x16x32_bf16 v[192:195], a[128:131], a[0:3], v[192:195]
    ds_read_b64_tr_b16 a[148:149], v8 offset:3072
    v_mfma_f32_16x16x32_bf16 v[196:199], a[128:131], a[4:7], v[196:199]
    buffer_load_dwordx4 v16, s[8:11], s79 offen offset:3072 lds
    v_mfma_f32_16x16x32_bf16 v[200:203], a[128:131], a[8:11], v[200:203]
    ds_read_b64_tr_b16 a[150:151], v8 offset:3584
    s_waitcnt vmcnt(13)
    v_mfma_f32_16x16x32_bf16 v[204:207], a[128:131], a[12:15], v[204:207]
    s_mul_i32 s81, s94, 229376
    s_add_u32 s81, s81, s83
    v_mfma_f32_16x16x32_bf16 v[208:211], a[132:135], a[0:3], v[208:211]
    ds_read_b64_tr_b16 a[152:153], v9 offset:2048
    s_add_u32 s82, s81, 112640
    v_mfma_f32_16x16x32_bf16 v[212:215], a[132:135], a[4:7], v[212:215]
    ds_read_b128 a[64:67], v22 offset:0
    s_add_u32 m0, s80, 49152
    v_mfma_f32_16x16x32_bf16 v[216:219], a[132:135], a[8:11], v[216:219]
    ds_read_b64_tr_b16 a[154:155], v9 offset:2560
    buffer_load_dwordx4 v5, s[12:15], s81 offen offset:0 lds
    v_mfma_f32_16x16x32_bf16 v[220:223], a[132:135], a[12:15], v[220:223]
    s_waitcnt lgkmcnt(7)
    ds_read_b128 a[68:71], v22 offset:2048
    v_mfma_f32_16x16x32_bf16 v[224:227], a[136:139], a[0:3], v[224:227]
    ds_read_b64_tr_b16 a[156:157], v9 offset:3072
    buffer_load_dwordx4 v5, s[16:19], s81 offen offset:1024 lds
    v_mfma_f32_16x16x32_bf16 v[228:231], a[136:139], a[4:7], v[228:231]
    ds_read_b128 a[72:75], v22 offset:4096
    buffer_load_dwordx4 v5, s[12:15], s82 offen offset:2048 lds
    v_mfma_f32_16x16x32_bf16 v[232:235], a[136:139], a[8:11], v[232:235]
    ds_read_b64_tr_b16 a[158:159], v9 offset:3584
    buffer_load_dwordx4 v5, s[16:19], s82 offen offset:3072 lds
    v_mfma_f32_16x16x32_bf16 v[236:239], a[136:139], a[12:15], v[236:239]
    s_waitcnt vmcnt(13)
    s_barrier
    s_getpc_b64 s[98:99]
Lpc_4:
    s_lshr_b32 s3, s2, 3
    s_lshl_b32 s3, s3, 2
    v_mfma_f32_16x16x32_bf16 v[240:243], a[140:143], a[0:3], v[240:243]
    ds_read_b64_tr_b16 a[128:129], v6 offset:32768
    s_add_u32 s3, s3, s4
    v_mfma_f32_16x16x32_bf16 v[244:247], a[140:143], a[4:7], v[244:247]
    ds_read_b128 a[76:79], v22 offset:6144
    s_lshl_b32 s3, s3, 9
    v_mfma_f32_16x16x32_bf16 v[248:251], a[140:143], a[8:11], v[248:251]
    ds_read_b64_tr_b16 a[130:131], v6 offset:33280
    v_lshl_add_u32 v28, v0, 3, s3
    v_mfma_f32_16x16x32_bf16 v[252:255], a[140:143], a[12:15], v[252:255]
    s_waitcnt lgkmcnt(10)
    ds_read_b128 a[80:83], v23 offset:0
    v_mfma_f32_16x16x32_bf16 v[192:195], a[144:147], a[16:19], v[192:195]
    ds_read_b64_tr_b16 a[132:133], v6 offset:33792
    v_min_u32 v28, L_end-Lpc_4, v28
    v_mfma_f32_16x16x32_bf16 v[196:199], a[144:147], a[20:23], v[196:199]
    ds_read_b128 a[84:87], v23 offset:2048
    global_load_dword a170, v28, s[98:99]
    v_mfma_f32_16x16x32_bf16 v[200:203], a[144:147], a[24:27], v[200:203]
    ds_read_b64_tr_b16 a[134:135], v6 offset:34304
    v_min_u32 v17, 49, v0
    v_mfma_f32_16x16x32_bf16 v[204:207], a[144:147], a[28:31], v[204:207]
    ds_read_b128 a[88:91], v23 offset:4096
    ds_read_b128 a[92:95], v23 offset:6144
    s_bfe_u32 s86, s73, 131073
    v_mfma_f32_16x16x32_bf16 v[208:211], a[148:151], a[16:19], v[208:211]
    ds_read_b64_tr_b16 a[136:137], v7 offset:32768
    s_lshl2_add_u32 s88, s5, s86
    v_mfma_f32_16x16x32_bf16 v[212:215], a[148:151], a[20:23], v[212:215]
    v_lshlrev_b32 v17, 2, v17
    s_lshl_b32 s88, s88, 5
    v_mfma_f32_16x16x32_bf16 v[216:219], a[148:151], a[24:27], v[216:219]
    ds_read_b64_tr_b16 a[138:139], v7 offset:33280
    s_add_u32 s88, s88, s6
    v_mfma_f32_16x16x32_bf16 v[220:223], a[148:151], a[28:31], v[220:223]
    s_waitcnt lgkmcnt(11)
    s_lshl_b32 s88, s88, 11
    v_mfma_f32_16x16x32_bf16 v[224:227], a[152:155], a[16:19], v[224:227]
    ds_read_b64_tr_b16 a[140:141], v7 offset:33792
    s_lshl_b32 s81, s5, 5
    v_mfma_f32_16x16x32_bf16 v[228:231], a[152:155], a[20:23], v[228:231]
    buffer_load_dword v16, v17, s[44:47], 0 offen sc1
    s_add_u32 s81, s81, s6
    v_mfma_f32_16x16x32_bf16 v[232:235], a[152:155], a[24:27], v[232:235]
    ds_read_b64_tr_b16 a[142:143], v7 offset:34304
    v_mfma_f32_16x16x32_bf16 v[236:239], a[152:155], a[28:31], v[236:239]
    s_add_u32 s85, s70, 0
    s_lshl_b32 s81, s81, 7
    v_mfma_f32_16x16x32_bf16 v[240:243], a[156:159], a[16:19], v[240:243]
    ds_read_b64_tr_b16 a[144:145], v6 offset:34816
    s_add_u32 s81, s81, 12648448
    v_mfma_f32_16x16x32_bf16 v[244:247], a[156:159], a[20:23], v[244:247]
    s_add_u32 m0, s93, 0
    s_lshl_b32 s76, s0, 1
    v_mfma_f32_16x16x32_bf16 v[248:251], a[156:159], a[24:27], v[248:251]
    ds_read_b64_tr_b16 a[146:147], v6 offset:35328
    v_mfma_f32_16x16x32_bf16 v[252:255], a[156:159], a[28:31], v[252:255]
    s_waitcnt lgkmcnt(8)
    s_waitcnt lgkmcnt(6)
    s_lshr_b32 s87, s4, 1
    v_mfma_f32_16x16x32_bf16 v[128:131], a[128:131], a[64:67], v[128:131]
    ds_read_b64_tr_b16 a[148:149], v6 offset:35840
    s_add_u32 s76, s76, s87
    v_mfma_f32_16x16x32_bf16 v[132:135], a[128:131], a[68:71], v[132:135]
    s_lshr_b32 s87, s74, 3
    v_mfma_f32_16x16x32_bf16 v[136:139], a[128:131], a[72:75], v[136:139]
    ds_read_b64_tr_b16 a[150:151], v6 offset:36352
    buffer_load_dwordx4 v15, s[20:23], s85 offen offset:0 lds
    v_mfma_f32_16x16x32_bf16 v[140:143], a[128:131], a[76:79], v[140:143]
    s_lshl_b32 s87, s87, 4
    v_mfma_f32_16x16x32_bf16 v[144:147], a[132:135], a[64:67], v[144:147]
    ds_read_b64_tr_b16 a[152:153], v7 offset:34816
    buffer_load_dwordx4 v29, s[20:23], s85 offen offset:1024 lds
    v_mfma_f32_16x16x32_bf16 v[148:151], a[132:135], a[68:71], v[148:151]
    s_add_u32 s76, s76, s87
    s_lshl_b32 s76, s76, 3
    v_mfma_f32_16x16x32_bf16 v[152:155], a[132:135], a[72:75], v[152:155]
    ds_read_b64_tr_b16 a[154:155], v7 offset:35328
    v_mfma_f32_16x16x32_bf16 v[156:159], a[132:135], a[76:79], v[156:159]
    s_waitcnt lgkmcnt(6)
    buffer_load_dwordx4 v30, s[20:23], s85 offen offset:2048 lds
    v_mfma_f32_16x16x32_bf16 v[160:163], a[136:139], a[64:67], v[160:163]
    ds_read_b64_tr_b16 a[156:157], v7 offset:35840
    s_and_b32 s87, s74, 7
    v_mfma_f32_16x16x32_bf16 v[164:167], a[136:139], a[68:71], v[164:167]
    buffer_load_dwordx4 v31, s[20:23], s85 offen offset:3072 lds
    s_add_u32 s76, s76, s87
    v_mfma_f32_16x16x32_bf16 v[168:171], a[136:139], a[72:75], v[168:171]
    ds_read_b64_tr_b16 a[158:159], v7 offset:36352
    s_lshr_b32 s87, s74, 2
    v_mfma_f32_16x16x32_bf16 v[172:175], a[136:139], a[76:79], v[172:175]
    s_waitcnt vmcnt(6)
    s_barrier
    s_xor_b32 s87, s87, s4
    v_mfma_f32_16x16x32_bf16 v[176:179], a[140:143], a[64:67], v[176:179]
    ds_read_b64_tr_b16 a[128:129], v6 offset:49152
    v_mfma_f32_16x16x32_bf16 v[180:183], a[140:143], a[68:71], v[180:183]
    s_add_u32 s85, s70, 32768
    s_and_b32 s87, s87, 1
    s_lshl1_add_u32 s76, s76, s87
    v_mfma_f32_16x16x32_bf16 v[184:187], a[140:143], a[72:75], v[184:187]
    ds_read_b64_tr_b16 a[130:131], v6 offset:49664
    s_add_u32 m0, s93, 4096
    v_mfma_f32_16x16x32_bf16 v[188:191], a[140:143], a[76:79], v[188:191]
    s_waitcnt lgkmcnt(6)
    ds_read_b128 a[96:99], v22 offset:8192
    v_mfma_f32_16x16x32_bf16 v[128:131], a[144:147], a[80:83], v[128:131]
    ds_read_b64_tr_b16 a[132:133], v6 offset:50176
    s_lshl_b32 s76, s76, 6
    v_mfma_f32_16x16x32_bf16 v[132:135], a[144:147], a[84:87], v[132:135]
    ds_read_b128 a[100:103], v22 offset:10240
    buffer_load_dwordx4 v15, s[20:23], s85 offen offset:0 lds
    v_mfma_f32_16x16x32_bf16 v[136:139], a[144:147], a[88:91], v[136:139]
    ds_read_b64_tr_b16 a[134:135], v6 offset:50688
    s_add_u32 s76, s76, 10485760
    v_mfma_f32_16x16x32_bf16 v[140:143], a[144:147], a[92:95], v[140:143]
    ds_read_b128 a[104:107], v22 offset:12288
    buffer_load_dwordx4 v29, s[20:23], s85 offen offset:1024 lds
    v_mfma_f32_16x16x32_bf16 v[144:147], a[148:151], a[80:83], v[144:147]
    ds_read_b64_tr_b16 a[136:137], v7 offset:49152
    s_add_u32 s77, s76, 0x80000
    v_mfma_f32_16x16x32_bf16 v[148:151], a[148:151], a[84:87], v[148:151]
    ds_read_b128 a[108:111], v22 offset:14336
    s_add_u32 s78, s76, 0x100000
    v_mfma_f32_16x16x32_bf16 v[152:155], a[148:151], a[88:91], v[152:155]
    ds_read_b64_tr_b16 a[138:139], v7 offset:49664
    buffer_load_dwordx4 v30, s[20:23], s85 offen offset:2048 lds
    v_mfma_f32_16x16x32_bf16 v[156:159], a[148:151], a[92:95], v[156:159]
    s_waitcnt lgkmcnt(10)
    ds_read_b128 a[112:115], v23 offset:8192
    v_mfma_f32_16x16x32_bf16 v[160:163], a[152:155], a[80:83], v[160:163]
    ds_read_b64_tr_b16 a[140:141], v7 offset:50176
    buffer_load_dwordx4 v31, s[20:23], s85 offen offset:3072 lds
    v_mfma_f32_16x16x32_bf16 v[164:167], a[152:155], a[84:87], v[164:167]
    ds_read_b128 a[116:119], v23 offset:10240
    s_add_u32 s79, s76, 0x180000
    v_mfma_f32_16x16x32_bf16 v[168:171], a[152:155], a[88:91], v[168:171]
    ds_read_b64_tr_b16 a[142:143], v7 offset:50688
    v_lshrrev_b32 v24, 1, v1
    v_mfma_f32_16x16x32_bf16 v[172:175], a[152:155], a[92:95], v[172:175]
    ds_read_b128 a[120:123], v23 offset:12288
    v_lshlrev_b32 v26, 16, v24
    v_mfma_f32_16x16x32_bf16 v[176:179], a[156:159], a[80:83], v[176:179]
    ds_read_b64_tr_b16 a[144:145], v6 offset:51200
    v_and_b32 v25, 1, v0
    v_mfma_f32_16x16x32_bf16 v[180:183], a[156:159], a[84:87], v[180:183]
    ds_read_b128 a[124:127], v23 offset:14336
    v_lshl_add_u32 v26, v25, 5, v26
    v_mfma_f32_16x16x32_bf16 v[184:187], a[156:159], a[88:91], v[184:187]
    ds_read_b64_tr_b16 a[146:147], v6 offset:51712
    v_and_b32 v28, 1, v2
    v_mfma_f32_16x16x32_bf16 v[188:191], a[156:159], a[92:95], v[188:191]
    s_waitcnt lgkmcnt(12)
    v_lshl_add_u32 v26, v28, 19, v26
    v_mfma_f32_16x16x32_bf16 v[128:131], a[128:131], a[96:99], v[128:131]
    ds_read_b64_tr_b16 a[148:149], v6 offset:52224
    v_lshrrev_b32 v28, 1, v2
    v_mfma_f32_16x16x32_bf16 v[132:135], a[128:131], a[100:103], v[132:135]
    s_add_u32 s85, s70, 65536
    v_lshl_add_u32 v4, v28, 4, v26
    s_waitcnt lgkmcnt(12)
    v_mfma_f32_16x16x32_bf16 v[136:139], a[128:131], a[104:107], v[136:139]
    ds_read_b64_tr_b16 a[150:151], v6 offset:52736
    s_lshl2_add_u32 s86, s0, s4
    s_waitcnt lgkmcnt(11)
    v_mfma_f32_16x16x32_bf16 v[140:143], a[128:131], a[108:111], v[140:143]
    s_add_u32 m0, s93, 8192
    v_and_or_b32 v28, v0, 7, s86
    v_mfma_f32_16x16x32_bf16 v[144:147], a[132:135], a[96:99], v[144:147]
    ds_read_b64_tr_b16 a[152:153], v7 offset:51200
    v_cmp_eq_u32 vcc, 0, v28
    v_mfma_f32_16x16x32_bf16 v[148:151], a[132:135], a[100:103], v[148:151]
    s_waitcnt lgkmcnt(4)
    v_bfe_u32 v28, v0, 3, 1
    v_xor_b32 v28, 1, v28
    v_mfma_f32_16x16x32_bf16 v[152:155], a[132:135], a[104:107], v[152:155]
    ds_read_b64_tr_b16 a[154:155], v7 offset:51712
    v_lshl_or_b32 v18, v28, 31, 1.0
    v_mfma_f32_16x16x32_bf16 v[156:159], a[132:135], a[108:111], v[156:159]
    v_mfma_f32_16x16x32_bf16 v[160:163], a[136:139], a[96:99], v[160:163]
    ds_read_b64_tr_b16 a[156:157], v7 offset:52224
    buffer_load_dwordx4 v15, s[20:23], s85 offen offset:0 lds
    v_mfma_f32_16x16x32_bf16 v[164:167], a[136:139], a[100:103], v[164:167]
    s_lshl_b32 s86, s4, 5
    s_add_u32 s86, s86, 155648
    v_mfma_f32_16x16x32_bf16 v[168:171], a[136:139], a[104:107], v[168:171]
    ds_read_b64_tr_b16 a[158:159], v7 offset:52736
    buffer_load_dwordx4 v29, s[20:23], s85 offen offset:1024 lds
    v_mfma_f32_16x16x32_bf16 v[172:175], a[136:139], a[108:111], v[172:175]
    v_lshrrev_b32 v24, 3, v0
    v_mfma_f32_16x16x32_bf16 v[176:179], a[140:143], a[96:99], v[176:179]
    ds_read_b64_tr_b16 a[128:129], v8 offset:16384
    v_cndmask_b32 v18, v18, 0, vcc
    v_mfma_f32_16x16x32_bf16 v[180:183], a[140:143], a[100:103], v[180:183]
    buffer_load_dwordx4 v30, s[20:23], s85 offen offset:2048 lds
    v_lshl_add_u32 v19, v24, 8, s86
    v_mfma_f32_16x16x32_bf16 v[184:187], a[140:143], a[104:107], v[184:187]
    ds_read_b64_tr_b16 a[130:131], v8 offset:16896
    v_lshl_add_u32 v19, v25, 7, v19
    v_mfma_f32_16x16x32_bf16 v[188:191], a[140:143], a[108:111], v[188:191]
    s_waitcnt lgkmcnt(6)
    buffer_load_dwordx4 v31, s[20:23], s85 offen offset:3072 lds
    v_mfma_f32_16x16x32_bf16 v[128:131], a[144:147], a[112:115], v[128:131]
    ds_read_b64_tr_b16 a[132:133], v8 offset:17408
    v_bfe_u32 v25, v0, 1, 2
    v_mfma_f32_16x16x32_bf16 v[132:135], a[144:147], a[116:119], v[132:135]
    v_lshl_add_u32 v19, v25, 3, v19
    v_mfma_f32_16x16x32_bf16 v[136:139], a[144:147], a[120:123], v[136:139]
    ds_read_b64_tr_b16 a[134:135], v8 offset:17920
    s_add_u32 s85, s70, 98304
    v_mfma_f32_16x16x32_bf16 v[140:143], a[144:147], a[124:127], v[140:143]
    s_waitcnt vmcnt(12)
    v_cmp_ne_u32 vcc, 1, v16
    s_cbranch_vccz Lok_6
    s_mov_b32 s3, 0
Lspin_7:
    buffer_load_dword v16, v17, s[44:47], 0 offen sc1
    s_waitcnt vmcnt(0)
    v_cmp_ne_u32 vcc, 1, v16
    s_add_u32 s3, s3, 1
    s_cmp_lt_u32 s3, 300000
    s_cbranch_vccz Lok_6
    s_cbranch_scc1 Lspin_7
Lok_6:
    v_mfma_f32_16x16x32_bf16 v[144:147], a[148:151], a[112:115], v[144:147]
    ds_read_b64_tr_b16 a[136:137], v9 offset:16384
    s_add_u32 m0, s93, 12288
    v_mfma_f32_16x16x32_bf16 v[148:151], a[148:151], a[116:119], v[148:151]
    s_lshr_b32 s86, s0, 2
    s_lshl_b32 s86, s86, 8
    v_mfma_f32_16x16x32_bf16 v[152:155], a[148:151], a[120:123], v[152:155]
    ds_read_b64_tr_b16 a[138:139], v9 offset:16896
    s_lshl_b32 s87, s4, 15
    v_mfma_f32_16x16x32_bf16 v[156:159], a[148:151], a[124:127], v[156:159]
    s_waitcnt lgkmcnt(6)
    buffer_load_dwordx4 v15, s[20:23], s85 offen offset:0 lds
    v_mfma_f32_16x16x32_bf16 v[160:163], a[152:155], a[112:115], v[160:163]
    ds_read_b64_tr_b16 a[140:141], v9 offset:17408
    s_add_u32 s86, s86, s87
    v_mfma_f32_16x16x32_bf16 v[164:167], a[152:155], a[116:119], v[164:167]
    buffer_load_dwordx4 v29, s[20:23], s85 offen offset:1024 lds
    s_add_u32 s82, s86, 12652032
    v_mfma_f32_16x16x32_bf16 v[168:171], a[152:155], a[120:123], v[168:171]
    ds_read_b64_tr_b16 a[142:143], v9 offset:17920
    v_lshrrev_b32 v17, 3, v0
    v_mfma_f32_16x16x32_bf16 v[172:175], a[152:155], a[124:127], v[172:175]
    v_mfma_f32_16x16x32_bf16 v[176:179], a[156:159], a[112:115], v[176:179]
    ds_read_b64_tr_b16 a[144:145], v8 offset:18432
    buffer_load_dwordx4 v30, s[20:23], s85 offen offset:2048 lds
    v_mfma_f32_16x16x32_bf16 v[180:183], a[156:159], a[116:119], v[180:183]
    v_lshlrev_b32 v17, 12, v17
    v_bfe_u32 v28, v0, 2, 1
    v_mfma_f32_16x16x32_bf16 v[184:187], a[156:159], a[120:123], v[184:187]
    ds_read_b64_tr_b16 a[146:147], v8 offset:18944
    buffer_load_dwordx4 v31, s[20:23], s85 offen offset:3072 lds
    v_mfma_f32_16x16x32_bf16 v[188:191], a[156:159], a[124:127], v[188:191]
    s_waitcnt lgkmcnt(6)
    v_lshl_add_u32 v17, v28, 7, v17
    v_mfma_f32_16x16x32_bf16 v[192:195], a[128:131], a[32:35], v[192:195]
    ds_read_b64_tr_b16 a[148:149], v8 offset:19456
    v_mfma_f32_16x16x32_bf16 v[196:199], a[128:131], a[36:39], v[196:199]
    s_waitcnt vmcnt(12)
    v_mfma_f32_16x16x32_bf16 v[200:203], a[128:131], a[40:43], v[200:203]
    ds_read_b64_tr_b16 a[150:151], v8 offset:19968
    s_xor_b32 s89, s88, 0
    v_mfma_f32_16x16x32_bf16 v[204:207], a[128:131], a[44:47], v[204:207]
    ds_read_b64_tr_b16 a[160:161], v10 offset:0
    v_max_f32 v128, 0, v128
    v_mfma_f32_16x16x32_bf16 v[208:211], a[132:135], a[32:35], v[208:211]
    ds_read_b64_tr_b16 a[152:153], v9 offset:18432
    v_max_f32 v129, 0, v129
    v_mfma_f32_16x16x32_bf16 v[212:215], a[132:135], a[36:39], v[212:215]
    ds_read_b64_tr_b16 a[162:163], v10 offset:2048
    v_max_f32 v130, 0, v130
    v_mfma_f32_16x16x32_bf16 v[216:219], a[132:135], a[40:43], v[216:219]
    ds_read_b64_tr_b16 a[154:155], v9 offset:18944
    v_max_f32 v131, 0, v131
    v_mfma_f32_16x16x32_bf16 v[220:223], a[132:135], a[44:47], v[220:223]
    s_waitcnt lgkmcnt(8)
    ds_read_b64_tr_b16 a[164:165], v11 offset:0
    v_mfma_f32_16x16x32_bf16 v[224:227], a[136:139], a[32:35], v[224:227]
    ds_read_b64_tr_b16 a[156:157], v9 offset:19456
    v_max_f32 v160, 0, v160
    v_mfma_f32_16x16x32_bf16 v[228:231], a[136:139], a[36:39], v[228:231]
    ds_read_b64_tr_b16 a[166:167], v11 offset:2048
    v_max_f32 v161, 0, v161
    v_mfma_f32_16x16x32_bf16 v[232:235], a[136:139], a[40:43], v[232:235]
    ds_read_b64_tr_b16 a[158:159], v9 offset:19968
    v_max_f32 v162, 0, v162
    v_mfma_f32_16x16x32_bf16 v[236:239], a[136:139], a[44:47], v[236:239]
    ds_read_b64_tr_b16 a[168:169], v12 offset:0
    v_max_f32 v163, 0, v163
    v_mfma_f32_16x16x32_bf16 v[240:243], a[140:143], a[32:35], v[240:243]
    ds_read_b64_tr_b16 a[128:129], v8 offset:32768
    v_mul_f32 v128, v128, v144
    v_mfma_f32_16x16x32_bf16 v[244:247], a[140:143], a[36:39], v[244:247]
    ds_read_b64_tr_b16 a[170:171], v12 offset:2048
    v_mul_f32 v129, v129, v145
    v_mfma_f32_16x16x32_bf16 v[248:251], a[140:143], a[40:43], v[248:251]
    ds_read_b64_tr_b16 a[130:131], v8 offset:33280
    v_mul_f32 v130, v130, v146
    v_mfma_f32_16x16x32_bf16 v[252:255], a[140:143], a[44:47], v[252:255]
    s_waitcnt lgkmcnt(12)
    ds_read_b64_tr_b16 a[172:173], v13 offset:0
    v_mfma_f32_16x16x32_bf16 v[192:195], a[144:147], a[48:51], v[192:195]
    ds_read_b64_tr_b16 a[132:133], v8 offset:33792
    v_mul_f32 v131, v131, v147
    v_mul_f32 v160, v160, v176
    v_mul_f32 v161, v161, v177
    v_mul_f32 v162, v162, v178
    v_mul_f32 v163, v163, v179
    v_cvt_pk_bf16_f32 v144, v128, v129
    v_mfma_f32_16x16x32_bf16 v[196:199], a[144:147], a[52:55], v[196:199]
    ds_read_b64_tr_b16 a[174:175], v13 offset:2048
    s_add_u32 s85, s70, 131072
    v_mfma_f32_16x16x32_bf16 v[200:203], a[144:147], a[56:59], v[200:203]
    ds_read_b64_tr_b16 a[134:135], v8 offset:34304
    s_add_u32 m0, s93, 0
    v_mfma_f32_16x16x32_bf16 v[204:207], a[144:147], a[60:63], v[204:207]
    s_waitcnt lgkmcnt(1)
    buffer_load_dwordx4 v15, s[20:23], s85 offen offset:0 lds
    v_mfma_f32_16x16x32_bf16 v[208:211], a[148:151], a[48:51], v[208:211]
    ds_read_b64_tr_b16 a[136:137], v9 offset:32768
    buffer_load_dwordx4 v29, s[20:23], s85 offen offset:1024 lds
    v_mfma_f32_16x16x32_bf16 v[212:215], a[148:151], a[52:55], v[212:215]
    buffer_load_dwordx4 v30, s[20:23], s85 offen offset:2048 lds
    v_cvt_pk_bf16_f32 v145, v130, v131
    v_cvt_pk_bf16_f32 v146, v160, v161
    v_cvt_pk_bf16_f32 v147, v162, v163
    buffer_store_dwordx4 v[144:147], v14, s[24:27], s89 offen sc1
    v_mfma_f32_16x16x32_bf16 v[216:219], a[148:151], a[56:59], v[216:219]
    ds_read_b64_tr_b16 a[138:139], v9 offset:33280
    buffer_load_dwordx4 v31, s[20:23], s85 offen offset:3072 lds
    v_mfma_f32_16x16x32_bf16 v[220:223], a[148:151], a[60:63], v[220:223]
    s_xor_b32 s89, s88, 65536
    v_max_f32 v132, 0, v132
    v_mfma_f32_16x16x32_bf16 v[224:227], a[152:155], a[48:51], v[224:227]
    ds_read_b64_tr_b16 a[140:141], v9 offset:33792
    v_max_f32 v133, 0, v133
    v_max_f32 v134, 0, v134
    v_mfma_f32_16x16x32_bf16 v[228:231], a[152:155], a[52:55], v[228:231]
    v_max_f32 v135, 0, v135
    v_max_f32 v164, 0, v164
    v_mfma_f32_16x16x32_bf16 v[232:235], a[152:155], a[56:59], v[232:235]
    ds_read_b64_tr_b16 a[142:143], v9 offset:34304
    v_max_f32 v165, 0, v165
    v_max_f32 v166, 0, v166
    v_mfma_f32_16x16x32_bf16 v[236:239], a[152:155], a[60:63], v[236:239]
    v_max_f32 v167, 0, v167
    v_mul_f32 v132, v132, v148
    v_mfma_f32_16x16x32_bf16 v[240:243], a[156:159], a[48:51], v[240:243]
    ds_read_b64_tr_b16 a[144:145], v8 offset:34816
    v_mul_f32 v133, v133, v149
    v_mul_f32 v134, v134, v150
    v_mfma_f32_16x16x32_bf16 v[244:247], a[156:159], a[52:55], v[244:247]
    v_mul_f32 v135, v135, v151
    v_mul_f32 v164, v164, v180
    v_mfma_f32_16x16x32_bf16 v[248:251], a[156:159], a[56:59], v[248:251]
    ds_read_b64_tr_b16 a[146:147], v8 offset:35328
    v_mul_f32 v165, v165, v181
    v_mul_f32 v166, v166, v182
    v_mfma_f32_16x16x32_bf16 v[252:255], a[156:159], a[60:63], v[252:255]
    s_waitcnt lgkmcnt(6)
    v_mul_f32 v167, v167, v183
    v_cvt_pk_bf16_f32 v148, v132, v133
    v_mfma_f32_16x16x32_bf16 v[192:195], a[128:131], a[64:67], v[192:195]
    ds_read_b64_tr_b16 a[148:149], v8 offset:35840
    v_cvt_pk_bf16_f32 v149, v134, v135
    v_cvt_pk_bf16_f32 v150, v164, v165
    v_mfma_f32_16x16x32_bf16 v[196:199], a[128:131], a[68:71], v[196:199]
    v_cvt_pk_bf16_f32 v151, v166, v167
    buffer_store_dwordx4 v[148:151], v14, s[24:27], s89 offen sc1
    v_mfma_f32_16x16x32_bf16 v[200:203], a[128:131], a[72:75], v[200:203]
    ds_read_b64_tr_b16 a[150:151], v8 offset:36352
    s_xor_b32 s89, s88, 131072
    v_max_f32 v136, 0, v136
    v_mfma_f32_16x16x32_bf16 v[204:207], a[128:131], a[76:79], v[204:207]
    v_max_f32 v137, 0, v137
    v_max_f32 v138, 0, v138
    v_mfma_f32_16x16x32_bf16 v[208:211], a[132:135], a[64:67], v[208:211]
    ds_read_b64_tr_b16 a[152:153], v9 offset:34816
    v_max_f32 v139, 0, v139
    v_max_f32 v168, 0, v168
    v_mfma_f32_16x16x32_bf16 v[212:215], a[132:135], a[68:71], v[212:215]
    v_max_f32 v169, 0, v169
    v_max_f32 v170, 0, v170
    v_mfma_f32_16x16x32_bf16 v[216:219], a[132:135], a[72:75], v[216:219]
    ds_read_b64_tr_b16 a[154:155], v9 offset:35328
    v_max_f32 v171, 0, v171
    v_mul_f32 v136, v136, v152
    v_mfma_f32_16x16x32_bf16 v[220:223], a[132:135], a[76:79], v[220:223]
    s_waitcnt lgkmcnt(6)
    v_mul_f32 v137, v137, v153
    v_mul_f32 v138, v138, v154
    v_mfma_f32_16x16x32_bf16 v[224:227], a[136:139], a[64:67], v[224:227]
    ds_read_b64_tr_b16 a[156:157], v9 offset:35840
    v_mul_f32 v139, v139, v155
    v_mul_f32 v168, v168, v184
    v_mfma_f32_16x16x32_bf16 v[228:231], a[136:139], a[68:71], v[228:231]
    v_mul_f32 v169, v169, v185
    v_mul_f32 v170, v170, v186
    v_mfma_f32_16x16x32_bf16 v[232:235], a[136:139], a[72:75], v[232:235]
    ds_read_b64_tr_b16 a[158:159], v9 offset:36352
    v_mul_f32 v171, v171, v187
    v_cvt_pk_bf16_f32 v152, v136, v137
    v_mfma_f32_16x16x32_bf16 v[236:239], a[136:139], a[76:79], v[236:239]
    v_cvt_pk_bf16_f32 v153, v138, v139
    v_cvt_pk_bf16_f32 v154, v168, v169
    v_mfma_f32_16x16x32_bf16 v[240:243], a[140:143], a[64:67], v[240:243]
    ds_read_b64_tr_b16 a[128:129], v8 offset:49152
    v_cvt_pk_bf16_f32 v155, v170, v171
    buffer_store_dwordx4 v[152:155], v14, s[24:27], s89 offen sc1
    v_mfma_f32_16x16x32_bf16 v[244:247], a[140:143], a[68:71], v[244:247]
    s_xor_b32 s89, s88, 196608
    v_max_f32 v140, 0, v140
    v_mfma_f32_16x16x32_bf16 v[248:251], a[140:143], a[72:75], v[248:251]
    ds_read_b64_tr_b16 a[130:131], v8 offset:49664
    v_max_f32 v141, 0, v141
    v_max_f32 v142, 0, v142
    v_mfma_f32_16x16x32_bf16 v[252:255], a[140:143], a[76:79], v[252:255]
    s_waitcnt lgkmcnt(6)
    v_max_f32 v143, 0, v143
    v_max_f32 v172, 0, v172
    v_mfma_f32_16x16x32_bf16 v[192:195], a[144:147], a[80:83], v[192:195]
    ds_read_b64_tr_b16 a[132:133], v8 offset:50176
    v_max_f32 v173, 0, v173
    v_max_f32 v174, 0, v174
    v_mfma_f32_16x16x32_bf16 v[196:199], a[144:147], a[84:87], v[196:199]
    v_max_f32 v175, 0, v175
    v_mul_f32 v140, v140, v156
    v_mfma_f32_16x16x32_bf16 v[200:203], a[144:147], a[88:91], v[200:203]
    ds_read_b64_tr_b16 a[134:135], v8 offset:50688
    v_mul_f32 v141, v141, v157
    v_mul_f32 v142, v142, v158
    v_mfma_f32_16x16x32_bf16 v[204:207], a[144:147], a[92:95], v[204:207]
    v_mul_f32 v143, v143, v159
    v_mul_f32 v172, v172, v188
    v_mfma_f32_16x16x32_bf16 v[208:211], a[148:151], a[80:83], v[208:211]
    ds_read_b64_tr_b16 a[136:137], v9 offset:49152
    v_mul_f32 v173, v173, v189
    v_mul_f32 v174, v174, v190
    v_mfma_f32_16x16x32_bf16 v[212:215], a[148:151], a[84:87], v[212:215]
    v_mul_f32 v175, v175, v191
    v_cvt_pk_bf16_f32 v156, v140, v141
    v_mfma_f32_16x16x32_bf16 v[216:219], a[148:151], a[88:91], v[216:219]
    ds_read_b64_tr_b16 a[138:139], v9 offset:49664
    v_cvt_pk_bf16_f32 v157, v142, v143
    v_cvt_pk_bf16_f32 v158, v172, v173
    v_mfma_f32_16x16x32_bf16 v[220:223], a[148:151], a[92:95], v[220:223]
    s_waitcnt lgkmcnt(6)
    v_cvt_pk_bf16_f32 v159, v174, v175
    buffer_store_dwordx4 v[156:159], v14, s[24:27], s89 offen sc1
    v_mfma_f32_16x16x32_bf16 v[224:227], a[152:155], a[80:83], v[224:227]
    ds_read_b64_tr_b16 a[140:141], v9 offset:50176
    v_mfma_f32_16x16x32_bf16 v[228:231], a[152:155], a[84:87], v[228:231]
    v_mfma_f32_16x16x32_bf16 v[232:235], a[152:155], a[88:91], v[232:235]
    ds_read_b64_tr_b16 a[142:143], v9 offset:50688
    v_mfma_f32_16x16x32_bf16 v[236:239], a[152:155], a[92:95], v[236:239]
    s_lshr_b32 s86, s74, 1
    v_mfma_f32_16x16x32_bf16 v[240:243], a[156:159], a[80:83], v[240:243]
    ds_read_b64_tr_b16 a[144:145], v8 offset:51200
    v_mfma_f32_16x16x32_bf16 v[244:247], a[156:159], a[84:87], v[244:247]
    s_lshl3_add_u32 s86, s86, s0
    v_mfma_f32_16x16x32_bf16 v[248:251], a[156:159], a[88:91], v[248:251]
    ds_read_b64_tr_b16 a[146:147], v8 offset:51712
    v_mfma_f32_16x16x32_bf16 v[252:255], a[156:159], a[92:95], v[252:255]
    s_waitcnt lgkmcnt(6)
    v_mfma_f32_16x16x32_bf16 v[192:195], a[128:131], a[96:99], v[192:195]
    ds_read_b64_tr_b16 a[148:149], v8 offset:52224
    s_lshl2_add_u32 s86, s86, s4
    v_mfma_f32_16x16x32_bf16 v[196:199], a[128:131], a[100:103], v[196:199]
    v_mfma_f32_16x16x32_bf16 v[200:203], a[128:131], a[104:107], v[200:203]
    ds_read_b64_tr_b16 a[150:151], v8 offset:52736
    v_mfma_f32_16x16x32_bf16 v[204:207], a[128:131], a[108:111], v[204:207]
    s_lshl_b32 s86, s86, 7
    v_mfma_f32_16x16x32_bf16 v[208:211], a[132:135], a[96:99], v[208:211]
    ds_read_b64_tr_b16 a[152:153], v9 offset:51200
    v_mfma_f32_16x16x32_bf16 v[212:215], a[132:135], a[100:103], v[212:215]
    v_mfma_f32_16x16x32_bf16 v[216:219], a[132:135], a[104:107], v[216:219]
    ds_read_b64_tr_b16 a[154:155], v9 offset:51712
    s_and_b32 s87, s74, 1
    v_mfma_f32_16x16x32_bf16 v[220:223], a[132:135], a[108:111], v[220:223]
    s_waitcnt lgkmcnt(6)
    v_mfma_f32_16x16x32_bf16 v[224:227], a[136:139], a[96:99], v[224:227]
    ds_read_b64_tr_b16 a[156:157], v9 offset:52224
    v_mfma_f32_16x16x32_bf16 v[228:231], a[136:139], a[100:103], v[228:231]
    s_add_u32 s86, s86, s87
    v_mfma_f32_16x16x32_bf16 v[232:235], a[136:139], a[104:107], v[232:235]
    ds_read_b64_tr_b16 a[158:159], v9 offset:52736
    v_mfma_f32_16x16x32_bf16 v[236:239], a[136:139], a[108:111], v[236:239]
    v_mfma_f32_16x16x32_bf16 v[240:243], a[140:143], a[96:99], v[240:243]
    buffer_load_dword v16, v17, s[24:27], s82 offen sc1
    s_lshl_b32 s86, s86, 5
    v_mfma_f32_16x16x32_bf16 v[244:247], a[140:143], a[100:103], v[244:247]
    v_mfma_f32_16x16x32_bf16 v[248:251], a[140:143], a[104:107], v[248:251]
    v_mfma_f32_16x16x32_bf16 v[252:255], a[140:143], a[108:111], v[252:255]
    s_waitcnt lgkmcnt(4)
    s_add_u32 s86, s86, 8388608
    v_mfma_f32_16x16x32_bf16 v[192:195], a[144:147], a[112:115], v[192:195]
    v_mfma_f32_16x16x32_bf16 v[196:199], a[144:147], a[116:119], v[196:199]
    v_mfma_f32_16x16x32_bf16 v[200:203], a[144:147], a[120:123], v[200:203]
    v_and_b32 v26, 62, v0
    v_mfma_f32_16x16x32_bf16 v[204:207], a[144:147], a[124:127], v[204:207]
    v_mfma_f32_16x16x32_bf16 v[208:211], a[148:151], a[112:115], v[208:211]
    v_mfma_f32_16x16x32_bf16 v[212:215], a[148:151], a[116:119], v[212:215]
    v_lshl_add_u32 v26, v26, 4, v14
    v_mfma_f32_16x16x32_bf16 v[216:219], a[148:151], a[120:123], v[216:219]
    v_mfma_f32_16x16x32_bf16 v[220:223], a[148:151], a[124:127], v[220:223]
    s_waitcnt lgkmcnt(0)
    v_mfma_f32_16x16x32_bf16 v[224:227], a[152:155], a[112:115], v[224:227]
    v_add_u32 v25, 0x400, v26
    v_mfma_f32_16x16x32_bf16 v[228:231], a[152:155], a[116:119], v[228:231]
    v_mfma_f32_16x16x32_bf16 v[232:235], a[152:155], a[120:123], v[232:235]
    v_mfma_f32_16x16x32_bf16 v[236:239], a[152:155], a[124:127], v[236:239]
    s_lshl_b32 s87, s4, 11
    v_mfma_f32_16x16x32_bf16 v[240:243], a[156:159], a[112:115], v[240:243]
    v_mfma_f32_16x16x32_bf16 v[244:247], a[156:159], a[116:119], v[244:247]
    v_mfma_f32_16x16x32_bf16 v[248:251], a[156:159], a[120:123], v[248:251]
    v_mfma_f32_16x16x32_bf16 v[252:255], a[156:159], a[124:127], v[252:255]
    s_xor_b32 s89, s88, 1024
    v_max_f32 v192, 0, v192
    v_max_f32 v193, 0, v193
    v_max_f32 v194, 0, v194
    v_max_f32 v195, 0, v195
    v_max_f32 v224, 0, v224
    v_max_f32 v225, 0, v225
    v_max_f32 v226, 0, v226
    v_max_f32 v227, 0, v227
    v_pk_mul_f32 v[192:193], v[192:193], v[208:209]
    v_pk_mul_f32 v[194:195], v[194:195], v[210:211]
    v_pk_mul_f32 v[224:225], v[224:225], v[240:241]
    v_pk_mul_f32 v[226:227], v[226:227], v[242:243]
    v_cvt_pk_bf16_f32 v208, v192, v193
    v_cvt_pk_bf16_f32 v209, v194, v195
    v_cvt_pk_bf16_f32 v210, v224, v225
    v_cvt_pk_bf16_f32 v211, v226, v227
    buffer_store_dwordx4 v[208:211], v14, s[24:27], s89 offen sc1
    s_add_u32 m0, s87, 155648
    s_waitcnt vmcnt(1)
    v_cmp_ne_u32 vcc, 1, v16
    s_cbranch_vccz Lok_8
    s_mov_b32 s3, 0
Lspin_9:
    buffer_load_dword v16, v17, s[24:27], s82 offen sc1
    s_waitcnt vmcnt(0)
    v_cmp_ne_u32 vcc, 1, v16
    s_add_u32 s3, s3, 1
    s_cmp_lt_u32 s3, 300000
    s_cbranch_vccz Lok_8
    s_cbranch_scc1 Lspin_9
Lok_8:
    buffer_load_dwordx4 v26, s[24:27], s86 offen sc1 lds
    buffer_load_dwordx4 v25, s[24:27], s86 offen offset:1024 sc1 lds
    s_xor_b32 s89, s88, 66560
    v_max_f32 v196, 0, v196
    v_max_f32 v197, 0, v197
    v_max_f32 v198, 0, v198
    v_max_f32 v199, 0, v199
    v_max_f32 v228, 0, v228
    v_max_f32 v229, 0, v229
    v_max_f32 v230, 0, v230
    v_max_f32 v231, 0, v231
    v_pk_mul_f32 v[196:197], v[196:197], v[212:213]
    v_pk_mul_f32 v[198:199], v[198:199], v[214:215]
    v_pk_mul_f32 v[228:229], v[228:229], v[244:245]
    v_pk_mul_f32 v[230:231], v[230:231], v[246:247]
    v_cvt_pk_bf16_f32 v212, v196, v197
    v_cvt_pk_bf16_f32 v213, v198, v199
    v_cvt_pk_bf16_f32 v214, v228, v229
    v_cvt_pk_bf16_f32 v215, v230, v231
    buffer_store_dwordx4 v[212:215], v14, s[24:27], s89 offen sc1
    s_xor_b32 s89, s88, 132096
    v_max_f32 v200, 0, v200
    v_max_f32 v201, 0, v201
    v_max_f32 v202, 0, v202
    v_max_f32 v203, 0, v203
    v_max_f32 v232, 0, v232
    v_max_f32 v233, 0, v233
    v_max_f32 v234, 0, v234
    v_max_f32 v235, 0, v235
    v_pk_mul_f32 v[200:201], v[200:201], v[216:217]
    v_pk_mul_f32 v[202:203], v[202:203], v[218:219]
    v_pk_mul_f32 v[232:233], v[232:233], v[248:249]
    v_pk_mul_f32 v[234:235], v[234:235], v[250:251]
    v_cvt_pk_bf16_f32 v216, v200, v201
    v_cvt_pk_bf16_f32 v217, v202, v203
    v_cvt_pk_bf16_f32 v218, v232, v233
    v_cvt_pk_bf16_f32 v219, v234, v235
    buffer_store_dwordx4 v[216:219], v14, s[24:27], s89 offen sc1
    s_xor_b32 s89, s88, 197632
    v_max_f32 v204, 0, v204
    v_max_f32 v205, 0, v205
    v_max_f32 v206, 0, v206
    v_max_f32 v207, 0, v207
    v_max_f32 v236, 0, v236
    v_max_f32 v237, 0, v237
    v_max_f32 v238, 0, v238
    v_max_f32 v239, 0, v239
    v_pk_mul_f32 v[204:205], v[204:205], v[220:221]
    v_pk_mul_f32 v[206:207], v[206:207], v[222:223]
    v_pk_mul_f32 v[236:237], v[236:237], v[252:253]
    v_pk_mul_f32 v[238:239], v[238:239], v[254:255]
    v_cvt_pk_bf16_f32 v220, v204, v205
    v_cvt_pk_bf16_f32 v221, v206, v207
    v_cvt_pk_bf16_f32 v222, v236, v237
    v_cvt_pk_bf16_f32 v223, v238, v239
    buffer_store_dwordx4 v[220:223], v14, s[24:27], s89 offen sc1
    s_mul_i32 s86, s4, 1280
    s_add_u32 s86, s86, 131072
    v_lshrrev_b32 v27, 2, v0
    v_lshl_add_u32 v28, v27, 4, v14
    v_add_u32 v28, s86, v28
    s_mov_b32 s88, 0x05040100
    s_mov_b32 s89, 0x07060302
    v_alignbyte_b32 v32, v33, v32, s1
    v_alignbyte_b32 v33, v34, v33, s1
    v_alignbyte_b32 v34, v35, v34, s1
    v_alignbyte_b32 v35, v40, v35, s1
    v_perm_b32 v192, v33, v32, s88
    v_perm_b32 v193, v35, v34, s88
    v_perm_b32 v194, v33, v32, s89
    v_perm_b32 v195, v35, v34, s89
    ds_write_b128 v28, v[192:195] offset:0
    v_alignbyte_b32 v36, v37, v36, s1
    v_alignbyte_b32 v37, v38, v37, s1
    v_alignbyte_b32 v38, v39, v38, s1
    v_alignbyte_b32 v39, v41, v39, s1
    v_perm_b32 v196, v37, v36, s88
    v_perm_b32 v197, v39, v38, s88
    v_perm_b32 v198, v37, v36, s89
    v_perm_b32 v199, v39, v38, s89
    ds_write_b128 v28, v[196:199] offset:5120
    v_pk_fma_f32 v[50:51], v[58:59], v[42:43], v[50:51] neg_lo:[0,0,1] neg_hi:[0,0,1]
    v_pk_fma_f32 v[52:53], v[58:59], v[44:45], v[52:53] neg_lo:[0,0,1] neg_hi:[0,0,1]
    v_pk_fma_f32 v[54:55], v[58:59], v[46:47], v[54:55] neg_lo:[0,0,1] neg_hi:[0,0,1]
    v_pk_fma_f32 v[56:57], v[58:59], v[48:49], v[56:57] neg_lo:[0,0,1] neg_hi:[0,0,1]
    v_cvt_pk_bf16_f32 v108, v50, v51
    v_cvt_pk_bf16_f32 v109, v52, v53
    v_cvt_pk_bf16_f32 v110, v54, v55
    v_cvt_pk_bf16_f32 v111, v56, v57
    v_pk_fma_f32 v[42:43], v[58:59], v[50:51], v[42:43] neg_lo:[0,0,1] neg_hi:[0,0,1]
    v_pk_fma_f32 v[44:45], v[58:59], v[52:53], v[44:45] neg_lo:[0,0,1] neg_hi:[0,0,1]
    v_pk_fma_f32 v[46:47], v[58:59], v[54:55], v[46:47] neg_lo:[0,0,1] neg_hi:[0,0,1]
    v_pk_fma_f32 v[48:49], v[58:59], v[56:57], v[48:49] neg_lo:[0,0,1] neg_hi:[0,0,1]
    v_cvt_pk_bf16_f32 v112, v42, v43
    v_cvt_pk_bf16_f32 v113, v44, v45
    v_cvt_pk_bf16_f32 v114, v46, v47
    v_cvt_pk_bf16_f32 v115, v48, v49
    v_pk_fma_f32 v[50:51], v[58:59], v[42:43], v[50:51] neg_lo:[0,0,1] neg_hi:[0,0,1]
    v_pk_fma_f32 v[52:53], v[58:59], v[44:45], v[52:53] neg_lo:[0,0,1] neg_hi:[0,0,1]
    v_pk_fma_f32 v[54:55], v[58:59], v[46:47], v[54:55] neg_lo:[0,0,1] neg_hi:[0,0,1]
    v_pk_fma_f32 v[56:57], v[58:59], v[48:49], v[56:57] neg_lo:[0,0,1] neg_hi:[0,0,1]
    v_cvt_pk_bf16_f32 v116, v50, v51
    v_cvt_pk_bf16_f32 v117, v52, v53
    v_cvt_pk_bf16_f32 v118, v54, v55
    v_cvt_pk_bf16_f32 v119, v56, v57
    v_pk_fma_f32 v[42:43], v[58:59], v[50:51], v[42:43] neg_lo:[0,0,1] neg_hi:[0,0,1]
    v_pk_fma_f32 v[44:45], v[58:59], v[52:53], v[44:45] neg_lo:[0,0,1] neg_hi:[0,0,1]
    v_pk_fma_f32 v[46:47], v[58:59], v[54:55], v[46:47] neg_lo:[0,0,1] neg_hi:[0,0,1]
    v_pk_fma_f32 v[48:49], v[58:59], v[56:57], v[48:49] neg_lo:[0,0,1] neg_hi:[0,0,1]
    v_cvt_pk_bf16_f32 v120, v42, v43
    v_cvt_pk_bf16_f32 v121, v44, v45
    v_cvt_pk_bf16_f32 v122, v46, v47
    v_cvt_pk_bf16_f32 v123, v48, v49
    v_pk_fma_f32 v[50:51], v[58:59], v[42:43], v[50:51] neg_lo:[0,0,1] neg_hi:[0,0,1]
    v_pk_fma_f32 v[52:53], v[58:59], v[44:45], v[52:53] neg_lo:[0,0,1] neg_hi:[0,0,1]
    v_pk_fma_f32 v[54:55], v[58:59], v[46:47], v[54:55] neg_lo:[0,0,1] neg_hi:[0,0,1]
    v_pk_fma_f32 v[56:57], v[58:59], v[48:49], v[56:57] neg_lo:[0,0,1] neg_hi:[0,0,1]
    v_cvt_pk_bf16_f32 v124, v50, v51
    v_cvt_pk_bf16_f32 v125, v52, v53
    v_cvt_pk_bf16_f32 v126, v54, v55
    v_cvt_pk_bf16_f32 v127, v56, v57
    s_lshl3_add_u32 s86, s75, s73
    s_lshl_b32 s86, s86, 1
    v_lshrrev_b32 v25, 5, v0
    v_add_u32 v236, s86, v25
    v_and_b32 v25, 3, v236
    v_lshrrev_b32 v26, 2, v236
    v_lshl_add_u32 v25, v25, 4, v26
    v_and_b32 v233, 0x1f0, v14
    v_lshl_add_u32 v232, v25, 15, v233
    v_lshl_add_u32 v232, s5, 10, v232
    buffer_load_dwordx4 v[216:219], v232, s[8:11], 0 offen offset:2048
    buffer_load_dwordx4 v[220:223], v232, s[8:11], 0 offen offset:2560
    buffer_load_dwordx4 v[224:227], v233, s[40:43], 0 offen
    buffer_load_dwordx4 v[228:231], v233, s[40:43], 0 offen offset:512
    s_or_b32 s87, s4, s0
    s_cselect_b32 s87, 4, 2
    s_lshl_b32 s86, s4, 4
    v_and_b32 v26, 3, v0
    v_cmp_eq_u32 vcc, s87, v26
    v_and_b32 v28, 1, v0
    v_lshl_add_u32 v28, v28, 3, s86
    v_lshrrev_b32 v27, 2, v0
    v_mul_u32_u24 v27, 80, v27
    v_cndmask_b32 v28, v28, 64, vcc
    s_mov_b32 s86, 131072
    v_add3_u32 v27, v27, v28, s86
    s_waitcnt vmcnt(7) lgkmcnt(0)
    s_barrier
    ds_read_b64_tr_b16 v[192:193], v27 offset:0
    ds_read_b64_tr_b16 v[194:195], v27 offset:2560
    ds_read_b64_tr_b16 v[196:197], v27 offset:5120
    ds_read_b64_tr_b16 v[198:199], v27 offset:7680
    ds_read_b64_tr_b16 v[200:201], v27 offset:1280
    ds_read_b64_tr_b16 v[202:203], v27 offset:3840
    ds_read_b64_tr_b16 v[204:205], v27 offset:6400
    ds_read_b64_tr_b16 v[206:207], v27 offset:8960
    ds_read_b64_tr_b16 v[128:129], v19 offset:0
    ds_read_b64_tr_b16 v[130:131], v19 offset:2048
    ds_read_b64_tr_b16 v[132:133], v19 offset:4096
    ds_read_b64_tr_b16 v[134:135], v19 offset:6144
    s_waitcnt lgkmcnt(4)
    v_lshlrev_b32 v208, 16, v192
    v_lshlrev_b32 v209, 16, v194
    v_lshlrev_b32 v210, 16, v196
    v_lshlrev_b32 v211, 16, v198
    v_add_f32 v32, v208, v209
    v_add_f32 v40, v210, v211
    v_sub_f32 v48, v211, v210
    v_sub_f32 v56, v208, v209
    v_cndmask_b32 v20, v32, v209, s[90:91]
    v_cndmask_b32 v21, v40, v211, s[90:91]
    v_cndmask_b32 v32, v32, v208, s[90:91]
    v_cndmask_b32 v40, v40, v210, s[90:91]
    s_waitcnt lgkmcnt(2)
    v_mfma_f32_16x16x32_bf16 v[136:139], a[224:227], v[128:131], 0
    v_cndmask_b32 v48, v48, 0, s[90:91]
    v_cndmask_b32 v56, v56, 0, s[90:91]
    v_and_b32 v212, s92, v192
    v_and_b32 v213, s92, v194
    v_and_b32 v214, s92, v196
    v_mfma_f32_16x16x32_bf16 v[140:143], a[232:235], v[128:131], 0
    v_and_b32 v215, s92, v198
    v_add_f32 v33, v212, v213
    v_add_f32 v41, v214, v215
    v_sub_f32 v49, v215, v214
    v_sub_f32 v57, v212, v213
    v_mfma_f32_16x16x32_bf16 v[144:147], a[240:243], v[128:131], 0
    v_lshlrev_b32 v208, 16, v193
    v_lshlrev_b32 v209, 16, v195
    v_lshlrev_b32 v210, 16, v197
    v_lshlrev_b32 v211, 16, v199
    v_add_f32 v34, v208, v209
    v_mfma_f32_16x16x32_bf16 v[148:151], a[248:251], v[128:131], 0
    v_add_f32 v42, v210, v211
    v_sub_f32 v50, v211, v210
    v_sub_f32 v58, v208, v209
    v_and_b32 v212, s92, v193
    v_and_b32 v213, s92, v195
    s_waitcnt lgkmcnt(0)
    v_mfma_f32_16x16x32_bf16 v[136:139], a[228:231], v[132:135], v[136:139]
    v_and_b32 v214, s92, v197
    v_and_b32 v215, s92, v199
    v_add_f32 v35, v212, v213
    v_add_f32 v43, v214, v215
    v_sub_f32 v51, v215, v214
    v_mfma_f32_16x16x32_bf16 v[140:143], a[236:239], v[132:135], v[140:143]
    v_sub_f32 v59, v212, v213
    v_lshlrev_b32 v208, 16, v200
    v_lshlrev_b32 v209, 16, v202
    v_lshlrev_b32 v210, 16, v204
    v_lshlrev_b32 v211, 16, v206
    v_mfma_f32_16x16x32_bf16 v[144:147], a[244:247], v[132:135], v[144:147]
    v_add_f32 v36, v208, v209
    v_add_f32 v44, v210, v211
    v_sub_f32 v52, v211, v210
    v_sub_f32 v60, v208, v209
    v_and_b32 v212, s92, v200
    v_mfma_f32_16x16x32_bf16 v[148:151], a[252:255], v[132:135], v[148:151]
    v_and_b32 v213, s92, v202
    v_and_b32 v214, s92, v204
    v_and_b32 v215, s92, v206
    v_add_f32 v37, v212, v213
    v_add_f32 v45, v214, v215
    v_sub_f32 v53, v215, v214
    v_sub_f32 v61, v212, v213
    v_lshlrev_b32 v208, 16, v201
    v_lshlrev_b32 v209, 16, v203
    v_lshlrev_b32 v210, 16, v205
    v_lshlrev_b32 v211, 16, v207
    v_add_f32 v38, v208, v209
    v_add_f32 v46, v210, v211
    v_sub_f32 v54, v211, v210
    v_sub_f32 v62, v208, v209
    v_and_b32 v212, s92, v201
    v_and_b32 v213, s92, v203
    v_and_b32 v214, s92, v205
    v_and_b32 v215, s92, v207
    v_add_f32 v39, v212, v213
    v_add_f32 v47, v214, v215
    v_sub_f32 v55, v215, v214
    v_sub_f32 v63, v212, v213
    v_mov_b32 v24, 1
    s_waitcnt vmcnt(4)
    s_mov_b64 exec, 1
    buffer_store_dword v24, v0, s[24:27], s81 offen sc1
    s_mov_b64 exec, -1
    s_nop 4
    v_mul_f32_dpp v152, v136, v18 row_ror:8 row_mask:0xf bank_mask:0xf
    v_mul_f32_dpp v153, v137, v18 row_ror:8 row_mask:0xf bank_mask:0xf
    v_mul_f32_dpp v154, v138, v18 row_ror:8 row_mask:0xf bank_mask:0xf
    v_mul_f32_dpp v155, v139, v18 row_ror:8 row_mask:0xf bank_mask:0xf
    v_mul_f32_dpp v156, v140, v18 row_ror:8 row_mask:0xf bank_mask:0xf
    v_mul_f32_dpp v157, v141, v18 row_ror:8 row_mask:0xf bank_mask:0xf
    v_mul_f32_dpp v158, v142, v18 row_ror:8 row_mask:0xf bank_mask:0xf
    v_mul_f32_dpp v159, v143, v18 row_ror:8 row_mask:0xf bank_mask:0xf
    v_mul_f32_dpp v160, v144, v18 row_ror:8 row_mask:0xf bank_mask:0xf
    v_mul_f32_dpp v161, v145, v18 row_ror:8 row_mask:0xf bank_mask:0xf
    v_mul_f32_dpp v162, v146, v18 row_ror:8 row_mask:0xf bank_mask:0xf
    v_mul_f32_dpp v163, v147, v18 row_ror:8 row_mask:0xf bank_mask:0xf
    v_mul_f32_dpp v164, v148, v18 row_ror:8 row_mask:0xf bank_mask:0xf
    v_mul_f32_dpp v165, v149, v18 row_ror:8 row_mask:0xf bank_mask:0xf
    v_mul_f32_dpp v166, v150, v18 row_ror:8 row_mask:0xf bank_mask:0xf
    v_mul_f32_dpp v167, v151, v18 row_ror:8 row_mask:0xf bank_mask:0xf
    v_pk_mul_f32 v[168:169], v[32:33], v[136:137]
    v_pk_mul_f32 v[170:171], v[34:35], v[138:139]
    v_pk_mul_f32 v[172:173], v[36:37], v[140:141]
    v_pk_mul_f32 v[174:175], v[38:39], v[142:143]
    v_pk_mul_f32 v[176:177], v[48:49], v[136:137]
    v_pk_mul_f32 v[178:179], v[50:51], v[138:139]
    v_pk_mul_f32 v[180:181], v[52:53], v[140:141]
    v_pk_mul_f32 v[182:183], v[54:55], v[142:143]
    v_pk_fma_f32 v[168:169], v[40:41], v[152:153], v[168:169]
    v_pk_fma_f32 v[170:171], v[42:43], v[154:155], v[170:171]
    v_pk_fma_f32 v[172:173], v[44:45], v[156:157], v[172:173]
    v_pk_fma_f32 v[174:175], v[46:47], v[158:159], v[174:175]
    v_mov_b32 v32, v20
    v_mov_b32 v40, v21
    v_pk_fma_f32 v[176:177], v[56:57], v[152:153], v[176:177]
    v_pk_fma_f32 v[178:179], v[58:59], v[154:155], v[178:179]
    v_pk_fma_f32 v[180:181], v[60:61], v[156:157], v[180:181]
    v_pk_fma_f32 v[182:183], v[62:63], v[158:159], v[182:183]
    v_pk_fma_f32 v[168:169], v[48:49], v[144:145], v[168:169] neg_lo:[1,0,0] neg_hi:[1,0,0]
    v_pk_fma_f32 v[170:171], v[50:51], v[146:147], v[170:171] neg_lo:[1,0,0] neg_hi:[1,0,0]
    v_pk_fma_f32 v[172:173], v[52:53], v[148:149], v[172:173] neg_lo:[1,0,0] neg_hi:[1,0,0]
    v_pk_fma_f32 v[174:175], v[54:55], v[150:151], v[174:175] neg_lo:[1,0,0] neg_hi:[1,0,0]
    v_pk_fma_f32 v[176:177], v[32:33], v[144:145], v[176:177]
    v_pk_fma_f32 v[178:179], v[34:35], v[146:147], v[178:179]
    v_pk_fma_f32 v[180:181], v[36:37], v[148:149], v[180:181]
    v_pk_fma_f32 v[182:183], v[38:39], v[150:151], v[182:183]
    v_pk_fma_f32 v[168:169], v[56:57], v[160:161], v[168:169] neg_lo:[1,0,0] neg_hi:[1,0,0]
    v_pk_fma_f32 v[170:171], v[58:59], v[162:163], v[170:171] neg_lo:[1,0,0] neg_hi:[1,0,0]
    v_pk_fma_f32 v[172:173], v[60:61], v[164:165], v[172:173] neg_lo:[1,0,0] neg_hi:[1,0,0]
    v_pk_fma_f32 v[174:175], v[62:63], v[166:167], v[174:175] neg_lo:[1,0,0] neg_hi:[1,0,0]
    v_pk_fma_f32 v[176:177], v[40:41], v[160:161], v[176:177]
    v_pk_fma_f32 v[178:179], v[42:43], v[162:163], v[178:179]
    v_pk_fma_f32 v[180:181], v[44:45], v[164:165], v[180:181]
    v_pk_fma_f32 v[182:183], v[46:47], v[166:167], v[182:183]
    v_cvt_pk_bf16_f32 v184, v168, v169
    v_cvt_pk_bf16_f32 v185, v170, v171
    v_cvt_pk_bf16_f32 v186, v172, v173
    v_cvt_pk_bf16_f32 v187, v174, v175
    v_cvt_pk_bf16_f32 v188, v176, v177
    v_cvt_pk_bf16_f32 v189, v178, v179
    v_mfma_f32_16x16x32_bf16 v[136:139], v[184:187], a[192:195], 0
    v_cvt_pk_bf16_f32 v190, v180, v181
    v_cvt_pk_bf16_f32 v191, v182, v183
    v_mfma_f32_16x16x32_bf16 v[140:143], v[184:187], a[200:203], 0
    s_lshl_b32 s83, s74, 8
    s_add_u32 s83, s83, s7
    s_lshl_b32 s83, s83, 10
    v_mfma_f32_16x16x32_bf16 v[144:147], v[184:187], a[208:211], 0
    s_xor_b32 s80, s83, 1048576
    s_andn2_b32 s87, s74, 4
    s_lshl_b32 s87, s87, 5
    v_mfma_f32_16x16x32_bf16 v[148:151], v[184:187], a[216:219], 0
    s_lshr_b32 s86, s7, 1
    s_add_u32 s86, s86, s87
    s_lshl_b32 s86, s86, 7
    v_mfma_f32_16x16x32_bf16 v[136:139], v[188:191], a[196:199], v[136:139]
    s_add_u32 s82, s86, 12648448
    v_lshrrev_b32 v24, 5, v0
    v_mfma_f32_16x16x32_bf16 v[140:143], v[188:191], a[204:207], v[140:143]
    v_mul_u32_u24 v24, 16384, v24
    v_bfe_u32 v17, v0, 3, 2
    v_mfma_f32_16x16x32_bf16 v[144:147], v[188:191], a[212:215], v[144:147]
    v_lshl_add_u32 v17, v17, 7, v24
    v_mfma_f32_16x16x32_bf16 v[148:151], v[188:191], a[220:223], v[148:151]
    v_cvt_pk_bf16_f32 v128, v136, v137
    v_cvt_pk_bf16_f32 v129, v138, v139
    s_nop 0
    v_cvt_pk_bf16_f32 v130, v140, v141
    v_cvt_pk_bf16_f32 v131, v142, v143
    s_nop 0
    v_cvt_pk_bf16_f32 v132, v144, v145
    v_cvt_pk_bf16_f32 v133, v146, v147
    v_cvt_pk_bf16_f32 v134, v148, v149
    v_cvt_pk_bf16_f32 v135, v150, v151
    v_permlane16_swap_b32 v128, v130
    v_permlane16_swap_b32 v129, v131
    buffer_store_dwordx4 v[128:131], v4, s[24:27], s76 offen sc1
    v_permlane16_swap_b32 v132, v134
    v_permlane16_swap_b32 v133, v135
    buffer_store_dwordx4 v[132:135], v4, s[24:27], s78 offen sc1
    s_waitcnt vmcnt(3)
    v_lshlrev_b32 v240, 16, v216
    v_and_b32 v241, s92, v216
    v_lshlrev_b32 v248, 16, v224
    v_and_b32 v249, s92, v224
    v_lshlrev_b32 v242, 16, v217
    v_and_b32 v243, s92, v217
    v_lshlrev_b32 v250, 16, v225
    v_and_b32 v251, s92, v225
    v_lshlrev_b32 v244, 16, v218
    v_and_b32 v245, s92, v218
    v_lshlrev_b32 v252, 16, v226
    v_and_b32 v253, s92, v226
    v_lshlrev_b32 v246, 16, v219
    v_and_b32 v247, s92, v219
    v_lshlrev_b32 v254, 16, v227
    v_and_b32 v255, s92, v227
    v_pk_mul_f32 v[240:241], v[240:241], v[248:249]
    v_pk_mul_f32 v[242:243], v[242:243], v[250:251]
    v_pk_mul_f32 v[244:245], v[244:245], v[252:253]
    v_pk_mul_f32 v[246:247], v[246:247], v[254:255]
    v_cvt_pk_bf16_f32 v216, v240, v241
    v_cvt_pk_bf16_f32 v217, v242, v243
    v_cvt_pk_bf16_f32 v218, v244, v245
    v_cvt_pk_bf16_f32 v219, v246, v247
    v_lshlrev_b32 v240, 16, v220
    v_and_b32 v241, s92, v220
    v_lshlrev_b32 v248, 16, v228
    v_and_b32 v249, s92, v228
    v_lshlrev_b32 v242, 16, v221
    v_and_b32 v243, s92, v221
    v_lshlrev_b32 v250, 16, v229
    v_and_b32 v251, s92, v229
    v_lshlrev_b32 v244, 16, v222
    v_and_b32 v245, s92, v222
    v_lshlrev_b32 v252, 16, v230
    v_and_b32 v253, s92, v230
    v_lshlrev_b32 v246, 16, v223
    v_and_b32 v247, s92, v223
    v_lshlrev_b32 v254, 16, v231
    v_and_b32 v255, s92, v231
    v_pk_mul_f32 v[240:241], v[240:241], v[248:249]
    v_pk_mul_f32 v[242:243], v[242:243], v[250:251]
    v_pk_mul_f32 v[244:245], v[244:245], v[252:253]
    v_pk_mul_f32 v[246:247], v[246:247], v[254:255]
    v_cvt_pk_bf16_f32 v220, v240, v241
    v_cvt_pk_bf16_f32 v221, v242, v243
    v_cvt_pk_bf16_f32 v222, v244, v245
    v_cvt_pk_bf16_f32 v223, v246, v247
    s_mov_b32 s3, 0x3f803f80
    v_dot2_f32_bf16 v232, v216, s3, 0
    v_dot2_f32_bf16 v233, v217, s3, 0
    v_dot2_f32_bf16 v234, v218, s3, 0
    v_dot2_f32_bf16 v235, v219, s3, 0
    v_dot2_f32_bf16 v232, v220, s3, v232
    v_dot2_f32_bf16 v233, v221, s3, v233
    v_dot2_f32_bf16 v234, v222, s3, v234
    v_dot2_f32_bf16 v235, v223, s3, v235
    v_lshlrev_b32 v236, 2, v236
    v_add_f32 v232, v232, v233
    s_nop 0
    v_add_f32 v234, v234, v235
    v_add_f32 v232, v232, v234
    s_nop 1
    v_add_f32_dpp v232, v232, v232 row_shr:1 row_mask:0xf bank_mask:0xf bound_ctrl:1
    s_nop 1
    v_add_f32_dpp v232, v232, v232 row_shr:2 row_mask:0xf bank_mask:0xf bound_ctrl:1
    s_nop 1
    v_add_f32_dpp v232, v232, v232 row_shr:4 row_mask:0xf bank_mask:0xf bound_ctrl:1
    s_nop 1
    v_add_f32_dpp v232, v232, v232 row_shr:8 row_mask:0xf bank_mask:0xf bound_ctrl:1
    s_nop 1
    v_add_f32_dpp v232, v232, v232 row_bcast:15 row_mask:0xa bank_mask:0xf
    v_cvt_pk_bf16_f32 v232, 0, v232
    v_mul_f32 v232, 0xbfb8aa3b, v232
    v_exp_f32 v232, v232
    s_nop 0
    v_add_f32 v232, 1.0, v232
    v_rcp_f32 v232, v232
    s_nop 0
    v_cvt_pk_bf16_f32 v232, 0, v232
    s_lshl_b32 s86, s5, 8
    s_add_u32 s86, s86, 12812288
    s_mov_b32 exec_lo, 0x80000000
    s_mov_b32 exec_hi, 0x80000000
    buffer_store_dword v232, v236, s[24:27], s86 offen sc1
    s_mov_b64 exec, -1
    s_lshl3_add_u32 s81, s74, s73
    s_lshl_b32 s81, s81, 5
    s_add_u32 s81, s81, 12779520
    v_mov_b32 v19, 1
    v_add_u32 v9, 147456, v14
    s_lshl_b32 s86, s4, 11
    s_add_u32 s86, s86, 147456
    ds_read_b64_tr_b16 a[176:177], v10 offset:4096
    v_add_u32 v181, s86, v14
    v_cvt_f32_u32 v180, v2
    ds_read_b64_tr_b16 a[178:179], v10 offset:6144
    v_mov_b32 v178, 0x3e800000
    s_lshl_b32 s86, s4, 4
    ds_read_b64_tr_b16 a[180:181], v11 offset:4096
    v_add_u32 v168, s86, v1
    ds_read_b64_tr_b16 a[182:183], v11 offset:6144
    v_cvt_f32_u32 v168, v168
    v_mul_f32 v171, 0x3c800000, v168
    ds_read_b64_tr_b16 a[184:185], v12 offset:4096
    v_add_f32 v179, v180, v180
    v_mul_f32 v172, v171, v179
    ds_read_b64_tr_b16 a[186:187], v12 offset:6144
    v_sub_f32 v173, v172, v178
    v_mul_f32 v168, 0.5, v168
    ds_read_b64_tr_b16 a[188:189], v13 offset:4096
    s_mov_b64 s[98:99], 0xffff
    ds_read_b64_tr_b16 a[190:191], v13 offset:6144
    v_cndmask_b32 v168, v173, v168, s[98:99]
    v_fmamk_f32 v162, v171, 0x3f800000, v172
    v_fmamk_f32 v163, v171, 0x3f800000, v173
    v_fmamk_f32 v164, v171, 0x41000000, v172
    ds_read_b64_tr_b16 a[0:1], v10 offset:8192
    v_fmamk_f32 v165, v171, 0x41000000, v173
    ds_read_b64_tr_b16 a[2:3], v10 offset:10240
    v_fmamk_f32 v166, v171, 0x41100000, v172
    v_fmamk_f32 v167, v171, 0x41100000, v173
    ds_read_b64_tr_b16 a[4:5], v11 offset:8192
    v_cos_f32 v160, v172
    v_cos_f32 v161, v168
    ds_read_b64_tr_b16 a[6:7], v11 offset:10240
    v_cos_f32 v162, v162
    v_cos_f32 v163, v163
    ds_read_b64_tr_b16 a[8:9], v12 offset:8192
    v_cos_f32 v164, v164
    ds_read_b64_tr_b16 a[10:11], v12 offset:10240
    v_cos_f32 v165, v165
    v_cos_f32 v166, v166
    ds_read_b64_tr_b16 a[12:13], v13 offset:8192
    v_cos_f32 v167, v167
    v_cvt_pk_bf16_f32 v160, v160, v161
    ds_read_b64_tr_b16 a[14:15], v13 offset:10240
    v_cvt_pk_bf16_f32 v161, v162, v163
    buffer_load_dword v16, v17, s[24:27], s82 offen sc1
    s_add_u32 s85, s70, 163840
    v_cvt_pk_bf16_f32 v162, v164, v165
    v_cvt_pk_bf16_f32 v163, v166, v167
    s_add_u32 m0, s93, 4096
    ds_write_b128 v181, v[160:163] offset:0
    v_fmamk_f32 v160, v171, 0x41800000, v172
    s_waitcnt lgkmcnt(9)
    v_fmamk_f32 v161, v171, 0x41800000, v173
    v_fmamk_f32 v162, v171, 0x41880000, v172
    buffer_load_dwordx4 v15, s[20:23], s85 offen offset:0 lds
    v_fmamk_f32 v163, v171, 0x41880000, v173
    buffer_load_dwordx4 v29, s[20:23], s85 offen offset:1024 lds
    v_fmamk_f32 v164, v171, 0x41c00000, v172
    v_fmamk_f32 v165, v171, 0x41c00000, v173
    buffer_load_dwordx4 v30, s[20:23], s85 offen offset:2048 lds
    v_fmamk_f32 v166, v171, 0x41c80000, v172
    v_fmamk_f32 v167, v171, 0x41c80000, v173
    buffer_load_dwordx4 v31, s[20:23], s85 offen offset:3072 lds
    v_cos_f32 v160, v160
    s_add_u32 s85, s70, 196608
    v_cos_f32 v161, v161
    v_cos_f32 v162, v162
    s_add_u32 m0, s93, 8192
    v_cos_f32 v163, v163
    v_cos_f32 v164, v164
    s_waitcnt lgkmcnt(1)
    v_cos_f32 v165, v165
    v_cos_f32 v166, v166
    buffer_load_dwordx4 v15, s[20:23], s85 offen offset:0 lds
    v_cos_f32 v167, v167
    buffer_load_dwordx4 v29, s[20:23], s85 offen offset:1024 lds
    v_cvt_pk_bf16_f32 v160, v160, v161
    v_cvt_pk_bf16_f32 v161, v162, v163
    buffer_load_dwordx4 v30, s[20:23], s85 offen offset:2048 lds
    v_cvt_pk_bf16_f32 v162, v164, v165
    v_cvt_pk_bf16_f32 v163, v166, v167
    buffer_load_dwordx4 v31, s[20:23], s85 offen offset:3072 lds
    ds_write_b128 v181, v[160:163] offset:1024
    s_waitcnt vmcnt(9) lgkmcnt(0)
    s_barrier
    s_cmp_lg_u32 s4, 0
    s_cbranch_scc1 Lnosig_10
    s_mov_b64 exec, 1
    buffer_store_dword v19, v0, s[24:27], s81 offen sc1
    s_mov_b64 exec, -1
Lnosig_10:
    s_waitcnt vmcnt(8)
    v_cmp_ne_u32 vcc, 1, v16
    s_cbranch_vccz Lok_11
    s_mov_b32 s3, 0
Lspin_12:
    buffer_load_dword v16, v17, s[24:27], s82 offen sc1
    s_waitcnt vmcnt(0)
    v_cmp_ne_u32 vcc, 1, v16
    s_add_u32 s3, s3, 1
    s_cmp_lt_u32 s3, 300000
    s_cbranch_vccz Lok_11
    s_cbranch_scc1 Lspin_12
Lok_11:
    s_add_u32 s94, s80, 0
    s_lshl_b32 s82, s4, 11
    s_add_u32 s82, s82, 12779520
    v_lshlrev_b32 v17, 5, v0
    s_lshl_b32 s88, s74, 16
    buffer_load_dwordx4 v[192:195], v14, s[24:27], s94 offen offset:0 sc1
    s_lshl_b32 s89, s4, 14
    s_add_u32 s88, s88, s89
    s_add_u32 s88, s88, 10485760
    buffer_load_dwordx4 v[196:199], v14, s[24:27], s94 offen offset:1024 sc1
    s_lshl_b32 s86, s74, 8
    s_add_u32 s86, s86, 12812288
    v_lshrrev_b32 v24, 1, v1
    v_lshlrev_b32 v24, 7, v24
    buffer_load_dwordx4 v[200:203], v14, s[24:27], s94 offen offset:2048 sc1
    v_and_b32 v25, 1, v0
    v_lshl_add_u32 v24, v25, 5, v24
    v_lshrrev_b32 v27, 1, v2
    buffer_load_dwordx4 v[204:207], v14, s[24:27], s94 offen offset:3072 sc1
    v_bfe_u32 v28, v0, 3, 1
    v_xor_b32 v28, v27, v28
    v_lshl_add_u32 v24, v28, 6, v24
    v_and_b32 v26, 1, v2
    s_add_u32 s94, s80, 4096
    v_lshl_add_u32 v5, v26, 4, v24
    v_lshrrev_b32 v24, 3, v0
    v_xor_b32 v25, v24, v0
    buffer_load_dwordx4 v[208:211], v14, s[24:27], s94 offen offset:0 sc1
    v_and_b32 v25, 7, v25
    v_lshlrev_b32 v24, 15, v24
    v_lshl_add_u32 v3, v25, 4, v24
    v_lshl_add_u32 v24, s4, 1, v27
    buffer_load_dwordx4 v[212:215], v14, s[24:27], s94 offen offset:1024 sc1
    v_xor_b32 v24, v24, v0
    v_and_b32 v24, 7, v24
    v_lshlrev_b32 v24, 4, v24
    buffer_load_dwordx4 v[216:219], v14, s[24:27], s94 offen offset:2048 sc1
    v_lshl_add_u32 v24, v1, 7, v24
    v_lshl_add_u32 v24, v26, 3, v24
    v_add_u32 v6, 155648, v24
    s_lshl_b32 s87, s4, 10
    s_add_u32 s94, s80, 65536
    s_add_u32 s87, s87, 155648
    v_add_u32 v7, s87, v14
    v_lshlrev_b32 v8, 4, v1
    buffer_load_dwordx4 v[220:223], v14, s[24:27], s94 offen offset:0 sc1
    s_lshl3_add_u32 s76, s74, s73
    s_lshl_b32 s76, s76, 7
    s_lshl_b32 s87, s4, 18
    s_add_u32 s76, s76, s87
    buffer_load_dwordx4 v[224:227], v14, s[24:27], s94 offen offset:1024 sc1
    s_add_u32 s77, s76, 0x100000
    s_xor_b32 s87, s4, 0
    s_mul_i32 s87, s87, 3072
    buffer_load_dwordx4 v[228:231], v14, s[24:27], s94 offen offset:2048 sc1
    s_add_u32 s87, s87, 77824
    v_add_u32 v32, s87, v14
    s_xor_b32 s87, s4, 1
    s_mul_i32 s87, s87, 3072
    buffer_load_dwordx4 v[232:235], v14, s[24:27], s94 offen offset:3072 sc1
    s_add_u32 s87, s87, 77824
    v_add_u32 v33, s87, v14
    s_xor_b32 s87, s4, 2
    s_add_u32 s94, s80, 69632
    s_mul_i32 s87, s87, 3072
    s_add_u32 s87, s87, 78848
    v_add_u32 v34, s87, v14
    s_xor_b32 s87, s4, 3
    buffer_load_dwordx4 v[236:239], v14, s[24:27], s94 offen offset:0 sc1
    s_mul_i32 s87, s87, 3072
    s_add_u32 s87, s87, 79872
    v_add_u32 v35, s87, v14
    ds_read_b128 a[224:227], v9 offset:0
    ds_read_b128 a[228:231], v9 offset:1024
    ds_read_b128 a[232:235], v9 offset:2048
    ds_read_b128 a[236:239], v9 offset:3072
    ds_read_b128 a[240:243], v9 offset:4096
    ds_read_b128 a[244:247], v9 offset:5120
    ds_read_b128 a[248:251], v9 offset:6144
    ds_read_b128 a[252:255], v9 offset:7168
    s_lshl3_add_u32 s87, s74, s73
    s_lshl_b32 s81, s87, 7
    s_add_u32 s81, s81, 12820480
    s_lshl2_add_u32 s78, s87, s4
    s_lshl_b32 s78, s78, 12
    s_xor_b32 s79, s78, 524288
    s_add_u32 s78, s78, 13631488
    s_add_u32 s79, s79, 13631488
    ds_read_b64_tr_b16 a[16:17], v10 offset:12288
    ds_read_b64_tr_b16 a[18:19], v10 offset:14336
    ds_read_b64_tr_b16 a[20:21], v11 offset:12288
    ds_read_b64_tr_b16 a[22:23], v11 offset:14336
    ds_read_b64_tr_b16 a[24:25], v12 offset:12288
    ds_read_b64_tr_b16 a[26:27], v12 offset:14336
    ds_read_b64_tr_b16 a[28:29], v13 offset:12288
    ds_read_b64_tr_b16 a[30:31], v13 offset:14336
    ds_read_b64_tr_b16 a[32:33], v10 offset:0
    ds_read_b64_tr_b16 a[34:35], v10 offset:2048
    ds_read_b64_tr_b16 a[36:37], v11 offset:0
    ds_read_b64_tr_b16 a[38:39], v11 offset:2048
    ds_read_b64_tr_b16 a[40:41], v12 offset:0
    ds_read_b64_tr_b16 a[42:43], v12 offset:2048
    ds_read_b64_tr_b16 a[44:45], v13 offset:0
    ds_read_b64_tr_b16 a[46:47], v13 offset:2048
    s_waitcnt vmcnt(16)
    ds_read_b64_tr_b16 a[48:49], v10 offset:4096
    ds_read_b64_tr_b16 a[50:51], v10 offset:6144
    ds_read_b64_tr_b16 a[52:53], v11 offset:4096
    ds_read_b64_tr_b16 a[54:55], v11 offset:6144
    ds_read_b64_tr_b16 a[56:57], v12 offset:4096
    ds_read_b64_tr_b16 a[58:59], v12 offset:6144
    ds_read_b64_tr_b16 a[60:61], v13 offset:4096
    ds_read_b64_tr_b16 a[62:63], v13 offset:6144
    s_waitcnt vmcnt(12)
    ds_read_b64_tr_b16 a[64:65], v10 offset:8192
    ds_read_b64_tr_b16 a[66:67], v10 offset:10240
    ds_read_b64_tr_b16 a[68:69], v11 offset:8192
    ds_read_b64_tr_b16 a[70:71], v11 offset:10240
    ds_read_b64_tr_b16 a[72:73], v12 offset:8192
    ds_read_b64_tr_b16 a[74:75], v12 offset:10240
    ds_read_b64_tr_b16 a[76:77], v13 offset:8192
    ds_read_b64_tr_b16 a[78:79], v13 offset:10240
    s_waitcnt vmcnt(11)
    v_mfma_f32_16x16x32_bf16 v[128:131], a[160:163], v[192:195], 0
    v_mfma_f32_16x16x32_bf16 v[144:147], a[164:167], v[192:195], 0
    buffer_load_dwordx4 v[240:243], v14, s[24:27], s94 offen offset:1024 sc1
    v_mfma_f32_16x16x32_bf16 v[160:163], a[168:171], v[192:195], 0
    v_mfma_f32_16x16x32_bf16 v[176:179], a[172:175], v[192:195], 0
    s_waitcnt vmcnt(11)
    v_mfma_f32_16x16x32_bf16 v[128:131], a[176:179], v[196:199], v[128:131]
    buffer_load_dwordx4 v[244:247], v14, s[24:27], s94 offen offset:2048 sc1
    v_mfma_f32_16x16x32_bf16 v[144:147], a[180:183], v[196:199], v[144:147]
    v_mfma_f32_16x16x32_bf16 v[160:163], a[184:187], v[196:199], v[160:163]
    v_mfma_f32_16x16x32_bf16 v[176:179], a[188:191], v[196:199], v[176:179]
    s_waitcnt vmcnt(11)
    v_mfma_f32_16x16x32_bf16 v[128:131], a[0:3], v[200:203], v[128:131]
    s_add_u32 s94, s80, 131072
    buffer_load_dwordx4 v[248:251], v14, s[24:27], s94 offen offset:0 sc1
    v_mfma_f32_16x16x32_bf16 v[144:147], a[4:7], v[200:203], v[144:147]
    v_mfma_f32_16x16x32_bf16 v[160:163], a[8:11], v[200:203], v[160:163]
    v_mfma_f32_16x16x32_bf16 v[176:179], a[12:15], v[200:203], v[176:179]
    s_waitcnt vmcnt(11)
    s_waitcnt lgkmcnt(14)
    v_mfma_f32_16x16x32_bf16 v[128:131], a[16:19], v[204:207], v[128:131]
    buffer_load_dwordx4 v[252:255], v14, s[24:27], s94 offen offset:1024 sc1
    v_mfma_f32_16x16x32_bf16 v[144:147], a[20:23], v[204:207], v[144:147]
    v_mfma_f32_16x16x32_bf16 v[160:163], a[24:27], v[204:207], v[160:163]
    v_mfma_f32_16x16x32_bf16 v[176:179], a[28:31], v[204:207], v[176:179]
    s_waitcnt vmcnt(11)
    v_mfma_f32_16x16x32_bf16 v[128:131], a[32:35], v[208:211], v[128:131]
    buffer_load_dwordx4 v[192:195], v14, s[24:27], s94 offen offset:2048 sc1
    v_mfma_f32_16x16x32_bf16 v[144:147], a[36:39], v[208:211], v[144:147]
    v_mfma_f32_16x16x32_bf16 v[160:163], a[40:43], v[208:211], v[160:163]
    v_mfma_f32_16x16x32_bf16 v[176:179], a[44:47], v[208:211], v[176:179]
    s_waitcnt vmcnt(11)
    v_mfma_f32_16x16x32_bf16 v[128:131], a[48:51], v[212:215], v[128:131]
    buffer_load_dwordx4 v[196:199], v14, s[24:27], s94 offen offset:3072 sc1
    s_waitcnt lgkmcnt(12)
    v_mfma_f32_16x16x32_bf16 v[144:147], a[52:55], v[212:215], v[144:147]
    s_waitcnt lgkmcnt(10)
    v_mfma_f32_16x16x32_bf16 v[160:163], a[56:59], v[212:215], v[160:163]
    s_waitcnt lgkmcnt(8)
    v_mfma_f32_16x16x32_bf16 v[176:179], a[60:63], v[212:215], v[176:179]
    s_waitcnt vmcnt(11)
    s_waitcnt lgkmcnt(4)
    v_mfma_f32_16x16x32_bf16 v[144:147], a[68:71], v[216:219], v[144:147]
    s_add_u32 s94, s80, 135168
    buffer_load_dwordx4 v[200:203], v14, s[24:27], s94 offen offset:0 sc1
    s_waitcnt lgkmcnt(2)
    v_mfma_f32_16x16x32_bf16 v[160:163], a[72:75], v[216:219], v[160:163]
    s_waitcnt lgkmcnt(0)
    v_mfma_f32_16x16x32_bf16 v[176:179], a[76:79], v[216:219], v[176:179]
    v_mfma_f32_16x16x32_bf16 v[128:131], a[64:67], v[216:219], v[128:131]
    s_waitcnt vmcnt(11)
    v_mfma_f32_16x16x32_bf16 v[132:135], a[160:163], v[220:223], 0
    buffer_load_dwordx4 v[204:207], v14, s[24:27], s94 offen offset:1024 sc1
    v_mfma_f32_16x16x32_bf16 v[148:151], a[164:167], v[220:223], 0
    v_mfma_f32_16x16x32_bf16 v[164:167], a[168:171], v[220:223], 0
    ds_write_b128 v33, v[144:147] offset:53248
    v_mfma_f32_16x16x32_bf16 v[180:183], a[172:175], v[220:223], 0
    s_waitcnt vmcnt(11)
    v_mfma_f32_16x16x32_bf16 v[132:135], a[176:179], v[224:227], v[132:135]
    buffer_load_dwordx4 v[208:211], v14, s[24:27], s94 offen offset:2048 sc1
    v_mfma_f32_16x16x32_bf16 v[148:151], a[180:183], v[224:227], v[148:151]
    v_mfma_f32_16x16x32_bf16 v[164:167], a[184:187], v[224:227], v[164:167]
    v_mfma_f32_16x16x32_bf16 v[180:183], a[188:191], v[224:227], v[180:183]
    s_waitcnt vmcnt(11)
    ds_write_b128 v34, v[160:163] offset:53248
    v_mfma_f32_16x16x32_bf16 v[132:135], a[0:3], v[228:231], v[132:135]
    s_add_u32 s94, s80, 196608
    buffer_load_dwordx4 v[212:215], v14, s[24:27], s94 offen offset:0 sc1
    v_mfma_f32_16x16x32_bf16 v[148:151], a[4:7], v[228:231], v[148:151]
    v_mfma_f32_16x16x32_bf16 v[164:167], a[8:11], v[228:231], v[164:167]
    v_mfma_f32_16x16x32_bf16 v[180:183], a[12:15], v[228:231], v[180:183]
    s_waitcnt vmcnt(11)
    v_mfma_f32_16x16x32_bf16 v[132:135], a[16:19], v[232:235], v[132:135]
    buffer_load_dwordx4 v[216:219], v14, s[24:27], s94 offen offset:1024 sc1
    v_mfma_f32_16x16x32_bf16 v[148:151], a[20:23], v[232:235], v[148:151]
    ds_write_b128 v35, v[176:179] offset:53248
    v_mfma_f32_16x16x32_bf16 v[164:167], a[24:27], v[232:235], v[164:167]
    s_barrier
    v_mfma_f32_16x16x32_bf16 v[180:183], a[28:31], v[232:235], v[180:183]
    s_waitcnt vmcnt(11)
    v_mfma_f32_16x16x32_bf16 v[132:135], a[32:35], v[236:239], v[132:135]
    buffer_load_dwordx4 v[220:223], v14, s[24:27], s94 offen offset:2048 sc1
    v_mfma_f32_16x16x32_bf16 v[148:151], a[36:39], v[236:239], v[148:151]
    v_mfma_f32_16x16x32_bf16 v[164:167], a[40:43], v[236:239], v[164:167]
    v_mfma_f32_16x16x32_bf16 v[180:183], a[44:47], v[236:239], v[180:183]
    s_waitcnt vmcnt(11)
    v_mfma_f32_16x16x32_bf16 v[132:135], a[48:51], v[240:243], v[132:135]
    buffer_load_dwordx4 v[224:227], v14, s[24:27], s94 offen offset:3072 sc1
    buffer_load_dword v16, v17, s[24:27], s82 offen sc1
    v_mfma_f32_16x16x32_bf16 v[148:151], a[52:55], v[240:243], v[148:151]
    v_mfma_f32_16x16x32_bf16 v[164:167], a[56:59], v[240:243], v[164:167]
    v_mfma_f32_16x16x32_bf16 v[180:183], a[60:63], v[240:243], v[180:183]
    s_waitcnt vmcnt(12)
    v_mfma_f32_16x16x32_bf16 v[148:151], a[68:71], v[244:247], v[148:151]
    s_add_u32 s94, s80, 200704
    buffer_load_dwordx4 v[228:231], v14, s[24:27], s94 offen offset:0 sc1
    v_mfma_f32_16x16x32_bf16 v[164:167], a[72:75], v[244:247], v[164:167]
    v_mfma_f32_16x16x32_bf16 v[180:183], a[76:79], v[244:247], v[180:183]
    v_mfma_f32_16x16x32_bf16 v[132:135], a[64:67], v[244:247], v[132:135]
    s_waitcnt vmcnt(12)
    v_mfma_f32_16x16x32_bf16 v[136:139], a[160:163], v[248:251], 0
    buffer_load_dwordx4 v[232:235], v14, s[24:27], s94 offen offset:1024 sc1
    v_mfma_f32_16x16x32_bf16 v[152:155], a[164:167], v[248:251], 0
    v_mfma_f32_16x16x32_bf16 v[168:171], a[168:171], v[248:251], 0
    ds_write_b128 v33, v[148:151] offset:0
    v_mfma_f32_16x16x32_bf16 v[184:187], a[172:175], v[248:251], 0
    s_waitcnt vmcnt(12)
    v_mfma_f32_16x16x32_bf16 v[136:139], a[176:179], v[252:255], v[136:139]
    buffer_load_dwordx4 v[236:239], v14, s[24:27], s94 offen offset:2048 sc1
    ds_write_b128 v34, v[164:167] offset:0
    v_mfma_f32_16x16x32_bf16 v[152:155], a[180:183], v[252:255], v[152:155]
    v_mfma_f32_16x16x32_bf16 v[168:171], a[184:187], v[252:255], v[168:171]
    ds_write_b128 v35, v[180:183] offset:0
    v_mfma_f32_16x16x32_bf16 v[184:187], a[188:191], v[252:255], v[184:187]
    s_waitcnt vmcnt(12)
    v_mfma_f32_16x16x32_bf16 v[136:139], a[0:3], v[192:195], v[136:139]
    s_add_u32 s94, s83, 0
    buffer_load_dwordx4 v[240:243], v14, s[24:27], s94 offen offset:0 sc1
    v_mfma_f32_16x16x32_bf16 v[152:155], a[4:7], v[192:195], v[152:155]
    v_mfma_f32_16x16x32_bf16 v[168:171], a[8:11], v[192:195], v[168:171]
    s_waitcnt lgkmcnt(0)
    s_barrier
    v_mfma_f32_16x16x32_bf16 v[184:187], a[12:15], v[192:195], v[184:187]
    s_waitcnt vmcnt(12)
    ds_read_b128 v[144:147], v32 offset:53248
    v_mfma_f32_16x16x32_bf16 v[136:139], a[16:19], v[196:199], v[136:139]
    buffer_load_dwordx4 v[244:247], v14, s[24:27], s94 offen offset:1024 sc1
    ds_read_b128 v[160:163], v32 offset:54272
    v_mfma_f32_16x16x32_bf16 v[152:155], a[20:23], v[196:199], v[152:155]
    ds_read_b128 v[176:179], v32 offset:55296
    v_mfma_f32_16x16x32_bf16 v[168:171], a[24:27], v[196:199], v[168:171]
    ds_read_b128 v[148:151], v32 offset:0
    v_mfma_f32_16x16x32_bf16 v[184:187], a[28:31], v[196:199], v[184:187]
    s_waitcnt vmcnt(12)
    ds_read_b128 v[164:167], v32 offset:1024
    v_mfma_f32_16x16x32_bf16 v[136:139], a[32:35], v[200:203], v[136:139]
    buffer_load_dwordx4 v[248:251], v14, s[24:27], s94 offen offset:2048 sc1
    ds_read_b128 v[180:183], v32 offset:2048
    v_mfma_f32_16x16x32_bf16 v[152:155], a[36:39], v[200:203], v[152:155]
    v_mfma_f32_16x16x32_bf16 v[168:171], a[40:43], v[200:203], v[168:171]
    s_waitcnt lgkmcnt(3)
    v_add_f32 v128, v128, v144
    v_mfma_f32_16x16x32_bf16 v[184:187], a[44:47], v[200:203], v[184:187]
    s_waitcnt vmcnt(12)
    v_add_f32 v129, v129, v145
    v_mfma_f32_16x16x32_bf16 v[136:139], a[48:51], v[204:207], v[136:139]
    buffer_load_dwordx4 v[252:255], v14, s[24:27], s94 offen offset:3072 sc1
    v_add_f32 v130, v130, v146
    v_mfma_f32_16x16x32_bf16 v[152:155], a[52:55], v[204:207], v[152:155]
    v_add_f32 v131, v131, v147
    v_add_f32 v160, v160, v176
    v_mfma_f32_16x16x32_bf16 v[168:171], a[56:59], v[204:207], v[168:171]
    v_add_f32 v161, v161, v177
    v_add_f32 v162, v162, v178
    v_mfma_f32_16x16x32_bf16 v[184:187], a[60:63], v[204:207], v[184:187]
    s_waitcnt vmcnt(12)
    v_add_f32 v163, v163, v179
    v_mfma_f32_16x16x32_bf16 v[152:155], a[68:71], v[208:211], v[152:155]
    s_add_u32 s94, s83, 4096
    buffer_load_dwordx4 v[192:195], v14, s[24:27], s94 offen offset:0 sc1
    v_mfma_f32_16x16x32_bf16 v[168:171], a[72:75], v[208:211], v[168:171]
    v_add_f32 v128, v128, v160
    v_add_f32 v129, v129, v161
    v_mfma_f32_16x16x32_bf16 v[184:187], a[76:79], v[208:211], v[184:187]
    v_add_f32 v130, v130, v162
    v_add_f32 v131, v131, v163
    v_mfma_f32_16x16x32_bf16 v[136:139], a[64:67], v[208:211], v[136:139]
    s_waitcnt vmcnt(12)
    v_cvt_pk_bf16_f32 v24, v128, v129
    v_mfma_f32_16x16x32_bf16 v[140:143], a[160:163], v[212:215], 0
    buffer_load_dwordx4 v[196:199], v14, s[24:27], s94 offen offset:1024 sc1
    v_cvt_pk_bf16_f32 v25, v130, v131
    v_mfma_f32_16x16x32_bf16 v[156:159], a[164:167], v[212:215], 0
    s_waitcnt lgkmcnt(0)
    v_add_f32 v132, v132, v148
    v_mfma_f32_16x16x32_bf16 v[172:175], a[168:171], v[212:215], 0
    v_add_f32 v133, v133, v149
    v_add_f32 v134, v134, v150
    v_mfma_f32_16x16x32_bf16 v[188:191], a[172:175], v[212:215], 0
    s_waitcnt vmcnt(12)
    v_add_f32 v135, v135, v151
    v_mfma_f32_16x16x32_bf16 v[140:143], a[176:179], v[216:219], v[140:143]
    buffer_load_dwordx4 v[200:203], v14, s[24:27], s94 offen offset:2048 sc1
    v_add_f32 v164, v164, v180
    v_mfma_f32_16x16x32_bf16 v[156:159], a[180:183], v[216:219], v[156:159]
    v_add_f32 v165, v165, v181
    v_add_f32 v166, v166, v182
    v_mfma_f32_16x16x32_bf16 v[172:175], a[184:187], v[216:219], v[172:175]
    v_add_f32 v167, v167, v183
    v_add_f32 v132, v132, v164
    v_mfma_f32_16x16x32_bf16 v[188:191], a[188:191], v[216:219], v[188:191]
    s_waitcnt vmcnt(12)
    v_add_f32 v133, v133, v165
    v_mfma_f32_16x16x32_bf16 v[140:143], a[0:3], v[220:223], v[140:143]
    s_waitcnt vmcnt(10)
    v_cmp_ne_u32 vcc, 1, v16
    s_cbranch_vccz Lok_13
    s_mov_b32 s3, 0
Lspin_14:
    buffer_load_dword v16, v17, s[24:27], s82 offen sc1
    s_waitcnt vmcnt(0)
    v_cmp_ne_u32 vcc, 1, v16
    s_add_u32 s3, s3, 1
    s_cmp_lt_u32 s3, 300000
    s_cbranch_vccz Lok_13
    s_cbranch_scc1 Lspin_14
Lok_13:
    v_mfma_f32_16x16x32_bf16 v[156:159], a[4:7], v[220:223], v[156:159]
    s_xor_b32 s82, s81, 4096
    s_add_u32 m0, s89, 0
    v_mfma_f32_16x16x32_bf16 v[172:175], a[8:11], v[220:223], v[172:175]
    v_add_f32 v134, v134, v166
    v_add_f32 v135, v135, v167
    v_mfma_f32_16x16x32_bf16 v[188:191], a[12:15], v[220:223], v[188:191]
    buffer_load_dwordx4 v14, s[24:27], s88 offen offset:0 sc1 lds
    v_mfma_f32_16x16x32_bf16 v[140:143], a[16:19], v[224:227], v[140:143]
    v_cvt_pk_bf16_f32 v26, v132, v133
    v_cvt_pk_bf16_f32 v27, v134, v135
    v_mfma_f32_16x16x32_bf16 v[156:159], a[20:23], v[224:227], v[156:159]
    buffer_load_dwordx4 v14, s[24:27], s88 offen offset:1024 sc1 lds
    buffer_store_dwordx4 v[24:27], v14, s[24:27], s79 offen offset:0 sc1
    v_mfma_f32_16x16x32_bf16 v[172:175], a[24:27], v[224:227], v[172:175]
    ds_write_b128 v33, v[152:155] offset:12288
    v_mfma_f32_16x16x32_bf16 v[188:191], a[28:31], v[224:227], v[188:191]
    s_waitcnt vmcnt(12)
    buffer_load_dwordx4 v14, s[24:27], s88 offen offset:2048 sc1 lds
    v_mfma_f32_16x16x32_bf16 v[140:143], a[32:35], v[228:231], v[140:143]
    ds_write_b128 v34, v[168:171] offset:12288
    v_mfma_f32_16x16x32_bf16 v[156:159], a[36:39], v[228:231], v[156:159]
    buffer_load_dwordx4 v14, s[24:27], s88 offen offset:3072 sc1 lds
    ds_write_b128 v35, v[184:187] offset:12288
    v_mfma_f32_16x16x32_bf16 v[172:175], a[40:43], v[228:231], v[172:175]
    v_mov_b32 v17, 0
    s_add_u32 s94, s83, 65536
    v_mfma_f32_16x16x32_bf16 v[188:191], a[44:47], v[228:231], v[188:191]
    s_waitcnt vmcnt(13)
    buffer_load_dwordx4 v[204:207], v14, s[24:27], s94 offen offset:0 sc1
    v_mfma_f32_16x16x32_bf16 v[140:143], a[48:51], v[232:235], v[140:143]
    buffer_load_dwordx4 v[208:211], v14, s[24:27], s94 offen offset:1024 sc1
    v_mfma_f32_16x16x32_bf16 v[156:159], a[52:55], v[232:235], v[156:159]
    buffer_load_dwordx4 v[212:215], v14, s[24:27], s94 offen offset:2048 sc1
    v_mfma_f32_16x16x32_bf16 v[172:175], a[56:59], v[232:235], v[172:175]
    v_mfma_f32_16x16x32_bf16 v[188:191], a[60:63], v[232:235], v[188:191]
    s_waitcnt vmcnt(15)
    v_mfma_f32_16x16x32_bf16 v[156:159], a[68:71], v[236:239], v[156:159]
    buffer_load_dwordx4 v[216:219], v14, s[24:27], s94 offen offset:3072 sc1
    v_mfma_f32_16x16x32_bf16 v[172:175], a[72:75], v[236:239], v[172:175]
    v_mfma_f32_16x16x32_bf16 v[188:191], a[76:79], v[236:239], v[188:191]
    v_mfma_f32_16x16x32_bf16 v[140:143], a[64:67], v[236:239], v[140:143]
    s_waitcnt vmcnt(15)
    v_mfma_f32_16x16x32_bf16 v[128:131], a[160:163], v[240:243], 0
    s_add_u32 m0, s89, 4096
    v_mfma_f32_16x16x32_bf16 v[144:147], a[164:167], v[240:243], 0
    s_add_u32 s88, s88, 4096
    v_mfma_f32_16x16x32_bf16 v[160:163], a[168:171], v[240:243], 0
    ds_write_b128 v33, v[156:159] offset:24576
    v_mfma_f32_16x16x32_bf16 v[176:179], a[172:175], v[240:243], 0
    s_waitcnt vmcnt(14)
    buffer_load_dwordx4 v14, s[24:27], s88 offen offset:0 sc1 lds
    v_mfma_f32_16x16x32_bf16 v[128:131], a[176:179], v[244:247], v[128:131]
    ds_write_b128 v34, v[172:175] offset:24576
    v_mfma_f32_16x16x32_bf16 v[144:147], a[180:183], v[244:247], v[144:147]
    buffer_load_dwordx4 v14, s[24:27], s88 offen offset:1024 sc1 lds
    v_mfma_f32_16x16x32_bf16 v[160:163], a[184:187], v[244:247], v[160:163]
    buffer_load_dwordx4 v14, s[24:27], s88 offen offset:2048 sc1 lds
    ds_write_b128 v35, v[188:191] offset:24576
    v_mfma_f32_16x16x32_bf16 v[176:179], a[188:191], v[244:247], v[176:179]
    s_waitcnt vmcnt(16)
    v_mfma_f32_16x16x32_bf16 v[128:131], a[0:3], v[248:251], v[128:131]
    buffer_load_dwordx4 v14, s[24:27], s88 offen offset:3072 sc1 lds
    v_mfma_f32_16x16x32_bf16 v[144:147], a[4:7], v[248:251], v[144:147]
    s_add_u32 s94, s83, 69632
    buffer_load_dwordx4 v[220:223], v14, s[24:27], s94 offen offset:0 sc1
    v_mfma_f32_16x16x32_bf16 v[160:163], a[8:11], v[248:251], v[160:163]
    s_waitcnt lgkmcnt(0)
    s_barrier
    v_mfma_f32_16x16x32_bf16 v[176:179], a[12:15], v[248:251], v[176:179]
    s_waitcnt vmcnt(17)
    ds_read_b128 v[152:155], v32 offset:12288
    v_mfma_f32_16x16x32_bf16 v[128:131], a[16:19], v[252:255], v[128:131]
    ds_read_b128 v[168:171], v32 offset:13312
    v_mfma_f32_16x16x32_bf16 v[144:147], a[20:23], v[252:255], v[144:147]
    ds_read_b128 v[184:187], v32 offset:14336
    v_mfma_f32_16x16x32_bf16 v[160:163], a[24:27], v[252:255], v[160:163]
    ds_read_b128 v[156:159], v32 offset:24576
    v_mfma_f32_16x16x32_bf16 v[176:179], a[28:31], v[252:255], v[176:179]
    s_waitcnt vmcnt(16)
    ds_read_b128 v[172:175], v32 offset:25600
    v_mfma_f32_16x16x32_bf16 v[128:131], a[32:35], v[192:195], v[128:131]
    ds_read_b128 v[188:191], v32 offset:26624
    v_mfma_f32_16x16x32_bf16 v[144:147], a[36:39], v[192:195], v[144:147]
    v_mfma_f32_16x16x32_bf16 v[160:163], a[40:43], v[192:195], v[160:163]
    s_waitcnt lgkmcnt(3)
    v_add_f32 v136, v136, v152
    v_mfma_f32_16x16x32_bf16 v[176:179], a[44:47], v[192:195], v[176:179]
    s_waitcnt vmcnt(15)
    v_add_f32 v137, v137, v153
    v_mfma_f32_16x16x32_bf16 v[128:131], a[48:51], v[196:199], v[128:131]
    buffer_load_dwordx4 v[224:227], v14, s[24:27], s94 offen offset:1024 sc1
    v_add_f32 v138, v138, v154
    v_mfma_f32_16x16x32_bf16 v[144:147], a[52:55], v[196:199], v[144:147]
    v_add_f32 v139, v139, v155
    v_add_f32 v168, v168, v184
    v_mfma_f32_16x16x32_bf16 v[160:163], a[56:59], v[196:199], v[160:163]
    v_add_f32 v169, v169, v185
    v_add_f32 v170, v170, v186
    v_mfma_f32_16x16x32_bf16 v[176:179], a[60:63], v[196:199], v[176:179]
    s_waitcnt vmcnt(15)
    v_add_f32 v171, v171, v187
    v_mfma_f32_16x16x32_bf16 v[144:147], a[68:71], v[200:203], v[144:147]
    s_add_u32 m0, s89, 8192
    v_add_f32 v136, v136, v168
    v_mfma_f32_16x16x32_bf16 v[160:163], a[72:75], v[200:203], v[160:163]
    s_add_u32 s88, s88, 4096
    v_add_f32 v137, v137, v169
    v_mfma_f32_16x16x32_bf16 v[176:179], a[76:79], v[200:203], v[176:179]
    v_add_f32 v138, v138, v170
    v_add_f32 v139, v139, v171
    v_cvt_pk_bf16_f32 v28, v136, v137
    v_cvt_pk_bf16_f32 v29, v138, v139
    v_mfma_f32_16x16x32_bf16 v[128:131], a[64:67], v[200:203], v[128:131]
    s_waitcnt vmcnt(9)
    buffer_load_dwordx4 v14, s[24:27], s88 offen offset:0 sc1 lds
    v_mfma_f32_16x16x32_bf16 v[132:135], a[160:163], v[204:207], 0
    s_barrier
    s_waitcnt lgkmcnt(0)
    v_mfma_f32_16x16x32_bf16 v[148:151], a[164:167], v[204:207], 0
    ds_read_b128 a[80:83], v5 offset:0
    buffer_load_dwordx4 v14, s[24:27], s88 offen offset:1024 sc1 lds
    v_add_f32 v140, v140, v156
    v_add_f32 v141, v141, v157
    v_add_f32 v142, v142, v158
    v_add_f32 v143, v143, v159
    v_add_f32 v172, v172, v188
    v_add_f32 v173, v173, v189
    v_mfma_f32_16x16x32_bf16 v[164:167], a[168:171], v[204:207], 0
    ds_read_b128 a[84:87], v5 offset:16384
    buffer_load_dwordx4 v14, s[24:27], s88 offen offset:2048 sc1 lds
    v_mfma_f32_16x16x32_bf16 v[180:183], a[172:175], v[204:207], 0
    s_waitcnt vmcnt(11)
    ds_read_b128 a[88:91], v5 offset:32768
    v_mfma_f32_16x16x32_bf16 v[132:135], a[176:179], v[208:211], v[132:135]
    ds_read_b128 a[92:95], v5 offset:49152
    buffer_load_dwordx4 v14, s[24:27], s88 offen offset:3072 sc1 lds
    v_mfma_f32_16x16x32_bf16 v[148:151], a[180:183], v[208:211], v[148:151]
    ds_read_b128 a[96:99], v5 offset:1024
    buffer_load_dwordx4 v[228:231], v14, s[24:27], s94 offen offset:2048 sc1
    v_mfma_f32_16x16x32_bf16 v[164:167], a[184:187], v[208:211], v[164:167]
    ds_read_b128 a[100:103], v5 offset:17408
    v_add_f32 v174, v174, v190
    v_add_f32 v175, v175, v191
    v_add_f32 v140, v140, v172
    v_add_f32 v141, v141, v173
    v_mfma_f32_16x16x32_bf16 v[180:183], a[188:191], v[208:211], v[180:183]
    s_waitcnt vmcnt(12)
    ds_read_b128 a[104:107], v5 offset:33792
    v_mfma_f32_16x16x32_bf16 v[132:135], a[0:3], v[212:215], v[132:135]
    ds_read_b128 a[108:111], v5 offset:50176
    v_add_f32 v142, v142, v174
    v_add_f32 v143, v143, v175
    v_mfma_f32_16x16x32_bf16 v[148:151], a[4:7], v[212:215], v[148:151]
    ds_read_b128 a[112:115], v5 offset:2048
    v_cvt_pk_bf16_f32 v30, v140, v141
    v_mfma_f32_16x16x32_bf16 v[164:167], a[8:11], v[212:215], v[164:167]
    s_waitcnt lgkmcnt(7)
    ds_read_b128 a[116:119], v5 offset:18432
    v_mfma_f32_16x16x32_bf16 v[48:51], a[80:83], v[64:67], 0
    ds_read_b128 a[120:123], v5 offset:34816
    v_cvt_pk_bf16_f32 v31, v142, v143
    buffer_store_dwordx4 v[28:31], v14, s[24:27], s79 offen offset:1024 sc1
    v_mfma_f32_16x16x32_bf16 v[52:55], a[84:87], v[64:67], 0
    ds_read_b128 a[124:127], v5 offset:51200
    buffer_load_dwordx4 v[20:23], v8, s[24:27], s86 offen sc1
    v_mfma_f32_16x16x32_bf16 v[180:183], a[12:15], v[212:215], v[180:183]
    s_waitcnt lgkmcnt(8)
    ds_write_b128 v33, v[144:147] offset:53248
    ds_write_b128 v34, v[160:163] offset:53248
    ds_write_b128 v35, v[176:179] offset:53248
    v_mfma_f32_16x16x32_bf16 v[56:59], a[88:91], v[64:67], 0
    ds_read_b128 a[128:131], v5 offset:3072
    v_mfma_f32_16x16x32_bf16 v[60:63], a[92:95], v[64:67], 0
    s_waitcnt vmcnt(13)
    ds_read_b128 a[132:135], v5 offset:19456
    v_mfma_f32_16x16x32_bf16 v[132:135], a[16:19], v[216:219], v[132:135]
    s_waitcnt lgkmcnt(11)
    s_add_u32 s94, s83, 131072
    v_mfma_f32_16x16x32_bf16 v[48:51], a[96:99], v[68:71], v[48:51]
    ds_read_b128 a[136:139], v5 offset:35840
    buffer_load_dwordx4 v[232:235], v14, s[24:27], s94 offen offset:0 sc1
    v_mfma_f32_16x16x32_bf16 v[52:55], a[100:103], v[68:71], v[52:55]
    ds_read_b128 a[140:143], v5 offset:52224
    v_mfma_f32_16x16x32_bf16 v[148:151], a[20:23], v[216:219], v[148:151]
    s_waitcnt lgkmcnt(11)
    s_waitcnt vmcnt(10)
    s_barrier
    v_mfma_f32_16x16x32_bf16 v[56:59], a[104:107], v[68:71], v[56:59]
    ds_read_b128 a[80:83], v5 offset:4096
    s_add_u32 m0, s89, 12288
    v_mfma_f32_16x16x32_bf16 v[60:63], a[108:111], v[68:71], v[60:63]
    ds_read_b128 a[84:87], v5 offset:20480
    s_add_u32 s88, s88, 4096
    v_mfma_f32_16x16x32_bf16 v[164:167], a[24:27], v[216:219], v[164:167]
    s_waitcnt lgkmcnt(11)
    v_mfma_f32_16x16x32_bf16 v[48:51], a[112:115], v[72:75], v[48:51]
    ds_read_b128 a[88:91], v5 offset:36864
    buffer_load_dwordx4 v14, s[24:27], s88 offen offset:0 sc1 lds
    v_mfma_f32_16x16x32_bf16 v[52:55], a[116:119], v[72:75], v[52:55]
    ds_read_b128 a[92:95], v5 offset:53248
    v_mfma_f32_16x16x32_bf16 v[180:183], a[28:31], v[216:219], v[180:183]
    s_waitcnt lgkmcnt(11)
    buffer_load_dwordx4 v14, s[24:27], s88 offen offset:1024 sc1 lds
    v_mfma_f32_16x16x32_bf16 v[56:59], a[120:123], v[72:75], v[56:59]
    ds_read_b128 a[96:99], v5 offset:5120
    buffer_load_dwordx4 v14, s[24:27], s88 offen offset:2048 sc1 lds
    v_mfma_f32_16x16x32_bf16 v[60:63], a[124:127], v[72:75], v[60:63]
    s_waitcnt vmcnt(12)
    ds_read_b128 a[100:103], v5 offset:21504
    v_mfma_f32_16x16x32_bf16 v[132:135], a[32:35], v[220:223], v[132:135]
    s_waitcnt lgkmcnt(8)
    buffer_load_dwordx4 v14, s[24:27], s88 offen offset:3072 sc1 lds
    v_mfma_f32_16x16x32_bf16 v[48:51], a[128:131], v[76:79], v[48:51]
    ds_read_b128 a[104:107], v5 offset:37888
    buffer_load_dwordx4 v[236:239], v14, s[24:27], s94 offen offset:1024 sc1
    v_mfma_f32_16x16x32_bf16 v[52:55], a[132:135], v[76:79], v[52:55]
    ds_read_b128 a[108:111], v5 offset:54272
    v_mfma_f32_16x16x32_bf16 v[148:151], a[36:39], v[220:223], v[148:151]
    s_waitcnt lgkmcnt(8)
    v_mfma_f32_16x16x32_bf16 v[56:59], a[136:139], v[76:79], v[56:59]
    ds_read_b128 a[112:115], v5 offset:6144
    v_mfma_f32_16x16x32_bf16 v[60:63], a[140:143], v[76:79], v[60:63]
    ds_read_b128 a[116:119], v5 offset:22528
    v_mfma_f32_16x16x32_bf16 v[164:167], a[40:43], v[220:223], v[164:167]
    s_waitcnt lgkmcnt(8)
    v_mfma_f32_16x16x32_bf16 v[48:51], a[80:83], v[80:83], v[48:51]
    ds_read_b128 a[120:123], v5 offset:38912
    v_mfma_f32_16x16x32_bf16 v[52:55], a[84:87], v[80:83], v[52:55]
    ds_read_b128 a[124:127], v5 offset:55296
    v_mfma_f32_16x16x32_bf16 v[180:183], a[44:47], v[220:223], v[180:183]
    s_waitcnt lgkmcnt(8)
    v_mfma_f32_16x16x32_bf16 v[56:59], a[88:91], v[80:83], v[56:59]
    ds_read_b128 a[128:131], v5 offset:7168
    v_mfma_f32_16x16x32_bf16 v[60:63], a[92:95], v[80:83], v[60:63]
    s_waitcnt vmcnt(13)
    ds_read_b128 a[132:135], v5 offset:23552
    v_mfma_f32_16x16x32_bf16 v[132:135], a[48:51], v[224:227], v[132:135]
    s_waitcnt lgkmcnt(8)
    buffer_load_dwordx4 v[240:243], v14, s[24:27], s94 offen offset:2048 sc1
    v_mfma_f32_16x16x32_bf16 v[48:51], a[96:99], v[84:87], v[48:51]
    ds_read_b128 a[136:139], v5 offset:39936
    s_waitcnt vmcnt(8)
    s_barrier
    s_cmp_lg_u32 s4, 0
    s_cbranch_scc1 Lnop_15
    s_mov_b64 exec, 1
    buffer_store_dword v19, v0, s[24:27], s81 offen sc1
    s_mov_b64 exec, -1
Lnop_15:
    v_mfma_f32_16x16x32_bf16 v[52:55], a[100:103], v[84:87], v[52:55]
    ds_read_b128 a[140:143], v5 offset:56320
    v_mfma_f32_16x16x32_bf16 v[148:151], a[52:55], v[224:227], v[148:151]
    s_waitcnt lgkmcnt(8)
    s_barrier
    v_mfma_f32_16x16x32_bf16 v[56:59], a[104:107], v[84:87], v[56:59]
    ds_read_b128 a[80:83], v5 offset:8192
    v_mfma_f32_16x16x32_bf16 v[60:63], a[108:111], v[84:87], v[60:63]
    ds_read_b128 a[84:87], v5 offset:24576
    v_mfma_f32_16x16x32_bf16 v[164:167], a[56:59], v[224:227], v[164:167]
    s_waitcnt lgkmcnt(8)
    v_mfma_f32_16x16x32_bf16 v[48:51], a[112:115], v[88:91], v[48:51]
    ds_read_b128 a[88:91], v5 offset:40960
    v_mfma_f32_16x16x32_bf16 v[52:55], a[116:119], v[88:91], v[52:55]
    ds_read_b128 a[92:95], v5 offset:57344
    v_mfma_f32_16x16x32_bf16 v[180:183], a[60:63], v[224:227], v[180:183]
    s_waitcnt lgkmcnt(8)
    v_mfma_f32_16x16x32_bf16 v[56:59], a[120:123], v[88:91], v[56:59]
    ds_read_b128 a[96:99], v5 offset:9216
    v_mfma_f32_16x16x32_bf16 v[60:63], a[124:127], v[88:91], v[60:63]
    ds_read_b128 a[100:103], v5 offset:25600
    v_mfma_f32_16x16x32_bf16 v[148:151], a[68:71], v[228:231], v[148:151]
    s_waitcnt lgkmcnt(8)
    buffer_load_dwordx4 v[244:247], v14, s[24:27], s94 offen offset:3072 sc1
    v_mfma_f32_16x16x32_bf16 v[48:51], a[128:131], v[92:95], v[48:51]
    ds_read_b128 a[104:107], v5 offset:41984
    v_mfma_f32_16x16x32_bf16 v[52:55], a[132:135], v[92:95], v[52:55]
    ds_read_b128 a[108:111], v5 offset:58368
    v_mfma_f32_16x16x32_bf16 v[164:167], a[72:75], v[228:231], v[164:167]
    s_waitcnt lgkmcnt(8)
    v_mfma_f32_16x16x32_bf16 v[56:59], a[136:139], v[92:95], v[56:59]
    ds_read_b128 a[112:115], v5 offset:10240
    v_mfma_f32_16x16x32_bf16 v[60:63], a[140:143], v[92:95], v[60:63]
    ds_read_b128 a[116:119], v5 offset:26624
    v_mfma_f32_16x16x32_bf16 v[180:183], a[76:79], v[228:231], v[180:183]
    s_waitcnt lgkmcnt(8)
    v_mfma_f32_16x16x32_bf16 v[48:51], a[80:83], v[96:99], v[48:51]
    ds_read_b128 a[120:123], v5 offset:43008
    v_mfma_f32_16x16x32_bf16 v[52:55], a[84:87], v[96:99], v[52:55]
    ds_read_b128 a[124:127], v5 offset:59392
    s_add_u32 s94, s83, 135168
    v_mfma_f32_16x16x32_bf16 v[132:135], a[64:67], v[228:231], v[132:135]
    s_waitcnt lgkmcnt(8)
    buffer_load_dwordx4 v[248:251], v14, s[24:27], s94 offen offset:0 sc1
    v_mfma_f32_16x16x32_bf16 v[56:59], a[88:91], v[96:99], v[56:59]
    ds_read_b128 a[128:131], v5 offset:11264
    v_mfma_f32_16x16x32_bf16 v[60:63], a[92:95], v[96:99], v[60:63]
    s_waitcnt vmcnt(8)
    ds_read_b128 a[132:135], v5 offset:27648
    v_mfma_f32_16x16x32_bf16 v[136:139], a[160:163], v[232:235], 0
    s_waitcnt lgkmcnt(8)
    buffer_load_dwordx4 v[252:255], v14, s[24:27], s94 offen offset:1024 sc1
    ds_write_b128 v33, v[148:151] offset:0
    v_mfma_f32_16x16x32_bf16 v[48:51], a[96:99], v[100:103], v[48:51]
    ds_read_b128 a[136:139], v5 offset:44032
    v_mfma_f32_16x16x32_bf16 v[52:55], a[100:103], v[100:103], v[52:55]
    ds_read_b128 a[140:143], v5 offset:60416
    ds_write_b128 v34, v[164:167] offset:0
    v_mfma_f32_16x16x32_bf16 v[152:155], a[164:167], v[232:235], 0
    s_waitcnt lgkmcnt(10)
    s_waitcnt vmcnt(5)
    s_barrier
    v_mfma_f32_16x16x32_bf16 v[56:59], a[104:107], v[100:103], v[56:59]
    ds_read_b128 a[80:83], v5 offset:12288
    buffer_load_dwordx4 v[192:195], v14, s[24:27], s94 offen offset:2048 sc1
    ds_write_b128 v35, v[180:183] offset:0
    v_mfma_f32_16x16x32_bf16 v[60:63], a[108:111], v[100:103], v[60:63]
    ds_read_b128 a[84:87], v5 offset:28672
    v_mfma_f32_16x16x32_bf16 v[168:171], a[168:171], v[232:235], 0
    s_waitcnt lgkmcnt(11)
    v_mfma_f32_16x16x32_bf16 v[48:51], a[112:115], v[104:107], v[48:51]
    ds_read_b128 a[88:91], v5 offset:45056
    v_mfma_f32_16x16x32_bf16 v[52:55], a[116:119], v[104:107], v[52:55]
    ds_read_b128 a[92:95], v5 offset:61440
    s_waitcnt lgkmcnt(3)
    s_barrier
    v_mfma_f32_16x16x32_bf16 v[184:187], a[172:175], v[232:235], 0
    ds_read_b128 v[144:147], v32 offset:53248
    v_mfma_f32_16x16x32_bf16 v[56:59], a[120:123], v[104:107], v[56:59]
    ds_read_b128 a[96:99], v5 offset:13312
    v_mfma_f32_16x16x32_bf16 v[60:63], a[124:127], v[104:107], v[60:63]
    s_waitcnt vmcnt(5)
    ds_read_b128 a[100:103], v5 offset:29696
    v_mfma_f32_16x16x32_bf16 v[136:139], a[176:179], v[236:239], v[136:139]
    ds_read_b128 v[160:163], v32 offset:54272
    v_mfma_f32_16x16x32_bf16 v[48:51], a[128:131], v[108:111], v[48:51]
    ds_read_b128 a[104:107], v5 offset:46080
    v_mfma_f32_16x16x32_bf16 v[52:55], a[132:135], v[108:111], v[52:55]
    ds_read_b128 a[108:111], v5 offset:62464
    buffer_load_dword v16, v17, s[24:27], s82 offen sc1
    v_mfma_f32_16x16x32_bf16 v[152:155], a[180:183], v[236:239], v[152:155]
    ds_read_b128 v[176:179], v32 offset:55296
    ds_read_b128 v[148:151], v32 offset:0
    ds_read_b128 v[164:167], v32 offset:1024
    ds_read_b128 v[180:183], v32 offset:2048
    v_mfma_f32_16x16x32_bf16 v[56:59], a[136:139], v[108:111], v[56:59]
    ds_read_b128 a[112:115], v5 offset:14336
    s_add_u32 s94, s83, 196608
    v_mfma_f32_16x16x32_bf16 v[60:63], a[140:143], v[108:111], v[60:63]
    ds_read_b128 a[116:119], v5 offset:30720
    buffer_load_dwordx4 v[196:199], v14, s[24:27], s94 offen offset:0 sc1
    v_mfma_f32_16x16x32_bf16 v[168:171], a[184:187], v[236:239], v[168:171]
    s_waitcnt lgkmcnt(14)
    s_waitcnt lgkmcnt(5)
    v_mfma_f32_16x16x32_bf16 v[48:51], a[80:83], v[112:115], v[48:51]
    ds_read_b128 a[120:123], v5 offset:47104
    v_add_f32 v128, v128, v144
    v_mfma_f32_16x16x32_bf16 v[52:55], a[84:87], v[112:115], v[52:55]
    ds_read_b128 a[124:127], v5 offset:63488
    buffer_load_dwordx4 v[200:203], v14, s[24:27], s94 offen offset:1024 sc1
    v_mfma_f32_16x16x32_bf16 v[184:187], a[188:191], v[236:239], v[184:187]
    v_add_f32 v129, v129, v145
    v_mfma_f32_16x16x32_bf16 v[56:59], a[88:91], v[112:115], v[56:59]
    ds_read_b128 a[128:131], v5 offset:15360
    v_add_f32 v130, v130, v146
    v_add_f32 v131, v131, v147
    v_add_f32 v160, v160, v176
    v_add_f32 v161, v161, v177
    v_mfma_f32_16x16x32_bf16 v[60:63], a[92:95], v[112:115], v[60:63]
    s_waitcnt vmcnt(7)
    ds_read_b128 a[132:135], v5 offset:31744
    v_mfma_f32_16x16x32_bf16 v[136:139], a[0:3], v[240:243], v[136:139]
    buffer_load_dwordx4 v[204:207], v14, s[24:27], s94 offen offset:2048 sc1
    v_mfma_f32_16x16x32_bf16 v[48:51], a[96:99], v[116:119], v[48:51]
    ds_read_b128 a[136:139], v5 offset:48128
    v_add_f32 v162, v162, v178
    v_add_f32 v163, v163, v179
    v_mfma_f32_16x16x32_bf16 v[52:55], a[100:103], v[116:119], v[52:55]
    ds_read_b128 a[140:143], v5 offset:64512
    v_add_f32 v128, v128, v160
    v_add_f32 v129, v129, v161
    v_mfma_f32_16x16x32_bf16 v[152:155], a[4:7], v[240:243], v[152:155]
    v_add_f32 v130, v130, v162
    v_add_f32 v131, v131, v163
    v_mfma_f32_16x16x32_bf16 v[56:59], a[104:107], v[116:119], v[56:59]
    buffer_load_dwordx4 v[208:211], v14, s[24:27], s94 offen offset:3072 sc1
    s_waitcnt lgkmcnt(8)
    v_mfma_f32_16x16x32_bf16 v[60:63], a[108:111], v[116:119], v[60:63]
    v_add_f32 v132, v132, v148
    v_add_f32 v133, v133, v149
    v_mfma_f32_16x16x32_bf16 v[168:171], a[8:11], v[240:243], v[168:171]
    s_waitcnt lgkmcnt(6)
    v_add_f32 v134, v134, v150
    v_mfma_f32_16x16x32_bf16 v[48:51], a[112:115], v[120:123], v[48:51]
    v_add_f32 v135, v135, v151
    v_add_f32 v164, v164, v180
    v_mfma_f32_16x16x32_bf16 v[52:55], a[116:119], v[120:123], v[52:55]
    s_add_u32 s94, s83, 200704
    buffer_load_dwordx4 v[212:215], v14, s[24:27], s94 offen offset:0 sc1
    v_mfma_f32_16x16x32_bf16 v[184:187], a[12:15], v[240:243], v[184:187]
    s_waitcnt lgkmcnt(4)
    v_add_f32 v165, v165, v181
    v_mfma_f32_16x16x32_bf16 v[56:59], a[120:123], v[120:123], v[56:59]
    v_add_f32 v166, v166, v182
    v_add_f32 v167, v167, v183
    v_mfma_f32_16x16x32_bf16 v[60:63], a[124:127], v[120:123], v[60:63]
    s_waitcnt vmcnt(9)
    v_add_f32 v132, v132, v164
    v_add_f32 v133, v133, v165
    v_mfma_f32_16x16x32_bf16 v[136:139], a[16:19], v[244:247], v[136:139]
    s_waitcnt lgkmcnt(2)
    buffer_load_dwordx4 v[216:219], v14, s[24:27], s94 offen offset:1024 sc1
    v_mfma_f32_16x16x32_bf16 v[48:51], a[128:131], v[124:127], v[48:51]
    v_add_f32 v134, v134, v166
    v_add_f32 v135, v135, v167
    v_mfma_f32_16x16x32_bf16 v[52:55], a[132:135], v[124:127], v[52:55]
    s_waitcnt vmcnt(6)
    v_cmp_ne_u32 vcc, 1, v16
    s_cbranch_vccz Lok_16
    s_mov_b32 s3, 0
Lspin_17:
    buffer_load_dword v16, v17, s[24:27], s82 offen sc1
    s_waitcnt vmcnt(0)
    v_cmp_ne_u32 vcc, 1, v16
    s_add_u32 s3, s3, 1
    s_cmp_lt_u32 s3, 300000
    s_cbranch_vccz Lok_16
    s_cbranch_scc1 Lspin_17
Lok_16:
    v_mfma_f32_16x16x32_bf16 v[152:155], a[20:23], v[244:247], v[152:155]
    s_waitcnt lgkmcnt(0)
    buffer_load_dwordx4 v[24:27], v14, s[24:27], s78 offen offset:0 sc1
    v_mfma_f32_16x16x32_bf16 v[56:59], a[136:139], v[124:127], v[56:59]
    buffer_load_dwordx4 v[220:223], v14, s[24:27], s94 offen offset:2048 sc1
    buffer_load_dwordx4 v[28:31], v14, s[24:27], s78 offen offset:1024 sc1
    v_mfma_f32_16x16x32_bf16 v[60:63], a[140:143], v[124:127], v[60:63]
    v_mfma_f32_16x16x32_bf16 v[168:171], a[24:27], v[244:247], v[168:171]
    v_mfma_f32_16x16x32_bf16 v[184:187], a[28:31], v[244:247], v[184:187]
    v_mfma_f32_16x16x32_bf16 v[136:139], a[32:35], v[248:251], v[136:139]
    v_mfma_f32_16x16x32_bf16 v[152:155], a[36:39], v[248:251], v[152:155]
    v_cvt_pk_bf16_f32 v36, v48, v49
    v_cvt_pk_bf16_f32 v37, v50, v51
    v_mfma_f32_16x16x32_bf16 v[168:171], a[40:43], v[248:251], v[168:171]
    v_cvt_pk_bf16_f32 v38, v52, v53
    v_cvt_pk_bf16_f32 v39, v54, v55
    v_mfma_f32_16x16x32_bf16 v[184:187], a[44:47], v[248:251], v[184:187]
    v_cvt_pk_bf16_f32 v40, v56, v57
    v_mfma_f32_16x16x32_bf16 v[136:139], a[48:51], v[252:255], v[136:139]
    v_cvt_pk_bf16_f32 v41, v58, v59
    v_cvt_pk_bf16_f32 v42, v60, v61
    v_mfma_f32_16x16x32_bf16 v[152:155], a[52:55], v[252:255], v[152:155]
    v_cvt_pk_bf16_f32 v43, v62, v63
    v_mfma_f32_16x16x32_bf16 v[168:171], a[56:59], v[252:255], v[168:171]
    v_mfma_f32_16x16x32_bf16 v[184:187], a[60:63], v[252:255], v[184:187]
    v_mfma_f32_16x16x32_bf16 v[152:155], a[68:71], v[192:195], v[152:155]
    v_mfma_f32_16x16x32_bf16 v[64:67], v[36:39], a[224:227], 0
    v_mul_f32 v80, 0x36000000, v20
    v_mul_f32 v81, 0x36000000, v21
    v_mfma_f32_16x16x32_bf16 v[68:71], v[36:39], a[232:235], 0
    v_mul_f32 v82, 0x36000000, v22
    v_mul_f32 v83, 0x36000000, v23
    v_mfma_f32_16x16x32_bf16 v[72:75], v[36:39], a[240:243], 0
    v_sub_f32 v20, 1.0, v20
    v_sub_f32 v21, 1.0, v21
    v_mfma_f32_16x16x32_bf16 v[76:79], v[36:39], a[248:251], 0
    v_sub_f32 v22, 1.0, v22
    v_sub_f32 v23, 1.0, v23
    v_mfma_f32_16x16x32_bf16 v[64:67], v[40:43], a[228:231], v[64:67]
    v_mfma_f32_16x16x32_bf16 v[68:71], v[40:43], a[236:239], v[68:71]
    v_mfma_f32_16x16x32_bf16 v[72:75], v[40:43], a[244:247], v[72:75]
    v_mfma_f32_16x16x32_bf16 v[76:79], v[40:43], a[252:255], v[76:79]
    v_mfma_f32_16x16x32_bf16 v[168:171], a[72:75], v[192:195], v[168:171]
    v_mfma_f32_16x16x32_bf16 v[184:187], a[76:79], v[192:195], v[184:187]
    s_nop 2
    v_mul_f32 v64, v80, v64
    v_mul_f32 v65, v80, v65
    v_mfma_f32_16x16x32_bf16 v[136:139], a[64:67], v[192:195], v[136:139]
    s_waitcnt vmcnt(8)
    v_mul_f32 v66, v80, v66
    v_mfma_f32_16x16x32_bf16 v[140:143], a[160:163], v[196:199], 0
    v_mul_f32 v67, v80, v67
    v_mul_f32 v68, v81, v68
    v_mfma_f32_16x16x32_bf16 v[156:159], a[164:167], v[196:199], 0
    v_mul_f32 v69, v81, v69
    v_mul_f32 v70, v81, v70
    v_mfma_f32_16x16x32_bf16 v[172:175], a[168:171], v[196:199], 0
    ds_write_b128 v33, v[152:155] offset:12288
    v_mul_f32 v71, v81, v71
    v_mfma_f32_16x16x32_bf16 v[188:191], a[172:175], v[196:199], 0
    s_waitcnt vmcnt(7)
    v_mul_f32 v72, v82, v72
    v_mfma_f32_16x16x32_bf16 v[140:143], a[176:179], v[200:203], v[140:143]
    ds_write_b128 v34, v[168:171] offset:12288
    v_mul_f32 v73, v82, v73
    v_mfma_f32_16x16x32_bf16 v[156:159], a[180:183], v[200:203], v[156:159]
    v_mul_f32 v74, v82, v74
    v_mul_f32 v75, v82, v75
    v_mfma_f32_16x16x32_bf16 v[172:175], a[184:187], v[200:203], v[172:175]
    ds_write_b128 v35, v[184:187] offset:12288
    v_mul_f32 v76, v83, v76
    v_mfma_f32_16x16x32_bf16 v[188:191], a[188:191], v[200:203], v[188:191]
    s_waitcnt vmcnt(6)
    v_mul_f32 v77, v83, v77
    v_mfma_f32_16x16x32_bf16 v[140:143], a[0:3], v[204:207], v[140:143]
    v_mul_f32 v78, v83, v78
    v_mul_f32 v79, v83, v79
    v_mfma_f32_16x16x32_bf16 v[156:159], a[4:7], v[204:207], v[156:159]
    s_waitcnt vmcnt(2)
    v_lshlrev_b32 v88, 16, v24
    v_and_b32 v24, s92, v24
    v_mfma_f32_16x16x32_bf16 v[172:175], a[8:11], v[204:207], v[172:175]
    s_waitcnt lgkmcnt(0)
    s_barrier
    v_mfma_f32_16x16x32_bf16 v[188:191], a[12:15], v[204:207], v[188:191]
    ds_read_b128 v[152:155], v32 offset:12288
    v_mfma_f32_16x16x32_bf16 v[140:143], a[16:19], v[208:211], v[140:143]
    ds_read_b128 v[168:171], v32 offset:13312
    v_fmac_f32 v64, v20, v88
    v_mfma_f32_16x16x32_bf16 v[156:159], a[20:23], v[208:211], v[156:159]
    ds_read_b128 v[184:187], v32 offset:14336
    v_fmac_f32 v65, v20, v24
    v_mfma_f32_16x16x32_bf16 v[172:175], a[24:27], v[208:211], v[172:175]
    v_lshlrev_b32 v89, 16, v25
    v_and_b32 v25, s92, v25
    v_mfma_f32_16x16x32_bf16 v[188:191], a[28:31], v[208:211], v[188:191]
    v_fmac_f32 v66, v20, v89
    v_mfma_f32_16x16x32_bf16 v[140:143], a[32:35], v[212:215], v[140:143]
    v_fmac_f32 v67, v20, v25
    v_lshlrev_b32 v90, 16, v26
    v_mfma_f32_16x16x32_bf16 v[156:159], a[36:39], v[212:215], v[156:159]
    v_and_b32 v26, s92, v26
    v_fmac_f32 v68, v21, v90
    v_fmac_f32 v69, v21, v26
    v_lshlrev_b32 v91, 16, v27
    v_and_b32 v27, s92, v27
    v_fmac_f32 v70, v21, v91
    v_fmac_f32 v71, v21, v27
    v_fma_f32 v128, v128, v20, v64
    v_fma_f32 v129, v129, v20, v65
    v_fma_f32 v130, v130, v20, v66
    v_fma_f32 v131, v131, v20, v67
    v_cvt_pk_bf16_f32 v56, v128, v129
    v_cvt_pk_bf16_f32 v57, v130, v131
    ds_write_b64 v6, v[56:57] offset:0
    v_fma_f32 v132, v132, v21, v68
    v_mfma_f32_16x16x32_bf16 v[172:175], a[40:43], v[212:215], v[172:175]
    s_waitcnt lgkmcnt(1)
    v_add_f32 v136, v136, v152
    v_mfma_f32_16x16x32_bf16 v[188:191], a[44:47], v[212:215], v[188:191]
    v_add_f32 v137, v137, v153
    v_mfma_f32_16x16x32_bf16 v[140:143], a[48:51], v[216:219], v[140:143]
    v_add_f32 v138, v138, v154
    v_add_f32 v139, v139, v155
    v_mfma_f32_16x16x32_bf16 v[156:159], a[52:55], v[216:219], v[156:159]
    v_add_f32 v168, v168, v184
    v_add_f32 v169, v169, v185
    v_mfma_f32_16x16x32_bf16 v[172:175], a[56:59], v[216:219], v[172:175]
    v_add_f32 v170, v170, v186
    v_add_f32 v171, v171, v187
    v_mfma_f32_16x16x32_bf16 v[188:191], a[60:63], v[216:219], v[188:191]
    s_waitcnt vmcnt(1)
    v_add_f32 v136, v136, v168
    v_mfma_f32_16x16x32_bf16 v[156:159], a[68:71], v[220:223], v[156:159]
    v_add_f32 v137, v137, v169
    v_add_f32 v138, v138, v170
    v_mfma_f32_16x16x32_bf16 v[172:175], a[72:75], v[220:223], v[172:175]
    v_add_f32 v139, v139, v171
    v_fma_f32 v133, v133, v21, v69
    v_fma_f32 v134, v134, v21, v70
    v_mfma_f32_16x16x32_bf16 v[188:191], a[76:79], v[220:223], v[188:191]
    v_fma_f32 v135, v135, v21, v71
    v_cvt_pk_bf16_f32 v58, v132, v133
    v_mfma_f32_16x16x32_bf16 v[140:143], a[64:67], v[220:223], v[140:143]
    v_cvt_pk_bf16_f32 v59, v134, v135
    ds_write_b64 v6, v[58:59] offset:2048
    ds_write_b128 v33, v[156:159] offset:24576
    s_waitcnt vmcnt(0)
    v_lshlrev_b32 v92, 16, v28
    v_and_b32 v28, s92, v28
    v_fmac_f32 v72, v22, v92
    v_fmac_f32 v73, v22, v28
    v_lshlrev_b32 v93, 16, v29
    v_and_b32 v29, s92, v29
    ds_write_b128 v34, v[172:175] offset:24576
    v_fmac_f32 v74, v22, v93
    v_fmac_f32 v75, v22, v29
    v_lshlrev_b32 v94, 16, v30
    v_and_b32 v30, s92, v30
    v_fmac_f32 v76, v23, v94
    ds_write_b128 v35, v[188:191] offset:24576
    v_fmac_f32 v77, v23, v30
    v_lshlrev_b32 v95, 16, v31
    v_and_b32 v31, s92, v31
    v_fmac_f32 v78, v23, v95
    v_fmac_f32 v79, v23, v31
    s_waitcnt lgkmcnt(0)
    s_barrier
    ds_read_b128 v[156:159], v32 offset:24576
    ds_read_b128 v[172:175], v32 offset:25600
    ds_read_b128 v[188:191], v32 offset:26624
    ds_read_b128 v[36:39], v7
    v_fma_f32 v136, v136, v22, v72
    v_fma_f32 v137, v137, v22, v73
    v_fma_f32 v138, v138, v22, v74
    v_fma_f32 v139, v139, v22, v75
    v_cvt_pk_bf16_f32 v60, v136, v137
    v_cvt_pk_bf16_f32 v61, v138, v139
    ds_write_b64 v6, v[60:61] offset:4096
    s_waitcnt lgkmcnt(4)
    v_pk_add_f32 v[140:141], v[140:141], v[156:157]
    v_pk_add_f32 v[142:143], v[142:143], v[158:159]
    s_waitcnt lgkmcnt(2)
    v_pk_add_f32 v[172:173], v[172:173], v[188:189]
    v_pk_add_f32 v[174:175], v[174:175], v[190:191]
    v_pk_add_f32 v[140:141], v[140:141], v[172:173]
    v_pk_add_f32 v[142:143], v[142:143], v[174:175]
    s_waitcnt lgkmcnt(1)
    buffer_store_dwordx4 v[36:39], v3, s[28:31], s76 offen sc1
    v_fma_f32 v140, v140, v23, v76
    v_fma_f32 v141, v141, v23, v77
    v_fma_f32 v142, v142, v23, v78
    v_fma_f32 v143, v143, v23, v79
    v_cvt_pk_bf16_f32 v62, v140, v141
    v_cvt_pk_bf16_f32 v63, v142, v143
    ds_write_b64 v6, v[62:63] offset:6144
    s_waitcnt lgkmcnt(0)
    s_barrier
    ds_read_b128 v[40:43], v7 offset:4096
    s_waitcnt lgkmcnt(0)
    buffer_store_dwordx4 v[40:43], v3, s[28:31], s77 offen sc1
    s_endpgm
L_dft:
    s_add_u32 s76, s76, 0x800
    s_add_u32 s77, s76, 0x80000
    s_add_u32 s78, s76, 0x100000
    s_add_u32 s79, s76, 0x180000
    s_add_u32 s6, s75, 28
    s_and_b32 s94, s70, 2
    s_mov_b32 s83, s94
    v_mov_b32 v5, v18
    v_lshlrev_b32 v14, 4, v0
    s_mov_b32 s14, 0x200e00
    s_mov_b32 s15, 0x20000
    s_waitcnt lgkmcnt(0)
    s_sub_u32 s8, s48, 2048
    s_subb_u32 s9, s49, 0
    s_sub_u32 s12, s48, 3584
    s_subb_u32 s13, s49, 0
    v_lshl_add_u32 v4, s94, 7, v3
    v_lshl_add_u32 v16, s94, 7, v5
    s_add_u32 m0, s93, 0
    s_nop 0
    buffer_load_dwordx4 v4, s[8:11], s76 offen offset:0 lds
    buffer_load_dwordx4 v16, s[8:11], s76 offen offset:1024 lds
    buffer_load_dwordx4 v4, s[12:15], s76 offen offset:2048 lds
    buffer_load_dwordx4 v16, s[12:15], s76 offen offset:3072 lds
    s_add_u32 m0, s93, 4096
    s_nop 0
    buffer_load_dwordx4 v4, s[8:11], s77 offen offset:0 lds
    buffer_load_dwordx4 v16, s[8:11], s77 offen offset:1024 lds
    buffer_load_dwordx4 v4, s[12:15], s77 offen offset:2048 lds
    buffer_load_dwordx4 v16, s[12:15], s77 offen offset:3072 lds
    s_add_u32 m0, s93, 8192
    s_nop 0
    buffer_load_dwordx4 v4, s[8:11], s78 offen offset:0 lds
    buffer_load_dwordx4 v16, s[8:11], s78 offen offset:1024 lds
    buffer_load_dwordx4 v4, s[12:15], s78 offen offset:2048 lds
    buffer_load_dwordx4 v16, s[12:15], s78 offen offset:3072 lds
    s_lshr_b32 s86, s75, 1
    s_lshl_b32 s86, s86, 2
    s_add_u32 s86, s86, s4
    s_lshl_b32 s86, s86, 5
    s_and_b32 s87, s75, 1
    s_add_u32 s86, s86, s87
    v_lshl_add_u32 v112, v1, 1, s86
    v_cvt_f32_u32 v114, v112
    v_cmp_eq_u32 vcc, 0, v112
    v_mul_f32 v114, 0x3b000000, v114
    v_mov_b32 v117, 0x3e800000
    s_lshl_b32 s86, s83, 6
    v_lshl_add_u32 v118, v2, 2, s86
    v_cvt_f32_u32 v118, v118
    v_cndmask_b32 v115, v114, 0.5, vcc
    v_cndmask_b32 v117, v117, 0, vcc
    v_mul_f32 v116, v114, v118
    v_fmac_f32 v117, v115, v118
    v_mul_f32 v104, 0x42000000, v114
    v_mul_f32 v106, 0x42000000, v115
    v_cos_f32 v104, v104
    v_cos_f32 v106, v106
    s_lshl_b32 s86, s4, 11
    v_add_u32 v119, s86, v14
    v_add_f32 v104, v104, v104
    v_add_f32 v106, v106, v106
    v_mov_b32 v105, v104
    v_mov_b32 v107, v106
    v_fmamk_f32 v65, v114, 0x3f800000, v116
    v_fmamk_f32 v66, v114, 0x40000000, v116
    v_fmamk_f32 v67, v114, 0x40400000, v116
    v_fmamk_f32 v68, v114, 0x41800000, v116
    v_fmamk_f32 v69, v114, 0x41880000, v116
    v_fmamk_f32 v70, v114, 0x41900000, v116
    v_fmamk_f32 v71, v114, 0x41980000, v116
    v_cos_f32 v64, v116
    v_cos_f32 v65, v65
    v_cos_f32 v66, v66
    v_cos_f32 v67, v67
    v_cos_f32 v68, v68
    v_cos_f32 v69, v69
    v_cos_f32 v70, v70
    v_cos_f32 v71, v71
    v_cvt_pk_bf16_f32 v96, v64, v65
    v_cvt_pk_bf16_f32 v97, v66, v67
    v_cvt_pk_bf16_f32 v98, v68, v69
    v_cvt_pk_bf16_f32 v99, v70, v71
    ds_write_b128 v119, v[96:99] offset:0
    v_fmamk_f32 v81, v115, 0x3f800000, v117
    v_fmamk_f32 v82, v115, 0x40000000, v117
    v_fmamk_f32 v83, v115, 0x40400000, v117
    v_fmamk_f32 v84, v115, 0x41800000, v117
    v_fmamk_f32 v85, v115, 0x41880000, v117
    v_fmamk_f32 v86, v115, 0x41900000, v117
    v_fmamk_f32 v87, v115, 0x41980000, v117
    v_cos_f32 v80, v117
    v_cos_f32 v81, v81
    v_cos_f32 v82, v82
    v_cos_f32 v83, v83
    v_cos_f32 v84, v84
    v_cos_f32 v85, v85
    v_cos_f32 v86, v86
    v_cos_f32 v87, v87
    v_cvt_pk_bf16_f32 v100, v80, v81
    v_cvt_pk_bf16_f32 v101, v82, v83
    v_cvt_pk_bf16_f32 v102, v84, v85
    v_cvt_pk_bf16_f32 v103, v86, v87
    ds_write_b128 v119, v[100:103] offset:1024
    v_fmamk_f32 v72, v114, 0x42000000, v116
    v_fmamk_f32 v73, v114, 0x42040000, v116
    v_fmamk_f32 v74, v114, 0x42080000, v116
    v_fmamk_f32 v75, v114, 0x420c0000, v116
    v_fmamk_f32 v76, v114, 0x42400000, v116
    v_fmamk_f32 v77, v114, 0x42440000, v116
    v_fmamk_f32 v78, v114, 0x42480000, v116
    v_fmamk_f32 v79, v114, 0x424c0000, v116
    v_cos_f32 v72, v72
    v_cos_f32 v73, v73
    v_cos_f32 v74, v74
    v_cos_f32 v75, v75
    v_cos_f32 v76, v76
    v_cos_f32 v77, v77
    v_cos_f32 v78, v78
    v_cos_f32 v79, v79
    v_cvt_pk_bf16_f32 v96, v72, v73
    v_cvt_pk_bf16_f32 v97, v74, v75
    v_cvt_pk_bf16_f32 v98, v76, v77
    v_cvt_pk_bf16_f32 v99, v78, v79
    ds_write_b128 v119, v[96:99] offset:8192
    v_fmamk_f32 v88, v115, 0x42000000, v117
    v_fmamk_f32 v89, v115, 0x42040000, v117
    v_fmamk_f32 v90, v115, 0x42080000, v117
    v_fmamk_f32 v91, v115, 0x420c0000, v117
    v_fmamk_f32 v92, v115, 0x42400000, v117
    v_fmamk_f32 v93, v115, 0x42440000, v117
    v_fmamk_f32 v94, v115, 0x42480000, v117
    v_fmamk_f32 v95, v115, 0x424c0000, v117
    v_cos_f32 v88, v88
    v_cos_f32 v89, v89
    v_cos_f32 v90, v90
    v_cos_f32 v91, v91
    v_cos_f32 v92, v92
    v_cos_f32 v93, v93
    v_cos_f32 v94, v94
    v_cos_f32 v95, v95
    v_cvt_pk_bf16_f32 v100, v88, v89
    v_cvt_pk_bf16_f32 v101, v90, v91
    v_cvt_pk_bf16_f32 v102, v92, v93
    v_cvt_pk_bf16_f32 v103, v94, v95
    ds_write_b128 v119, v[100:103] offset:9216
    v_pk_fma_f32 v[64:65], v[104:105], v[72:73], v[64:65] neg_lo:[0,0,1] neg_hi:[0,0,1]
    v_pk_fma_f32 v[66:67], v[104:105], v[74:75], v[66:67] neg_lo:[0,0,1] neg_hi:[0,0,1]
    v_pk_fma_f32 v[68:69], v[104:105], v[76:77], v[68:69] neg_lo:[0,0,1] neg_hi:[0,0,1]
    v_pk_fma_f32 v[70:71], v[104:105], v[78:79], v[70:71] neg_lo:[0,0,1] neg_hi:[0,0,1]
    v_cvt_pk_bf16_f32 v96, v64, v65
    v_cvt_pk_bf16_f32 v97, v66, v67
    v_cvt_pk_bf16_f32 v98, v68, v69
    v_cvt_pk_bf16_f32 v99, v70, v71
    ds_write_b128 v119, v[96:99] offset:16384
    v_pk_fma_f32 v[80:81], v[106:107], v[88:89], v[80:81] neg_lo:[0,0,1] neg_hi:[0,0,1]
    v_pk_fma_f32 v[82:83], v[106:107], v[90:91], v[82:83] neg_lo:[0,0,1] neg_hi:[0,0,1]
    v_pk_fma_f32 v[84:85], v[106:107], v[92:93], v[84:85] neg_lo:[0,0,1] neg_hi:[0,0,1]
    v_pk_fma_f32 v[86:87], v[106:107], v[94:95], v[86:87] neg_lo:[0,0,1] neg_hi:[0,0,1]
    v_cvt_pk_bf16_f32 v100, v80, v81
    v_cvt_pk_bf16_f32 v101, v82, v83
    v_cvt_pk_bf16_f32 v102, v84, v85
    v_cvt_pk_bf16_f32 v103, v86, v87
    ds_write_b128 v119, v[100:103] offset:17408
    v_pk_fma_f32 v[72:73], v[104:105], v[64:65], v[72:73] neg_lo:[0,0,1] neg_hi:[0,0,1]
    v_pk_fma_f32 v[74:75], v[104:105], v[66:67], v[74:75] neg_lo:[0,0,1] neg_hi:[0,0,1]
    v_pk_fma_f32 v[76:77], v[104:105], v[68:69], v[76:77] neg_lo:[0,0,1] neg_hi:[0,0,1]
    v_pk_fma_f32 v[78:79], v[104:105], v[70:71], v[78:79] neg_lo:[0,0,1] neg_hi:[0,0,1]
    v_cvt_pk_bf16_f32 v96, v72, v73
    v_cvt_pk_bf16_f32 v97, v74, v75
    v_cvt_pk_bf16_f32 v98, v76, v77
    v_cvt_pk_bf16_f32 v99, v78, v79
    ds_write_b128 v119, v[96:99] offset:24576
    v_pk_fma_f32 v[88:89], v[106:107], v[80:81], v[88:89] neg_lo:[0,0,1] neg_hi:[0,0,1]
    v_pk_fma_f32 v[90:91], v[106:107], v[82:83], v[90:91] neg_lo:[0,0,1] neg_hi:[0,0,1]
    v_pk_fma_f32 v[92:93], v[106:107], v[84:85], v[92:93] neg_lo:[0,0,1] neg_hi:[0,0,1]
    v_pk_fma_f32 v[94:95], v[106:107], v[86:87], v[94:95] neg_lo:[0,0,1] neg_hi:[0,0,1]
    v_cvt_pk_bf16_f32 v100, v88, v89
    v_cvt_pk_bf16_f32 v101, v90, v91
    v_cvt_pk_bf16_f32 v102, v92, v93
    v_cvt_pk_bf16_f32 v103, v94, v95
    ds_write_b128 v119, v[100:103] offset:25600
    v_pk_fma_f32 v[64:65], v[104:105], v[72:73], v[64:65] neg_lo:[0,0,1] neg_hi:[0,0,1]
    v_pk_fma_f32 v[66:67], v[104:105], v[74:75], v[66:67] neg_lo:[0,0,1] neg_hi:[0,0,1]
    v_pk_fma_f32 v[68:69], v[104:105], v[76:77], v[68:69] neg_lo:[0,0,1] neg_hi:[0,0,1]
    v_pk_fma_f32 v[70:71], v[104:105], v[78:79], v[70:71] neg_lo:[0,0,1] neg_hi:[0,0,1]
    v_cvt_pk_bf16_f32 v96, v64, v65
    v_cvt_pk_bf16_f32 v97, v66, v67
    v_cvt_pk_bf16_f32 v98, v68, v69
    v_cvt_pk_bf16_f32 v99, v70, v71
    ds_write_b128 v119, v[96:99] offset:32768
    v_pk_fma_f32 v[80:81], v[106:107], v[88:89], v[80:81] neg_lo:[0,0,1] neg_hi:[0,0,1]
    v_pk_fma_f32 v[82:83], v[106:107], v[90:91], v[82:83] neg_lo:[0,0,1] neg_hi:[0,0,1]
    v_pk_fma_f32 v[84:85], v[106:107], v[92:93], v[84:85] neg_lo:[0,0,1] neg_hi:[0,0,1]
    v_pk_fma_f32 v[86:87], v[106:107], v[94:95], v[86:87] neg_lo:[0,0,1] neg_hi:[0,0,1]
    v_cvt_pk_bf16_f32 v100, v80, v81
    v_cvt_pk_bf16_f32 v101, v82, v83
    v_cvt_pk_bf16_f32 v102, v84, v85
    v_cvt_pk_bf16_f32 v103, v86, v87
    ds_write_b128 v119, v[100:103] offset:33792
    v_pk_fma_f32 v[72:73], v[104:105], v[64:65], v[72:73] neg_lo:[0,0,1] neg_hi:[0,0,1]
    v_pk_fma_f32 v[74:75], v[104:105], v[66:67], v[74:75] neg_lo:[0,0,1] neg_hi:[0,0,1]
    v_pk_fma_f32 v[76:77], v[104:105], v[68:69], v[76:77] neg_lo:[0,0,1] neg_hi:[0,0,1]
    v_pk_fma_f32 v[78:79], v[104:105], v[70:71], v[78:79] neg_lo:[0,0,1] neg_hi:[0,0,1]
    v_cvt_pk_bf16_f32 v96, v72, v73
    v_cvt_pk_bf16_f32 v97, v74, v75
    v_cvt_pk_bf16_f32 v98, v76, v77
    v_cvt_pk_bf16_f32 v99, v78, v79
    ds_write_b128 v119, v[96:99] offset:40960
    v_pk_fma_f32 v[88:89], v[106:107], v[80:81], v[88:89] neg_lo:[0,0,1] neg_hi:[0,0,1]
    v_pk_fma_f32 v[90:91], v[106:107], v[82:83], v[90:91] neg_lo:[0,0,1] neg_hi:[0,0,1]
    v_pk_fma_f32 v[92:93], v[106:107], v[84:85], v[92:93] neg_lo:[0,0,1] neg_hi:[0,0,1]
    v_pk_fma_f32 v[94:95], v[106:107], v[86:87], v[94:95] neg_lo:[0,0,1] neg_hi:[0,0,1]
    v_cvt_pk_bf16_f32 v100, v88, v89
    v_cvt_pk_bf16_f32 v101, v90, v91
    v_cvt_pk_bf16_f32 v102, v92, v93
    v_cvt_pk_bf16_f32 v103, v94, v95
    ds_write_b128 v119, v[100:103] offset:41984
    v_pk_fma_f32 v[64:65], v[104:105], v[72:73], v[64:65] neg_lo:[0,0,1] neg_hi:[0,0,1]
    v_pk_fma_f32 v[66:67], v[104:105], v[74:75], v[66:67] neg_lo:[0,0,1] neg_hi:[0,0,1]
    v_pk_fma_f32 v[68:69], v[104:105], v[76:77], v[68:69] neg_lo:[0,0,1] neg_hi:[0,0,1]
    v_pk_fma_f32 v[70:71], v[104:105], v[78:79], v[70:71] neg_lo:[0,0,1] neg_hi:[0,0,1]
    v_cvt_pk_bf16_f32 v96, v64, v65
    v_cvt_pk_bf16_f32 v97, v66, v67
    v_cvt_pk_bf16_f32 v98, v68, v69
    v_cvt_pk_bf16_f32 v99, v70, v71
    ds_write_b128 v119, v[96:99] offset:49152
    v_pk_fma_f32 v[80:81], v[106:107], v[88:89], v[80:81] neg_lo:[0,0,1] neg_hi:[0,0,1]
    v_pk_fma_f32 v[82:83], v[106:107], v[90:91], v[82:83] neg_lo:[0,0,1] neg_hi:[0,0,1]
    v_pk_fma_f32 v[84:85], v[106:107], v[92:93], v[84:85] neg_lo:[0,0,1] neg_hi:[0,0,1]
    v_pk_fma_f32 v[86:87], v[106:107], v[94:95], v[86:87] neg_lo:[0,0,1] neg_hi:[0,0,1]
    v_cvt_pk_bf16_f32 v100, v80, v81
    v_cvt_pk_bf16_f32 v101, v82, v83
    v_cvt_pk_bf16_f32 v102, v84, v85
    v_cvt_pk_bf16_f32 v103, v86, v87
    ds_write_b128 v119, v[100:103] offset:50176
    v_pk_fma_f32 v[72:73], v[104:105], v[64:65], v[72:73] neg_lo:[0,0,1] neg_hi:[0,0,1]
    v_pk_fma_f32 v[74:75], v[104:105], v[66:67], v[74:75] neg_lo:[0,0,1] neg_hi:[0,0,1]
    v_pk_fma_f32 v[76:77], v[104:105], v[68:69], v[76:77] neg_lo:[0,0,1] neg_hi:[0,0,1]
    v_pk_fma_f32 v[78:79], v[104:105], v[70:71], v[78:79] neg_lo:[0,0,1] neg_hi:[0,0,1]
    v_cvt_pk_bf16_f32 v96, v72, v73
    v_cvt_pk_bf16_f32 v97, v74, v75
    v_cvt_pk_bf16_f32 v98, v76, v77
    v_cvt_pk_bf16_f32 v99, v78, v79
    ds_write_b128 v119, v[96:99] offset:57344
    v_pk_fma_f32 v[88:89], v[106:107], v[80:81], v[88:89] neg_lo:[0,0,1] neg_hi:[0,0,1]
    v_pk_fma_f32 v[90:91], v[106:107], v[82:83], v[90:91] neg_lo:[0,0,1] neg_hi:[0,0,1]
    v_pk_fma_f32 v[92:93], v[106:107], v[84:85], v[92:93] neg_lo:[0,0,1] neg_hi:[0,0,1]
    v_pk_fma_f32 v[94:95], v[106:107], v[86:87], v[94:95] neg_lo:[0,0,1] neg_hi:[0,0,1]
    v_cvt_pk_bf16_f32 v100, v88, v89
    v_cvt_pk_bf16_f32 v101, v90, v91
    v_cvt_pk_bf16_f32 v102, v92, v93
    v_cvt_pk_bf16_f32 v103, v94, v95
    ds_write_b128 v119, v[100:103] offset:58368
    s_add_u32 m0, s93, 12288
    s_nop 0
    buffer_load_dwordx4 v4, s[8:11], s79 offen offset:0 lds
    buffer_load_dwordx4 v16, s[8:11], s79 offen offset:1024 lds
    buffer_load_dwordx4 v4, s[12:15], s79 offen offset:2048 lds
    buffer_load_dwordx4 v16, s[12:15], s79 offen offset:3072 lds
    s_lshl_b32 s87, s87, 15
    v_lshrrev_b32 v24, 1, v2
    v_mul_u32_u24 v24, s87, v24
    v_or_b32 v24, 0x3f80, v24
    v_and_b32 v25, 1, v0
    v_lshlrev_b32 v25, 4, v25
    v_lshlrev_b32 v24, v25, v24
    v_lshrrev_b32 v25, 1, v1
    v_and_b32 v26, 1, v2
    v_lshlrev_b32 v27, 2, v26
    v_xor_b32 v27, v25, v27
    v_cmp_eq_u32 vcc, 0, v27
    v_cmp_eq_u32 s[96:97], 1, v27
    v_cmp_eq_u32 s[98:99], 2, v27
    v_cndmask_b32 v20, 0, v24, vcc
    v_cmp_eq_u32 vcc, 3, v27
    v_cndmask_b32 v21, 0, v24, s[96:97]
    v_cndmask_b32 v22, 0, v24, s[98:99]
    v_cndmask_b32 v23, 0, v24, vcc
    v_xor_b32 v24, v26, v25
    v_lshlrev_b32 v24, 4, v24
    v_lshl_add_u32 v24, v1, 7, v24
    v_lshrrev_b32 v25, 1, v2
    v_lshl_add_u32 v24, v25, 11, v24
    v_add_u32 v6, s93, v24
    v_xor_b32 v7, 32, v6
    v_xor_b32 v8, 64, v6
    v_xor_b32 v9, 0x60, v6
    v_lshlrev_b32 v14, 4, v0
    s_lshl_b32 s84, s71, 2
    s_add_u32 s84, s84, s4
    s_mul_i32 s3, s70, 112
    s_add_u32 s84, s84, s3
    s_lshl_b32 s84, s84, 11
    s_mov_b32 s92, 0xffff0000
    s_add_u32 s0, s73, 1
    s_and_b32 s0, s0, 7
    s_and_b32 s1, s74, 1
    s_lshl_b32 s1, s1, 1
    s_mov_b64 s[24:25], s[68:69]
    s_mov_b32 s26, 0x10000000
    s_mov_b32 s27, 0x20000
    s_mov_b64 s[44:45], s[66:67]
    s_mov_b32 s46, 0x100
    s_mov_b32 s47, 0x20000
    s_mov_b64 s[20:21], s[60:61]
    s_mov_b32 s22, 0x1c0000
    s_mov_b32 s23, 0x20000
    s_mov_b64 s[28:29], s[64:65]
    s_mov_b32 s30, 0x200000
    s_mov_b32 s31, 0x20000
    s_mov_b64 s[32:33], s[50:51]
    s_mov_b32 s34, 0x101000
    s_mov_b32 s35, 0x20000
    s_mov_b64 s[36:37], s[52:53]
    s_mov_b32 s38, 0x101000
    s_mov_b32 s39, 0x20000
    s_mov_b64 s[40:41], s[62:63]
    s_mov_b32 s42, 0x400
    s_mov_b32 s43, 0x20000
    s_waitcnt lgkmcnt(0)
    s_barrier
    ds_read_b128 a[64:67], v14 offset:0
    ds_read_b128 a[68:71], v14 offset:1024
    ds_read_b128 a[72:75], v14 offset:2048
    ds_read_b128 a[76:79], v14 offset:3072
    ds_read_b128 a[80:83], v14 offset:4096
    ds_read_b128 a[84:87], v14 offset:5120
    ds_read_b128 a[88:91], v14 offset:6144
    ds_read_b128 a[92:95], v14 offset:7168
    s_waitcnt vmcnt(12)
    ds_read_b128 a[0:3], v6 offset:0
    ds_read_b128 a[4:7], v7 offset:0
    ds_read_b128 a[8:11], v8 offset:0
    ds_read_b128 a[12:15], v9 offset:0
    ds_read_b128 a[96:99], v14 offset:8192
    ds_read_b128 a[100:103], v14 offset:9216
    ds_read_b128 a[104:107], v14 offset:10240
    ds_read_b128 a[108:111], v14 offset:11264
    ds_read_b128 a[112:115], v14 offset:12288
    ds_read_b128 a[116:119], v14 offset:13312
    ds_read_b128 a[120:123], v14 offset:14336
    ds_read_b128 a[124:127], v14 offset:15360
    s_waitcnt lgkmcnt(11)
    v_mfma_f32_16x16x32_bf16 v[48:51], v[20:23], a[0:3], 0
    s_waitcnt lgkmcnt(10)
    v_mfma_f32_16x16x32_bf16 v[52:55], v[20:23], a[4:7], 0
    s_waitcnt lgkmcnt(9)
    v_mfma_f32_16x16x32_bf16 v[56:59], v[20:23], a[8:11], 0
    s_waitcnt lgkmcnt(8)
    v_mfma_f32_16x16x32_bf16 v[60:63], v[20:23], a[12:15], 0
    s_add_u32 s94, s94, 1
    s_and_b32 s94, s94, 3
    v_lshl_add_u32 v4, s94, 7, v3
    v_lshl_add_u32 v16, s94, 7, v5
    s_add_u32 m0, s93, 0
    s_nop 0
    buffer_load_dwordx4 v4, s[8:11], s76 offen offset:0 lds
    buffer_load_dwordx4 v16, s[8:11], s76 offen offset:1024 lds
    buffer_load_dwordx4 v4, s[12:15], s76 offen offset:2048 lds
    buffer_load_dwordx4 v16, s[12:15], s76 offen offset:3072 lds
    s_waitcnt vmcnt(12)
    ds_read_b128 a[16:19], v6 offset:4096
    ds_read_b128 a[20:23], v7 offset:4096
    ds_read_b128 a[24:27], v8 offset:4096
    ds_read_b128 a[28:31], v9 offset:4096
    v_cvt_pk_bf16_f32 v32, v48, v49
    v_cvt_pk_bf16_f32 v33, v50, v51
    v_cvt_pk_bf16_f32 v34, v52, v53
    v_cvt_pk_bf16_f32 v35, v54, v55
    v_cvt_pk_bf16_f32 v36, v56, v57
    v_cvt_pk_bf16_f32 v37, v58, v59
    v_cvt_pk_bf16_f32 v38, v60, v61
    v_cvt_pk_bf16_f32 v39, v62, v63
    v_mfma_f32_16x16x32_bf16 v[128:131], v[32:35], a[64:67], 0
    v_mfma_f32_16x16x32_bf16 v[144:147], v[32:35], a[68:71], 0
    v_mfma_f32_16x16x32_bf16 v[160:163], v[32:35], a[72:75], 0
    ds_read_b128 a[128:131], v14 offset:16384
    s_lshl_b32 s86, s4, 4
    v_mfma_f32_16x16x32_bf16 v[176:179], v[32:35], a[76:79], 0
    v_mfma_f32_16x16x32_bf16 v[192:195], v[32:35], a[80:83], 0
    v_mfma_f32_16x16x32_bf16 v[208:211], v[32:35], a[84:87], 0
    s_waitcnt lgkmcnt(1)
    v_mfma_f32_16x16x32_bf16 v[48:51], v[20:23], a[16:19], 0
    s_add_u32 m0, s93, 4096
    ds_read_b128 a[132:135], v14 offset:17408
    v_mfma_f32_16x16x32_bf16 v[52:55], v[20:23], a[20:23], 0
    buffer_load_dwordx4 v4, s[8:11], s77 offen offset:0 lds
    v_add_u32 v24, s86, v1
    v_mfma_f32_16x16x32_bf16 v[56:59], v[20:23], a[24:27], 0
    v_mfma_f32_16x16x32_bf16 v[60:63], v[20:23], a[28:31], 0
    buffer_load_dwordx4 v16, s[8:11], s77 offen offset:1024 lds
    v_mfma_f32_16x16x32_bf16 v[224:227], v[32:35], a[88:91], 0
    buffer_load_dwordx4 v4, s[12:15], s77 offen offset:2048 lds
    ds_read_b128 a[136:139], v14 offset:18432
    v_mfma_f32_16x16x32_bf16 v[240:243], v[32:35], a[92:95], 0
    v_lshrrev_b32 v18, 1, v24
    v_mfma_f32_16x16x32_bf16 v[128:131], v[36:39], a[96:99], v[128:131]
    v_cvt_pk_bf16_f32 v40, v48, v49
    v_cvt_pk_bf16_f32 v41, v50, v51
    buffer_load_dwordx4 v16, s[12:15], s77 offen offset:3072 lds
    v_mfma_f32_16x16x32_bf16 v[144:147], v[36:39], a[100:103], v[144:147]
    v_cvt_pk_bf16_f32 v42, v52, v53
    v_cvt_pk_bf16_f32 v43, v54, v55
    v_mfma_f32_16x16x32_bf16 v[160:163], v[36:39], a[104:107], v[160:163]
    v_cvt_pk_bf16_f32 v44, v56, v57
    v_cvt_pk_bf16_f32 v45, v58, v59
    v_mfma_f32_16x16x32_bf16 v[176:179], v[36:39], a[108:111], v[176:179]
    v_cvt_pk_bf16_f32 v46, v60, v61
    v_cvt_pk_bf16_f32 v47, v62, v63
    v_mfma_f32_16x16x32_bf16 v[192:195], v[36:39], a[112:115], v[192:195]
    s_waitcnt vmcnt(12)
    ds_read_b128 a[0:3], v6 offset:8192
    v_mfma_f32_16x16x32_bf16 v[208:211], v[36:39], a[116:119], v[208:211]
    ds_read_b128 a[4:7], v7 offset:8192
    v_cvt_f32_u32 v18, v18
    v_mfma_f32_16x16x32_bf16 v[224:227], v[36:39], a[120:123], v[224:227]
    ds_read_b128 a[8:11], v8 offset:8192
    v_mul_f32 v18, 0x3c800000, v18
    v_mfma_f32_16x16x32_bf16 v[240:243], v[36:39], a[124:127], v[240:243]
    ds_read_b128 a[12:15], v9 offset:8192
    v_mfma_f32_16x16x32_bf16 v[132:135], v[40:43], a[64:67], 0
    ds_read_b128 a[140:143], v14 offset:19456
    v_mfma_f32_16x16x32_bf16 v[148:151], v[40:43], a[68:71], 0
    ds_read_b128 a[144:147], v14 offset:20480
    v_mfma_f32_16x16x32_bf16 v[164:167], v[40:43], a[72:75], 0
    v_mfma_f32_16x16x32_bf16 v[180:183], v[40:43], a[76:79], 0
    ds_read_b128 a[148:151], v14 offset:21504
    v_and_b32 v19, 1, v24
    v_mfma_f32_16x16x32_bf16 v[196:199], v[40:43], a[80:83], 0
    v_mfma_f32_16x16x32_bf16 v[212:215], v[40:43], a[84:87], 0
    s_waitcnt lgkmcnt(3)
    v_mfma_f32_16x16x32_bf16 v[48:51], v[20:23], a[0:3], 0
    s_add_u32 m0, s93, 8192
    v_mfma_f32_16x16x32_bf16 v[52:55], v[20:23], a[4:7], 0
    buffer_load_dwordx4 v4, s[8:11], s78 offen offset:0 lds
    v_cvt_f32_u32 v19, v19
    v_mfma_f32_16x16x32_bf16 v[56:59], v[20:23], a[8:11], 0
    ds_read_b128 a[152:155], v14 offset:22528
    v_mfma_f32_16x16x32_bf16 v[60:63], v[20:23], a[12:15], 0
    buffer_load_dwordx4 v16, s[8:11], s78 offen offset:1024 lds
    v_mfma_f32_16x16x32_bf16 v[228:231], v[40:43], a[88:91], 0
    buffer_load_dwordx4 v4, s[12:15], s78 offen offset:2048 lds
    v_mfma_f32_16x16x32_bf16 v[244:247], v[40:43], a[92:95], 0
    v_mul_f32 v19, 0xbe800000, v19
    v_mfma_f32_16x16x32_bf16 v[132:135], v[44:47], a[96:99], v[132:135]
    v_cvt_pk_bf16_f32 v32, v48, v49
    v_cvt_pk_bf16_f32 v33, v50, v51
    buffer_load_dwordx4 v16, s[12:15], s78 offen offset:3072 lds
    v_mfma_f32_16x16x32_bf16 v[148:151], v[44:47], a[100:103], v[148:151]
    v_cvt_pk_bf16_f32 v34, v52, v53
    v_cvt_pk_bf16_f32 v35, v54, v55
    v_mfma_f32_16x16x32_bf16 v[164:167], v[44:47], a[104:107], v[164:167]
    v_cvt_pk_bf16_f32 v36, v56, v57
    v_cvt_pk_bf16_f32 v37, v58, v59
    v_mfma_f32_16x16x32_bf16 v[180:183], v[44:47], a[108:111], v[180:183]
    v_cvt_pk_bf16_f32 v38, v60, v61
    v_cvt_pk_bf16_f32 v39, v62, v63
    v_mfma_f32_16x16x32_bf16 v[196:199], v[44:47], a[112:115], v[196:199]
    s_waitcnt vmcnt(12)
    ds_read_b128 a[16:19], v6 offset:12288
    v_mfma_f32_16x16x32_bf16 v[212:215], v[44:47], a[116:119], v[212:215]
    ds_read_b128 a[20:23], v7 offset:12288
    v_cmp_eq_u32 vcc, 1, v24
    v_mfma_f32_16x16x32_bf16 v[228:231], v[44:47], a[120:123], v[228:231]
    ds_read_b128 a[24:27], v8 offset:12288
    v_mfma_f32_16x16x32_bf16 v[244:247], v[44:47], a[124:127], v[244:247]
    ds_read_b128 a[28:31], v9 offset:12288
    v_lshlrev_b32 v24, 2, v2
    v_mfma_f32_16x16x32_bf16 v[136:139], v[32:35], a[64:67], 0
    ds_read_b128 a[156:159], v14 offset:23552
    v_mfma_f32_16x16x32_bf16 v[152:155], v[32:35], a[68:71], 0
    ds_read_b128 a[160:163], v14 offset:24576
    v_mfma_f32_16x16x32_bf16 v[168:171], v[32:35], a[72:75], 0
    ds_read_b128 a[164:167], v14 offset:25600
    v_mfma_f32_16x16x32_bf16 v[184:187], v[32:35], a[76:79], 0
    v_mfma_f32_16x16x32_bf16 v[200:203], v[32:35], a[80:83], 0
    v_cvt_f32_u32 v24, v24
    v_mfma_f32_16x16x32_bf16 v[216:219], v[32:35], a[84:87], 0
    s_waitcnt lgkmcnt(3)
    ds_read_b128 a[168:171], v14 offset:26624
    v_mfma_f32_16x16x32_bf16 v[48:51], v[20:23], a[16:19], 0
    s_add_u32 m0, s93, 12288
    v_mfma_f32_16x16x32_bf16 v[52:55], v[20:23], a[20:23], 0
    buffer_load_dwordx4 v4, s[8:11], s79 offen offset:0 lds
    v_mfma_f32_16x16x32_bf16 v[56:59], v[20:23], a[24:27], 0
    s_lshl_b32 s86, s4, 11
    v_mfma_f32_16x16x32_bf16 v[60:63], v[20:23], a[28:31], 0
    buffer_load_dwordx4 v16, s[8:11], s79 offen offset:1024 lds
    v_mfma_f32_16x16x32_bf16 v[232:235], v[32:35], a[88:91], 0
    buffer_load_dwordx4 v4, s[12:15], s79 offen offset:2048 lds
    ds_read_b128 a[172:175], v14 offset:27648
    v_mfma_f32_16x16x32_bf16 v[248:251], v[32:35], a[92:95], 0
    v_mfma_f32_16x16x32_bf16 v[136:139], v[36:39], a[96:99], v[136:139]
    v_cvt_pk_bf16_f32 v40, v48, v49
    v_cvt_pk_bf16_f32 v41, v50, v51
    buffer_load_dwordx4 v16, s[12:15], s79 offen offset:3072 lds
    v_mfma_f32_16x16x32_bf16 v[152:155], v[36:39], a[100:103], v[152:155]
    v_cvt_pk_bf16_f32 v42, v52, v53
    v_cvt_pk_bf16_f32 v43, v54, v55
    v_mfma_f32_16x16x32_bf16 v[168:171], v[36:39], a[104:107], v[168:171]
    v_cvt_pk_bf16_f32 v44, v56, v57
    v_cvt_pk_bf16_f32 v45, v58, v59
    v_mfma_f32_16x16x32_bf16 v[184:187], v[36:39], a[108:111], v[184:187]
    v_cvt_pk_bf16_f32 v46, v60, v61
    v_cvt_pk_bf16_f32 v47, v62, v63
    v_mfma_f32_16x16x32_bf16 v[200:203], v[36:39], a[112:115], v[200:203]
    s_waitcnt vmcnt(12)
    ds_read_b128 a[0:3], v6 offset:0
    v_mfma_f32_16x16x32_bf16 v[216:219], v[36:39], a[116:119], v[216:219]
    ds_read_b128 a[4:7], v7 offset:0
    s_add_u32 s86, s86, 155648
    v_mfma_f32_16x16x32_bf16 v[232:235], v[36:39], a[120:123], v[232:235]
    ds_read_b128 a[8:11], v8 offset:0
    v_cndmask_b32 v18, v18, 0.5, vcc
    v_mfma_f32_16x16x32_bf16 v[248:251], v[36:39], a[124:127], v[248:251]
    ds_read_b128 a[12:15], v9 offset:0
    v_mfma_f32_16x16x32_bf16 v[140:143], v[40:43], a[64:67], 0
    ds_read_b128 a[176:179], v14 offset:28672
    v_cndmask_b32 v19, v19, 0, vcc
    v_mfma_f32_16x16x32_bf16 v[156:159], v[40:43], a[68:71], 0
    ds_read_b128 a[180:183], v14 offset:29696
    v_mfma_f32_16x16x32_bf16 v[172:175], v[40:43], a[72:75], 0
    v_mfma_f32_16x16x32_bf16 v[188:191], v[40:43], a[76:79], 0
    ds_read_b128 a[184:187], v14 offset:30720
    v_mfma_f32_16x16x32_bf16 v[204:207], v[40:43], a[80:83], 0
    v_mfma_f32_16x16x32_bf16 v[220:223], v[40:43], a[84:87], 0
    s_waitcnt lgkmcnt(3)
    v_fmac_f32 v19, v18, v24
    v_mfma_f32_16x16x32_bf16 v[48:51], v[20:23], a[0:3], 0
    s_add_u32 s94, s94, 1
    s_and_b32 s94, s94, 3
    v_mfma_f32_16x16x32_bf16 v[52:55], v[20:23], a[4:7], 0
    v_lshl_add_u32 v4, s94, 7, v3
    ds_read_b128 a[188:191], v14 offset:31744
    v_mfma_f32_16x16x32_bf16 v[56:59], v[20:23], a[8:11], 0
    v_lshl_add_u32 v16, s94, 7, v5
    v_mfma_f32_16x16x32_bf16 v[60:63], v[20:23], a[12:15], 0
    s_add_u32 m0, s93, 0
    v_add_u32 v17, s86, v14
    v_mfma_f32_16x16x32_bf16 v[236:239], v[40:43], a[88:91], 0
    buffer_load_dwordx4 v4, s[8:11], s76 offen offset:0 lds
    v_mfma_f32_16x16x32_bf16 v[252:255], v[40:43], a[92:95], 0
    buffer_load_dwordx4 v16, s[8:11], s76 offen offset:1024 lds
    v_mfma_f32_16x16x32_bf16 v[140:143], v[44:47], a[96:99], v[140:143]
    v_cvt_pk_bf16_f32 v32, v48, v49
    v_cvt_pk_bf16_f32 v33, v50, v51
    buffer_load_dwordx4 v4, s[12:15], s76 offen offset:2048 lds
    v_mfma_f32_16x16x32_bf16 v[156:159], v[44:47], a[100:103], v[156:159]
    v_cvt_pk_bf16_f32 v34, v52, v53
    v_cvt_pk_bf16_f32 v35, v54, v55
    buffer_load_dwordx4 v16, s[12:15], s76 offen offset:3072 lds
    v_mfma_f32_16x16x32_bf16 v[172:175], v[44:47], a[104:107], v[172:175]
    v_cvt_pk_bf16_f32 v36, v56, v57
    v_cvt_pk_bf16_f32 v37, v58, v59
    v_mfma_f32_16x16x32_bf16 v[188:191], v[44:47], a[108:111], v[188:191]
    v_cvt_pk_bf16_f32 v38, v60, v61
    v_cvt_pk_bf16_f32 v39, v62, v63
    v_mfma_f32_16x16x32_bf16 v[204:207], v[44:47], a[112:115], v[204:207]
    s_waitcnt vmcnt(12)
    ds_read_b128 a[16:19], v6 offset:4096
    v_mfma_f32_16x16x32_bf16 v[220:223], v[44:47], a[116:119], v[220:223]
    ds_read_b128 a[20:23], v7 offset:4096
    v_fmamk_f32 v25, v18, 0x3f800000, v19
    v_mfma_f32_16x16x32_bf16 v[236:239], v[44:47], a[120:123], v[236:239]
    ds_read_b128 a[24:27], v8 offset:4096
    v_fmamk_f32 v26, v18, 0x40000000, v19
    v_mfma_f32_16x16x32_bf16 v[252:255], v[44:47], a[124:127], v[252:255]
    ds_read_b128 a[28:31], v9 offset:4096
    s_waitcnt lgkmcnt(4)
    v_mfma_f32_16x16x32_bf16 v[128:131], v[32:35], a[128:131], v[128:131]
    v_mfma_f32_16x16x32_bf16 v[144:147], v[32:35], a[132:135], v[144:147]
    v_fmamk_f32 v27, v18, 0x40400000, v19
    v_mfma_f32_16x16x32_bf16 v[160:163], v[32:35], a[136:139], v[160:163]
    ds_read_b128 a[64:67], v14 offset:32768
    v_mfma_f32_16x16x32_bf16 v[176:179], v[32:35], a[140:143], v[176:179]
    v_mfma_f32_16x16x32_bf16 v[192:195], v[32:35], a[144:147], v[192:195]
    v_mfma_f32_16x16x32_bf16 v[208:211], v[32:35], a[148:151], v[208:211]
    s_waitcnt lgkmcnt(1)
    v_mfma_f32_16x16x32_bf16 v[48:51], v[20:23], a[16:19], 0
    s_add_u32 m0, s93, 4096
    ds_read_b128 a[68:71], v14 offset:33792
    v_mfma_f32_16x16x32_bf16 v[52:55], v[20:23], a[20:23], 0
    buffer_load_dwordx4 v4, s[8:11], s77 offen offset:0 lds
    v_fmamk_f32 v28, v18, 0x41800000, v19
    v_mfma_f32_16x16x32_bf16 v[56:59], v[20:23], a[24:27], 0
    v_mfma_f32_16x16x32_bf16 v[60:63], v[20:23], a[28:31], 0
    buffer_load_dwordx4 v16, s[8:11], s77 offen offset:1024 lds
    v_mfma_f32_16x16x32_bf16 v[224:227], v[32:35], a[152:155], v[224:227]
    buffer_load_dwordx4 v4, s[12:15], s77 offen offset:2048 lds
    ds_read_b128 a[72:75], v14 offset:34816
    v_mfma_f32_16x16x32_bf16 v[240:243], v[32:35], a[156:159], v[240:243]
    v_fmamk_f32 v29, v18, 0x41880000, v19
    v_mfma_f32_16x16x32_bf16 v[128:131], v[36:39], a[160:163], v[128:131]
    v_cvt_pk_bf16_f32 v40, v48, v49
    v_cvt_pk_bf16_f32 v41, v50, v51
    buffer_load_dwordx4 v16, s[12:15], s77 offen offset:3072 lds
    v_mfma_f32_16x16x32_bf16 v[144:147], v[36:39], a[164:167], v[144:147]
    v_cvt_pk_bf16_f32 v42, v52, v53
    v_cvt_pk_bf16_f32 v43, v54, v55
    v_mfma_f32_16x16x32_bf16 v[160:163], v[36:39], a[168:171], v[160:163]
    v_cvt_pk_bf16_f32 v44, v56, v57
    v_cvt_pk_bf16_f32 v45, v58, v59
    v_mfma_f32_16x16x32_bf16 v[176:179], v[36:39], a[172:175], v[176:179]
    v_cvt_pk_bf16_f32 v46, v60, v61
    v_cvt_pk_bf16_f32 v47, v62, v63
    v_mfma_f32_16x16x32_bf16 v[192:195], v[36:39], a[176:179], v[192:195]
    s_waitcnt vmcnt(12)
    ds_read_b128 a[0:3], v6 offset:8192
    v_mfma_f32_16x16x32_bf16 v[208:211], v[36:39], a[180:183], v[208:211]
    ds_read_b128 a[4:7], v7 offset:8192
    v_fmamk_f32 v30, v18, 0x41900000, v19
    v_mfma_f32_16x16x32_bf16 v[224:227], v[36:39], a[184:187], v[224:227]
    ds_read_b128 a[8:11], v8 offset:8192
    v_fmamk_f32 v31, v18, 0x41980000, v19
    v_mfma_f32_16x16x32_bf16 v[240:243], v[36:39], a[188:191], v[240:243]
    ds_read_b128 a[12:15], v9 offset:8192
    v_mfma_f32_16x16x32_bf16 v[132:135], v[40:43], a[128:131], v[132:135]
    ds_read_b128 a[76:79], v14 offset:35840
    v_mfma_f32_16x16x32_bf16 v[148:151], v[40:43], a[132:135], v[148:151]
    ds_read_b128 a[80:83], v14 offset:36864
    v_mfma_f32_16x16x32_bf16 v[164:167], v[40:43], a[136:139], v[164:167]
    v_cos_f32 v24, v19
    v_mfma_f32_16x16x32_bf16 v[180:183], v[40:43], a[140:143], v[180:183]
    ds_read_b128 a[84:87], v14 offset:37888
    v_mfma_f32_16x16x32_bf16 v[196:199], v[40:43], a[144:147], v[196:199]
    v_mfma_f32_16x16x32_bf16 v[212:215], v[40:43], a[148:151], v[212:215]
    s_waitcnt lgkmcnt(3)
    v_mfma_f32_16x16x32_bf16 v[48:51], v[20:23], a[0:3], 0
    s_add_u32 m0, s93, 8192
    v_mfma_f32_16x16x32_bf16 v[52:55], v[20:23], a[4:7], 0
    buffer_load_dwordx4 v4, s[8:11], s78 offen offset:0 lds
    v_mfma_f32_16x16x32_bf16 v[56:59], v[20:23], a[8:11], 0
    ds_read_b128 a[88:91], v14 offset:38912
    v_mfma_f32_16x16x32_bf16 v[60:63], v[20:23], a[12:15], 0
    buffer_load_dwordx4 v16, s[8:11], s78 offen offset:1024 lds
    v_mfma_f32_16x16x32_bf16 v[228:231], v[40:43], a[152:155], v[228:231]
    buffer_load_dwordx4 v4, s[12:15], s78 offen offset:2048 lds
    v_mfma_f32_16x16x32_bf16 v[244:247], v[40:43], a[156:159], v[244:247]
    v_cos_f32 v25, v25
    v_mfma_f32_16x16x32_bf16 v[132:135], v[44:47], a[160:163], v[132:135]
    v_cvt_pk_bf16_f32 v32, v48, v49
    v_cvt_pk_bf16_f32 v33, v50, v51
    buffer_load_dwordx4 v16, s[12:15], s78 offen offset:3072 lds
    v_mfma_f32_16x16x32_bf16 v[148:151], v[44:47], a[164:167], v[148:151]
    v_cvt_pk_bf16_f32 v34, v52, v53
    v_cvt_pk_bf16_f32 v35, v54, v55
    v_mfma_f32_16x16x32_bf16 v[164:167], v[44:47], a[168:171], v[164:167]
    v_cvt_pk_bf16_f32 v36, v56, v57
    v_cvt_pk_bf16_f32 v37, v58, v59
    v_mfma_f32_16x16x32_bf16 v[180:183], v[44:47], a[172:175], v[180:183]
    v_cvt_pk_bf16_f32 v38, v60, v61
    v_cvt_pk_bf16_f32 v39, v62, v63
    v_mfma_f32_16x16x32_bf16 v[196:199], v[44:47], a[176:179], v[196:199]
    s_waitcnt vmcnt(12)
    ds_read_b128 a[16:19], v6 offset:12288
    v_mfma_f32_16x16x32_bf16 v[212:215], v[44:47], a[180:183], v[212:215]
    ds_read_b128 a[20:23], v7 offset:12288
    v_mfma_f32_16x16x32_bf16 v[228:231], v[44:47], a[184:187], v[228:231]
    ds_read_b128 a[24:27], v8 offset:12288
    v_mfma_f32_16x16x32_bf16 v[244:247], v[44:47], a[188:191], v[244:247]
    ds_read_b128 a[28:31], v9 offset:12288
    v_mfma_f32_16x16x32_bf16 v[136:139], v[32:35], a[128:131], v[136:139]
    ds_read_b128 a[92:95], v14 offset:39936
    v_mfma_f32_16x16x32_bf16 v[152:155], v[32:35], a[132:135], v[152:155]
    ds_read_b128 a[96:99], v14 offset:40960
    v_mfma_f32_16x16x32_bf16 v[168:171], v[32:35], a[136:139], v[168:171]
    ds_read_b128 a[100:103], v14 offset:41984
    v_mfma_f32_16x16x32_bf16 v[184:187], v[32:35], a[140:143], v[184:187]
    v_cos_f32 v26, v26
    v_mfma_f32_16x16x32_bf16 v[200:203], v[32:35], a[144:147], v[200:203]
    v_cos_f32 v27, v27
    v_mfma_f32_16x16x32_bf16 v[216:219], v[32:35], a[148:151], v[216:219]
    s_waitcnt lgkmcnt(3)
    ds_read_b128 a[104:107], v14 offset:43008
    v_mfma_f32_16x16x32_bf16 v[48:51], v[20:23], a[16:19], 0
    s_add_u32 m0, s93, 12288
    v_mfma_f32_16x16x32_bf16 v[52:55], v[20:23], a[20:23], 0
    buffer_load_dwordx4 v4, s[8:11], s79 offen offset:0 lds
    v_mfma_f32_16x16x32_bf16 v[56:59], v[20:23], a[24:27], 0
    v_cos_f32 v28, v28
    v_mfma_f32_16x16x32_bf16 v[60:63], v[20:23], a[28:31], 0
    buffer_load_dwordx4 v16, s[8:11], s79 offen offset:1024 lds
    v_cos_f32 v29, v29
    v_mfma_f32_16x16x32_bf16 v[232:235], v[32:35], a[152:155], v[232:235]
    buffer_load_dwordx4 v4, s[12:15], s79 offen offset:2048 lds
    ds_read_b128 a[108:111], v14 offset:44032
    v_mfma_f32_16x16x32_bf16 v[248:251], v[32:35], a[156:159], v[248:251]
    s_mul_i32 s83, s83, 0x40004000
    v_xor_b32 v20, s83, v20
    v_mfma_f32_16x16x32_bf16 v[136:139], v[36:39], a[160:163], v[136:139]
    v_cvt_pk_bf16_f32 v40, v48, v49
    v_cvt_pk_bf16_f32 v41, v50, v51
    buffer_load_dwordx4 v16, s[12:15], s79 offen offset:3072 lds
    v_mfma_f32_16x16x32_bf16 v[152:155], v[36:39], a[164:167], v[152:155]
    v_cvt_pk_bf16_f32 v42, v52, v53
    v_cvt_pk_bf16_f32 v43, v54, v55
    v_mfma_f32_16x16x32_bf16 v[168:171], v[36:39], a[168:171], v[168:171]
    v_cvt_pk_bf16_f32 v44, v56, v57
    v_cvt_pk_bf16_f32 v45, v58, v59
    v_mfma_f32_16x16x32_bf16 v[184:187], v[36:39], a[172:175], v[184:187]
    v_cvt_pk_bf16_f32 v46, v60, v61
    v_cvt_pk_bf16_f32 v47, v62, v63
    v_mfma_f32_16x16x32_bf16 v[200:203], v[36:39], a[176:179], v[200:203]
    s_waitcnt vmcnt(12)
    ds_read_b128 a[0:3], v6 offset:0
    v_mfma_f32_16x16x32_bf16 v[216:219], v[36:39], a[180:183], v[216:219]
    ds_read_b128 a[4:7], v7 offset:0
    v_xor_b32 v21, s83, v21
    v_mfma_f32_16x16x32_bf16 v[232:235], v[36:39], a[184:187], v[232:235]
    ds_read_b128 a[8:11], v8 offset:0
    v_xor_b32 v22, s83, v22
    v_mfma_f32_16x16x32_bf16 v[248:251], v[36:39], a[188:191], v[248:251]
    ds_read_b128 a[12:15], v9 offset:0
    v_xor_b32 v23, s83, v23
    v_mfma_f32_16x16x32_bf16 v[140:143], v[40:43], a[128:131], v[140:143]
    ds_read_b128 a[112:115], v14 offset:45056
    v_cos_f32 v30, v30
    v_mfma_f32_16x16x32_bf16 v[156:159], v[40:43], a[132:135], v[156:159]
    ds_read_b128 a[116:119], v14 offset:46080
    v_mfma_f32_16x16x32_bf16 v[172:175], v[40:43], a[136:139], v[172:175]
    v_cos_f32 v31, v31
    v_mfma_f32_16x16x32_bf16 v[188:191], v[40:43], a[140:143], v[188:191]
    ds_read_b128 a[120:123], v14 offset:47104
    v_cvt_pk_bf16_f32 v24, v24, v25
    v_mfma_f32_16x16x32_bf16 v[204:207], v[40:43], a[144:147], v[204:207]
    v_cvt_pk_bf16_f32 v25, v26, v27
    v_mfma_f32_16x16x32_bf16 v[220:223], v[40:43], a[148:151], v[220:223]
    s_waitcnt lgkmcnt(3)
    v_cvt_pk_bf16_f32 v26, v28, v29
    v_mfma_f32_16x16x32_bf16 v[48:51], v[20:23], a[0:3], 0
    s_add_u32 s94, s94, 1
    s_and_b32 s94, s94, 3
    v_mfma_f32_16x16x32_bf16 v[52:55], v[20:23], a[4:7], 0
    v_lshl_add_u32 v4, s94, 7, v3
    ds_read_b128 a[124:127], v14 offset:48128
    v_mfma_f32_16x16x32_bf16 v[56:59], v[20:23], a[8:11], 0
    v_lshl_add_u32 v16, s94, 7, v5
    v_mfma_f32_16x16x32_bf16 v[60:63], v[20:23], a[12:15], 0
    s_add_u32 m0, s93, 0
    v_cvt_pk_bf16_f32 v27, v30, v31
    v_mfma_f32_16x16x32_bf16 v[236:239], v[40:43], a[152:155], v[236:239]
    buffer_load_dwordx4 v4, s[8:11], s76 offen offset:0 lds
    v_mfma_f32_16x16x32_bf16 v[252:255], v[40:43], a[156:159], v[252:255]
    buffer_load_dwordx4 v16, s[8:11], s76 offen offset:1024 lds
    v_mfma_f32_16x16x32_bf16 v[140:143], v[44:47], a[160:163], v[140:143]
    v_cvt_pk_bf16_f32 v32, v48, v49
    v_cvt_pk_bf16_f32 v33, v50, v51
    buffer_load_dwordx4 v4, s[12:15], s76 offen offset:2048 lds
    v_mfma_f32_16x16x32_bf16 v[156:159], v[44:47], a[164:167], v[156:159]
    v_cvt_pk_bf16_f32 v34, v52, v53
    v_cvt_pk_bf16_f32 v35, v54, v55
    buffer_load_dwordx4 v16, s[12:15], s76 offen offset:3072 lds
    v_mfma_f32_16x16x32_bf16 v[172:175], v[44:47], a[168:171], v[172:175]
    v_cvt_pk_bf16_f32 v36, v56, v57
    v_cvt_pk_bf16_f32 v37, v58, v59
    v_mfma_f32_16x16x32_bf16 v[188:191], v[44:47], a[172:175], v[188:191]
    v_cvt_pk_bf16_f32 v38, v60, v61
    v_cvt_pk_bf16_f32 v39, v62, v63
    v_mfma_f32_16x16x32_bf16 v[204:207], v[44:47], a[176:179], v[204:207]
    s_waitcnt vmcnt(12)
    ds_read_b128 a[16:19], v6 offset:4096
    v_mfma_f32_16x16x32_bf16 v[220:223], v[44:47], a[180:183], v[220:223]
    ds_read_b128 a[20:23], v7 offset:4096
    v_mfma_f32_16x16x32_bf16 v[236:239], v[44:47], a[184:187], v[236:239]
    ds_read_b128 a[24:27], v8 offset:4096
    v_mfma_f32_16x16x32_bf16 v[252:255], v[44:47], a[188:191], v[252:255]
    ds_read_b128 a[28:31], v9 offset:4096
    s_waitcnt lgkmcnt(4)
    v_mfma_f32_16x16x32_bf16 v[128:131], v[32:35], a[64:67], v[128:131]
    ds_write_b128 v17, v[24:27] offset:0
    v_fmamk_f32 v24, v18, 0x42000000, v19
    v_mfma_f32_16x16x32_bf16 v[144:147], v[32:35], a[68:71], v[144:147]
    v_fmamk_f32 v25, v18, 0x42040000, v19
    v_mfma_f32_16x16x32_bf16 v[160:163], v[32:35], a[72:75], v[160:163]
    ds_read_b128 a[128:131], v14 offset:49152
    v_mfma_f32_16x16x32_bf16 v[176:179], v[32:35], a[76:79], v[176:179]
    v_mfma_f32_16x16x32_bf16 v[192:195], v[32:35], a[80:83], v[192:195]
    v_mfma_f32_16x16x32_bf16 v[208:211], v[32:35], a[84:87], v[208:211]
    s_waitcnt lgkmcnt(2)
    v_mfma_f32_16x16x32_bf16 v[48:51], v[20:23], a[16:19], 0
    s_add_u32 m0, s93, 4096
    ds_read_b128 a[132:135], v14 offset:50176
    v_mfma_f32_16x16x32_bf16 v[52:55], v[20:23], a[20:23], 0
    buffer_load_dwordx4 v4, s[8:11], s77 offen offset:0 lds
    v_fmamk_f32 v26, v18, 0x42080000, v19
    v_mfma_f32_16x16x32_bf16 v[56:59], v[20:23], a[24:27], 0
    v_mfma_f32_16x16x32_bf16 v[60:63], v[20:23], a[28:31], 0
    buffer_load_dwordx4 v16, s[8:11], s77 offen offset:1024 lds
    v_mfma_f32_16x16x32_bf16 v[224:227], v[32:35], a[88:91], v[224:227]
    buffer_load_dwordx4 v4, s[12:15], s77 offen offset:2048 lds
    ds_read_b128 a[136:139], v14 offset:51200
    v_mfma_f32_16x16x32_bf16 v[240:243], v[32:35], a[92:95], v[240:243]
    v_fmamk_f32 v27, v18, 0x420c0000, v19
    v_mfma_f32_16x16x32_bf16 v[128:131], v[36:39], a[96:99], v[128:131]
    v_cvt_pk_bf16_f32 v40, v48, v49
    v_cvt_pk_bf16_f32 v41, v50, v51
    buffer_load_dwordx4 v16, s[12:15], s77 offen offset:3072 lds
    v_mfma_f32_16x16x32_bf16 v[144:147], v[36:39], a[100:103], v[144:147]
    v_cvt_pk_bf16_f32 v42, v52, v53
    v_cvt_pk_bf16_f32 v43, v54, v55
    v_mfma_f32_16x16x32_bf16 v[160:163], v[36:39], a[104:107], v[160:163]
    v_cvt_pk_bf16_f32 v44, v56, v57
    v_cvt_pk_bf16_f32 v45, v58, v59
    v_mfma_f32_16x16x32_bf16 v[176:179], v[36:39], a[108:111], v[176:179]
    v_cvt_pk_bf16_f32 v46, v60, v61
    v_cvt_pk_bf16_f32 v47, v62, v63
    v_mfma_f32_16x16x32_bf16 v[192:195], v[36:39], a[112:115], v[192:195]
    s_waitcnt vmcnt(12)
    ds_read_b128 a[0:3], v6 offset:8192
    v_mfma_f32_16x16x32_bf16 v[208:211], v[36:39], a[116:119], v[208:211]
    ds_read_b128 a[4:7], v7 offset:8192
    v_fmamk_f32 v28, v18, 0x42400000, v19
    v_mfma_f32_16x16x32_bf16 v[224:227], v[36:39], a[120:123], v[224:227]
    ds_read_b128 a[8:11], v8 offset:8192
    v_fmamk_f32 v29, v18, 0x42440000, v19
    v_mfma_f32_16x16x32_bf16 v[240:243], v[36:39], a[124:127], v[240:243]
    ds_read_b128 a[12:15], v9 offset:8192
    v_mfma_f32_16x16x32_bf16 v[132:135], v[40:43], a[64:67], v[132:135]
    ds_read_b128 a[140:143], v14 offset:52224
    v_mfma_f32_16x16x32_bf16 v[148:151], v[40:43], a[68:71], v[148:151]
    ds_read_b128 a[144:147], v14 offset:53248
    v_mfma_f32_16x16x32_bf16 v[164:167], v[40:43], a[72:75], v[164:167]
    v_fmamk_f32 v30, v18, 0x42480000, v19
    v_mfma_f32_16x16x32_bf16 v[180:183], v[40:43], a[76:79], v[180:183]
    ds_read_b128 a[148:151], v14 offset:54272
    v_mfma_f32_16x16x32_bf16 v[196:199], v[40:43], a[80:83], v[196:199]
    v_mfma_f32_16x16x32_bf16 v[212:215], v[40:43], a[84:87], v[212:215]
    s_waitcnt lgkmcnt(3)
    v_mfma_f32_16x16x32_bf16 v[48:51], v[20:23], a[0:3], 0
    s_add_u32 m0, s93, 8192
    v_mfma_f32_16x16x32_bf16 v[52:55], v[20:23], a[4:7], 0
    buffer_load_dwordx4 v4, s[8:11], s78 offen offset:0 lds
    v_fmamk_f32 v31, v18, 0x424c0000, v19
    v_mfma_f32_16x16x32_bf16 v[56:59], v[20:23], a[8:11], 0
    ds_read_b128 a[152:155], v14 offset:55296
    v_mfma_f32_16x16x32_bf16 v[60:63], v[20:23], a[12:15], 0
    buffer_load_dwordx4 v16, s[8:11], s78 offen offset:1024 lds
    v_mfma_f32_16x16x32_bf16 v[228:231], v[40:43], a[88:91], v[228:231]
    buffer_load_dwordx4 v4, s[12:15], s78 offen offset:2048 lds
    v_mfma_f32_16x16x32_bf16 v[244:247], v[40:43], a[92:95], v[244:247]
    v_cos_f32 v24, v24
    v_mfma_f32_16x16x32_bf16 v[132:135], v[44:47], a[96:99], v[132:135]
    v_cvt_pk_bf16_f32 v32, v48, v49
    v_cvt_pk_bf16_f32 v33, v50, v51
    buffer_load_dwordx4 v16, s[12:15], s78 offen offset:3072 lds
    v_mfma_f32_16x16x32_bf16 v[148:151], v[44:47], a[100:103], v[148:151]
    v_cvt_pk_bf16_f32 v34, v52, v53
    v_cvt_pk_bf16_f32 v35, v54, v55
    v_mfma_f32_16x16x32_bf16 v[164:167], v[44:47], a[104:107], v[164:167]
    v_cvt_pk_bf16_f32 v36, v56, v57
    v_cvt_pk_bf16_f32 v37, v58, v59
    v_mfma_f32_16x16x32_bf16 v[180:183], v[44:47], a[108:111], v[180:183]
    v_cvt_pk_bf16_f32 v38, v60, v61
    v_cvt_pk_bf16_f32 v39, v62, v63
    v_mfma_f32_16x16x32_bf16 v[196:199], v[44:47], a[112:115], v[196:199]
    s_waitcnt vmcnt(12)
    ds_read_b128 a[16:19], v6 offset:12288
    v_mfma_f32_16x16x32_bf16 v[212:215], v[44:47], a[116:119], v[212:215]
    ds_read_b128 a[20:23], v7 offset:12288
    v_mfma_f32_16x16x32_bf16 v[228:231], v[44:47], a[120:123], v[228:231]
    ds_read_b128 a[24:27], v8 offset:12288
    v_mfma_f32_16x16x32_bf16 v[244:247], v[44:47], a[124:127], v[244:247]
    ds_read_b128 a[28:31], v9 offset:12288
    v_mfma_f32_16x16x32_bf16 v[136:139], v[32:35], a[64:67], v[136:139]
    ds_read_b128 a[156:159], v14 offset:56320
    v_mfma_f32_16x16x32_bf16 v[152:155], v[32:35], a[68:71], v[152:155]
    ds_read_b128 a[160:163], v14 offset:57344
    v_mfma_f32_16x16x32_bf16 v[168:171], v[32:35], a[72:75], v[168:171]
    ds_read_b128 a[164:167], v14 offset:58368
    v_mfma_f32_16x16x32_bf16 v[184:187], v[32:35], a[76:79], v[184:187]
    v_cos_f32 v25, v25
    v_mfma_f32_16x16x32_bf16 v[200:203], v[32:35], a[80:83], v[200:203]
    v_cos_f32 v26, v26
    v_mfma_f32_16x16x32_bf16 v[216:219], v[32:35], a[84:87], v[216:219]
    s_waitcnt lgkmcnt(3)
    ds_read_b128 a[168:171], v14 offset:59392
    v_mfma_f32_16x16x32_bf16 v[48:51], v[20:23], a[16:19], 0
    s_add_u32 m0, s93, 12288
    v_mfma_f32_16x16x32_bf16 v[52:55], v[20:23], a[20:23], 0
    buffer_load_dwordx4 v4, s[8:11], s79 offen offset:0 lds
    v_mfma_f32_16x16x32_bf16 v[56:59], v[20:23], a[24:27], 0
    v_cos_f32 v27, v27
    v_mfma_f32_16x16x32_bf16 v[60:63], v[20:23], a[28:31], 0
    buffer_load_dwordx4 v16, s[8:11], s79 offen offset:1024 lds
    v_mfma_f32_16x16x32_bf16 v[232:235], v[32:35], a[88:91], v[232:235]
    buffer_load_dwordx4 v4, s[12:15], s79 offen offset:2048 lds
    ds_read_b128 a[172:175], v14 offset:60416
    v_mfma_f32_16x16x32_bf16 v[248:251], v[32:35], a[92:95], v[248:251]
    v_cos_f32 v28, v28
    v_mfma_f32_16x16x32_bf16 v[136:139], v[36:39], a[96:99], v[136:139]
    v_cvt_pk_bf16_f32 v40, v48, v49
    v_cvt_pk_bf16_f32 v41, v50, v51
    buffer_load_dwordx4 v16, s[12:15], s79 offen offset:3072 lds
    v_mfma_f32_16x16x32_bf16 v[152:155], v[36:39], a[100:103], v[152:155]
    v_cvt_pk_bf16_f32 v42, v52, v53
    v_cvt_pk_bf16_f32 v43, v54, v55
    v_mfma_f32_16x16x32_bf16 v[168:171], v[36:39], a[104:107], v[168:171]
    v_cvt_pk_bf16_f32 v44, v56, v57
    v_cvt_pk_bf16_f32 v45, v58, v59
    v_mfma_f32_16x16x32_bf16 v[184:187], v[36:39], a[108:111], v[184:187]
    v_cvt_pk_bf16_f32 v46, v60, v61
    v_cvt_pk_bf16_f32 v47, v62, v63
    v_mfma_f32_16x16x32_bf16 v[200:203], v[36:39], a[112:115], v[200:203]
    s_waitcnt vmcnt(12)
    ds_read_b128 a[0:3], v6 offset:0
    v_mfma_f32_16x16x32_bf16 v[216:219], v[36:39], a[116:119], v[216:219]
    ds_read_b128 a[4:7], v7 offset:0
    v_mfma_f32_16x16x32_bf16 v[232:235], v[36:39], a[120:123], v[232:235]
    ds_read_b128 a[8:11], v8 offset:0
    v_mfma_f32_16x16x32_bf16 v[248:251], v[36:39], a[124:127], v[248:251]
    ds_read_b128 a[12:15], v9 offset:0
    v_mfma_f32_16x16x32_bf16 v[140:143], v[40:43], a[64:67], v[140:143]
    ds_read_b128 a[176:179], v14 offset:61440
    v_mfma_f32_16x16x32_bf16 v[156:159], v[40:43], a[68:71], v[156:159]
    ds_read_b128 a[180:183], v14 offset:62464
    v_mfma_f32_16x16x32_bf16 v[172:175], v[40:43], a[72:75], v[172:175]
    v_cos_f32 v29, v29
    v_mfma_f32_16x16x32_bf16 v[188:191], v[40:43], a[76:79], v[188:191]
    ds_read_b128 a[184:187], v14 offset:63488
    v_mfma_f32_16x16x32_bf16 v[204:207], v[40:43], a[80:83], v[204:207]
    v_cos_f32 v30, v30
    v_mfma_f32_16x16x32_bf16 v[220:223], v[40:43], a[84:87], v[220:223]
    s_waitcnt lgkmcnt(3)
    v_mfma_f32_16x16x32_bf16 v[48:51], v[20:23], a[0:3], 0
    v_cos_f32 v31, v31
    v_mfma_f32_16x16x32_bf16 v[52:55], v[20:23], a[4:7], 0
    ds_read_b128 a[188:191], v14 offset:64512
    v_cvt_pk_bf16_f32 v24, v24, v25
    v_mfma_f32_16x16x32_bf16 v[56:59], v[20:23], a[8:11], 0
    v_mfma_f32_16x16x32_bf16 v[60:63], v[20:23], a[12:15], 0
    v_cvt_pk_bf16_f32 v25, v26, v27
    v_mfma_f32_16x16x32_bf16 v[236:239], v[40:43], a[88:91], v[236:239]
    v_mfma_f32_16x16x32_bf16 v[252:255], v[40:43], a[92:95], v[252:255]
    v_mfma_f32_16x16x32_bf16 v[140:143], v[44:47], a[96:99], v[140:143]
    v_cvt_pk_bf16_f32 v32, v48, v49
    v_cvt_pk_bf16_f32 v33, v50, v51
    v_mfma_f32_16x16x32_bf16 v[156:159], v[44:47], a[100:103], v[156:159]
    v_cvt_pk_bf16_f32 v34, v52, v53
    v_cvt_pk_bf16_f32 v35, v54, v55
    v_mfma_f32_16x16x32_bf16 v[172:175], v[44:47], a[104:107], v[172:175]
    v_cvt_pk_bf16_f32 v36, v56, v57
    v_cvt_pk_bf16_f32 v37, v58, v59
    v_mfma_f32_16x16x32_bf16 v[188:191], v[44:47], a[108:111], v[188:191]
    v_cvt_pk_bf16_f32 v38, v60, v61
    v_cvt_pk_bf16_f32 v39, v62, v63
    v_mfma_f32_16x16x32_bf16 v[204:207], v[44:47], a[112:115], v[204:207]
    s_waitcnt vmcnt(8)
    ds_read_b128 a[16:19], v6 offset:4096
    v_mfma_f32_16x16x32_bf16 v[220:223], v[44:47], a[116:119], v[220:223]
    ds_read_b128 a[20:23], v7 offset:4096
    v_cvt_pk_bf16_f32 v26, v28, v29
    v_mfma_f32_16x16x32_bf16 v[236:239], v[44:47], a[120:123], v[236:239]
    ds_read_b128 a[24:27], v8 offset:4096
    v_cvt_pk_bf16_f32 v27, v30, v31
    v_mfma_f32_16x16x32_bf16 v[252:255], v[44:47], a[124:127], v[252:255]
    ds_read_b128 a[28:31], v9 offset:4096
    s_waitcnt lgkmcnt(4)
    v_mfma_f32_16x16x32_bf16 v[128:131], v[32:35], a[128:131], v[128:131]
    v_mfma_f32_16x16x32_bf16 v[144:147], v[32:35], a[132:135], v[144:147]
    ds_write_b128 v17, v[24:27] offset:1024
    v_mfma_f32_16x16x32_bf16 v[160:163], v[32:35], a[136:139], v[160:163]
    v_lshrrev_b32 v26, 2, v1
    v_mfma_f32_16x16x32_bf16 v[176:179], v[32:35], a[140:143], v[176:179]
    v_mfma_f32_16x16x32_bf16 v[192:195], v[32:35], a[144:147], v[192:195]
    v_mfma_f32_16x16x32_bf16 v[208:211], v[32:35], a[148:151], v[208:211]
    s_waitcnt lgkmcnt(1)
    v_lshlrev_b32 v26, 17, v26
    v_mfma_f32_16x16x32_bf16 v[48:51], v[20:23], a[16:19], 0
    v_mfma_f32_16x16x32_bf16 v[52:55], v[20:23], a[20:23], 0
    s_waitcnt lgkmcnt(0)
    s_barrier
    v_mfma_f32_16x16x32_bf16 v[56:59], v[20:23], a[24:27], 0
    v_lshl_add_u32 v26, v2, 6, v26
    v_mfma_f32_16x16x32_bf16 v[60:63], v[20:23], a[28:31], 0
    v_mfma_f32_16x16x32_bf16 v[224:227], v[32:35], a[152:155], v[224:227]
    v_mfma_f32_16x16x32_bf16 v[240:243], v[32:35], a[156:159], v[240:243]
    v_and_b32 v25, 3, v0
    v_mfma_f32_16x16x32_bf16 v[128:131], v[36:39], a[160:163], v[128:131]
    v_cvt_pk_bf16_f32 v40, v48, v49
    v_cvt_pk_bf16_f32 v41, v50, v51
    v_mfma_f32_16x16x32_bf16 v[144:147], v[36:39], a[164:167], v[144:147]
    v_cvt_pk_bf16_f32 v42, v52, v53
    v_cvt_pk_bf16_f32 v43, v54, v55
    v_mfma_f32_16x16x32_bf16 v[160:163], v[36:39], a[168:171], v[160:163]
    v_cvt_pk_bf16_f32 v44, v56, v57
    v_cvt_pk_bf16_f32 v45, v58, v59
    v_mfma_f32_16x16x32_bf16 v[176:179], v[36:39], a[172:175], v[176:179]
    v_cvt_pk_bf16_f32 v46, v60, v61
    v_cvt_pk_bf16_f32 v47, v62, v63
    v_mfma_f32_16x16x32_bf16 v[192:195], v[36:39], a[176:179], v[192:195]
    s_waitcnt vmcnt(4)
    ds_read_b128 a[0:3], v6 offset:8192
    v_mfma_f32_16x16x32_bf16 v[208:211], v[36:39], a[180:183], v[208:211]
    ds_read_b128 a[4:7], v7 offset:8192
    v_add_u32 v24, 155648, v14
    v_mfma_f32_16x16x32_bf16 v[224:227], v[36:39], a[184:187], v[224:227]
    ds_read_b128 a[8:11], v8 offset:8192
    v_lshl_add_u32 v4, v25, 4, v26
    v_mfma_f32_16x16x32_bf16 v[240:243], v[36:39], a[188:191], v[240:243]
    ds_read_b128 a[12:15], v9 offset:8192
    s_lshr_b32 s76, s75, 1
    v_mfma_f32_16x16x32_bf16 v[132:135], v[40:43], a[128:131], v[132:135]
    ds_read_b128 a[224:227], v24 offset:0
    s_lshl_b32 s76, s76, 7
    v_mfma_f32_16x16x32_bf16 v[148:151], v[40:43], a[132:135], v[148:151]
    v_cvt_pk_bf16_f32 v64, v128, v129
    v_cvt_pk_bf16_f32 v65, v130, v131
    v_mfma_f32_16x16x32_bf16 v[164:167], v[40:43], a[136:139], v[164:167]
    ds_read_b128 a[228:231], v24 offset:1024
    v_cvt_pk_bf16_f32 v72, v144, v145
    v_mfma_f32_16x16x32_bf16 v[180:183], v[40:43], a[140:143], v[180:183]
    s_add_u32 s76, s76, s5
    v_cvt_pk_bf16_f32 v73, v146, v147
    v_mfma_f32_16x16x32_bf16 v[196:199], v[40:43], a[144:147], v[196:199]
    v_cvt_pk_bf16_f32 v80, v160, v161
    v_cvt_pk_bf16_f32 v81, v162, v163
    v_mfma_f32_16x16x32_bf16 v[212:215], v[40:43], a[148:151], v[212:215]
    s_waitcnt lgkmcnt(2)
    v_cvt_pk_bf16_f32 v88, v176, v177
    v_mfma_f32_16x16x32_bf16 v[48:51], v[20:23], a[0:3], 0
    s_and_b32 s86, s75, 1
    v_cvt_pk_bf16_f32 v89, v178, v179
    v_mfma_f32_16x16x32_bf16 v[52:55], v[20:23], a[4:7], 0
    v_cvt_pk_bf16_f32 v96, v192, v193
    v_cvt_pk_bf16_f32 v97, v194, v195
    v_mfma_f32_16x16x32_bf16 v[56:59], v[20:23], a[8:11], 0
    ds_read_b128 a[232:235], v24 offset:2048
    v_cvt_pk_bf16_f32 v104, v208, v209
    v_mfma_f32_16x16x32_bf16 v[60:63], v[20:23], a[12:15], 0
    s_lshl1_add_u32 s76, s76, s86
    v_cvt_pk_bf16_f32 v105, v210, v211
    v_mfma_f32_16x16x32_bf16 v[228:231], v[40:43], a[152:155], v[228:231]
    v_cvt_pk_bf16_f32 v112, v224, v225
    v_cvt_pk_bf16_f32 v113, v226, v227
    v_mfma_f32_16x16x32_bf16 v[244:247], v[40:43], a[156:159], v[244:247]
    v_cvt_pk_bf16_f32 v120, v240, v241
    v_cvt_pk_bf16_f32 v121, v242, v243
    v_mfma_f32_16x16x32_bf16 v[132:135], v[44:47], a[160:163], v[132:135]
    v_cvt_pk_bf16_f32 v32, v48, v49
    v_cvt_pk_bf16_f32 v33, v50, v51
    v_mfma_f32_16x16x32_bf16 v[148:151], v[44:47], a[164:167], v[148:151]
    v_cvt_pk_bf16_f32 v34, v52, v53
    v_cvt_pk_bf16_f32 v35, v54, v55
    v_mfma_f32_16x16x32_bf16 v[164:167], v[44:47], a[168:171], v[164:167]
    v_cvt_pk_bf16_f32 v36, v56, v57
    v_cvt_pk_bf16_f32 v37, v58, v59
    v_mfma_f32_16x16x32_bf16 v[180:183], v[44:47], a[172:175], v[180:183]
    v_cvt_pk_bf16_f32 v38, v60, v61
    v_cvt_pk_bf16_f32 v39, v62, v63
    v_mfma_f32_16x16x32_bf16 v[196:199], v[44:47], a[176:179], v[196:199]
    s_waitcnt vmcnt(0)
    ds_read_b128 a[16:19], v6 offset:12288
    v_mfma_f32_16x16x32_bf16 v[212:215], v[44:47], a[180:183], v[212:215]
    ds_read_b128 a[20:23], v7 offset:12288
    s_lshl_b32 s76, s76, 8
    v_mfma_f32_16x16x32_bf16 v[228:231], v[44:47], a[184:187], v[228:231]
    ds_read_b128 a[24:27], v8 offset:12288
    s_add_u32 s76, s76, 8388608
    v_mfma_f32_16x16x32_bf16 v[244:247], v[44:47], a[188:191], v[244:247]
    ds_read_b128 a[28:31], v9 offset:12288
    s_add_u32 s77, s76, 0x80000
    v_mfma_f32_16x16x32_bf16 v[136:139], v[32:35], a[128:131], v[136:139]
    ds_read_b128 a[236:239], v24 offset:3072
    v_mfma_f32_16x16x32_bf16 v[152:155], v[32:35], a[132:135], v[152:155]
    ds_read_b128 a[240:243], v24 offset:4096
    s_add_u32 s78, s76, 0x100000
    v_mfma_f32_16x16x32_bf16 v[168:171], v[32:35], a[136:139], v[168:171]
    v_cvt_pk_bf16_f32 v66, v132, v133
    v_cvt_pk_bf16_f32 v67, v134, v135
    v_mfma_f32_16x16x32_bf16 v[184:187], v[32:35], a[140:143], v[184:187]
    v_cvt_pk_bf16_f32 v74, v148, v149
    v_cvt_pk_bf16_f32 v75, v150, v151
    v_mfma_f32_16x16x32_bf16 v[200:203], v[32:35], a[144:147], v[200:203]
    ds_read_b128 a[244:247], v24 offset:5120
    s_add_u32 s79, s76, 0x180000
    v_mfma_f32_16x16x32_bf16 v[216:219], v[32:35], a[148:151], v[216:219]
    s_waitcnt lgkmcnt(3)
    v_cvt_pk_bf16_f32 v82, v164, v165
    v_mfma_f32_16x16x32_bf16 v[48:51], v[20:23], a[16:19], 0
    v_cvt_pk_bf16_f32 v83, v166, v167
    v_cvt_pk_bf16_f32 v90, v180, v181
    v_mfma_f32_16x16x32_bf16 v[52:55], v[20:23], a[20:23], 0
    s_lshl_b32 s81, s5, 5
    v_cvt_pk_bf16_f32 v91, v182, v183
    v_mfma_f32_16x16x32_bf16 v[56:59], v[20:23], a[24:27], 0
    v_cvt_pk_bf16_f32 v98, v196, v197
    v_cvt_pk_bf16_f32 v99, v198, v199
    v_mfma_f32_16x16x32_bf16 v[60:63], v[20:23], a[28:31], 0
    ds_read_b128 a[248:251], v24 offset:6144
    v_cvt_pk_bf16_f32 v106, v212, v213
    v_mfma_f32_16x16x32_bf16 v[232:235], v[32:35], a[152:155], v[232:235]
    s_add_u32 s81, s81, s6
    v_cvt_pk_bf16_f32 v107, v214, v215
    v_mfma_f32_16x16x32_bf16 v[248:251], v[32:35], a[156:159], v[248:251]
    v_cvt_pk_bf16_f32 v114, v228, v229
    v_cvt_pk_bf16_f32 v115, v230, v231
    v_mfma_f32_16x16x32_bf16 v[136:139], v[36:39], a[160:163], v[136:139]
    v_cvt_pk_bf16_f32 v40, v48, v49
    v_cvt_pk_bf16_f32 v41, v50, v51
    v_mfma_f32_16x16x32_bf16 v[152:155], v[36:39], a[164:167], v[152:155]
    v_cvt_pk_bf16_f32 v42, v52, v53
    v_cvt_pk_bf16_f32 v43, v54, v55
    v_mfma_f32_16x16x32_bf16 v[168:171], v[36:39], a[168:171], v[168:171]
    v_cvt_pk_bf16_f32 v44, v56, v57
    v_cvt_pk_bf16_f32 v45, v58, v59
    v_mfma_f32_16x16x32_bf16 v[184:187], v[36:39], a[172:175], v[184:187]
    v_cvt_pk_bf16_f32 v46, v60, v61
    v_cvt_pk_bf16_f32 v47, v62, v63
    v_mfma_f32_16x16x32_bf16 v[200:203], v[36:39], a[176:179], v[200:203]
    ds_read_b128 a[252:255], v24 offset:7168
    s_lshl_b32 s81, s81, 7
    v_mfma_f32_16x16x32_bf16 v[216:219], v[36:39], a[180:183], v[216:219]
    s_add_u32 s81, s81, 12648448
    v_cvt_pk_bf16_f32 v122, v244, v245
    v_mfma_f32_16x16x32_bf16 v[232:235], v[36:39], a[184:187], v[232:235]
    v_cvt_pk_bf16_f32 v123, v246, v247
    v_mfma_f32_16x16x32_bf16 v[248:251], v[36:39], a[188:191], v[248:251]
    v_mfma_f32_16x16x32_bf16 v[140:143], v[40:43], a[128:131], v[140:143]
    v_mfma_f32_16x16x32_bf16 v[156:159], v[40:43], a[132:135], v[156:159]
    v_cvt_pk_bf16_f32 v68, v136, v137
    v_cvt_pk_bf16_f32 v69, v138, v139
    v_mfma_f32_16x16x32_bf16 v[172:175], v[40:43], a[136:139], v[172:175]
    v_cvt_pk_bf16_f32 v76, v152, v153
    v_cvt_pk_bf16_f32 v77, v154, v155
    v_mfma_f32_16x16x32_bf16 v[188:191], v[40:43], a[140:143], v[188:191]
    v_cvt_pk_bf16_f32 v84, v168, v169
    v_cvt_pk_bf16_f32 v85, v170, v171
    v_mfma_f32_16x16x32_bf16 v[140:143], v[44:47], a[160:163], v[140:143]
    v_cvt_pk_bf16_f32 v92, v184, v185
    v_cvt_pk_bf16_f32 v93, v186, v187
    v_mfma_f32_16x16x32_bf16 v[156:159], v[44:47], a[164:167], v[156:159]
    v_cvt_pk_bf16_f32 v100, v200, v201
    v_cvt_pk_bf16_f32 v101, v202, v203
    v_mfma_f32_16x16x32_bf16 v[172:175], v[44:47], a[168:171], v[172:175]
    v_cvt_pk_bf16_f32 v108, v216, v217
    v_cvt_pk_bf16_f32 v109, v218, v219
    v_mfma_f32_16x16x32_bf16 v[188:191], v[44:47], a[172:175], v[188:191]
    v_cvt_pk_bf16_f32 v116, v232, v233
    v_cvt_pk_bf16_f32 v117, v234, v235
    v_mfma_f32_16x16x32_bf16 v[204:207], v[40:43], a[144:147], v[204:207]
    v_cvt_pk_bf16_f32 v124, v248, v249
    v_cvt_pk_bf16_f32 v125, v250, v251
    v_mfma_f32_16x16x32_bf16 v[220:223], v[40:43], a[148:151], v[220:223]
    v_mfma_f32_16x16x32_bf16 v[236:239], v[40:43], a[152:155], v[236:239]
    v_cvt_pk_bf16_f32 v70, v140, v141
    v_cvt_pk_bf16_f32 v71, v142, v143
    v_mfma_f32_16x16x32_bf16 v[252:255], v[40:43], a[156:159], v[252:255]
    v_cvt_pk_bf16_f32 v78, v156, v157
    v_cvt_pk_bf16_f32 v79, v158, v159
    v_mfma_f32_16x16x32_bf16 v[204:207], v[44:47], a[176:179], v[204:207]
    v_cvt_pk_bf16_f32 v86, v172, v173
    v_cvt_pk_bf16_f32 v87, v174, v175
    v_mfma_f32_16x16x32_bf16 v[220:223], v[44:47], a[180:183], v[220:223]
    v_cvt_pk_bf16_f32 v94, v188, v189
    v_cvt_pk_bf16_f32 v95, v190, v191
    v_mfma_f32_16x16x32_bf16 v[236:239], v[44:47], a[184:187], v[236:239]
    v_mfma_f32_16x16x32_bf16 v[252:255], v[44:47], a[188:191], v[252:255]
    v_mfma_f32_16x16x32_bf16 v[128:131], v[64:67], a[224:227], 0
    v_mfma_f32_16x16x32_bf16 v[132:135], v[64:67], a[232:235], 0
    s_waitcnt lgkmcnt(3)
    v_mfma_f32_16x16x32_bf16 v[136:139], v[64:67], a[240:243], 0
    s_waitcnt lgkmcnt(1)
    v_mfma_f32_16x16x32_bf16 v[140:143], v[64:67], a[248:251], 0
    v_cvt_pk_bf16_f32 v102, v204, v205
    v_cvt_pk_bf16_f32 v103, v206, v207
    v_mfma_f32_16x16x32_bf16 v[128:131], v[68:71], a[228:231], v[128:131]
    v_cvt_pk_bf16_f32 v110, v220, v221
    v_cvt_pk_bf16_f32 v111, v222, v223
    v_mfma_f32_16x16x32_bf16 v[132:135], v[68:71], a[236:239], v[132:135]
    v_cvt_pk_bf16_f32 v118, v236, v237
    v_cvt_pk_bf16_f32 v119, v238, v239
    v_mfma_f32_16x16x32_bf16 v[136:139], v[68:71], a[244:247], v[136:139]
    v_cvt_pk_bf16_f32 v126, v252, v253
    v_cvt_pk_bf16_f32 v127, v254, v255
    s_waitcnt lgkmcnt(0)
    v_mfma_f32_16x16x32_bf16 v[140:143], v[68:71], a[252:255], v[140:143]
    v_mfma_f32_16x16x32_bf16 v[144:147], v[72:75], a[224:227], 0
    v_min_u32 v17, 49, v0
    v_mfma_f32_16x16x32_bf16 v[148:151], v[72:75], a[232:235], 0
    v_mfma_f32_16x16x32_bf16 v[152:155], v[72:75], a[240:243], 0
    v_lshlrev_b32 v17, 2, v17
    v_mfma_f32_16x16x32_bf16 v[156:159], v[72:75], a[248:251], 0
    v_mfma_f32_16x16x32_bf16 v[144:147], v[76:79], a[228:231], v[144:147]
    v_mfma_f32_16x16x32_bf16 v[148:151], v[76:79], a[236:239], v[148:151]
    buffer_load_dword v16, v17, s[44:47], 0 offen sc1
    v_mfma_f32_16x16x32_bf16 v[152:155], v[76:79], a[244:247], v[152:155]
    v_mfma_f32_16x16x32_bf16 v[156:159], v[76:79], a[252:255], v[156:159]
    v_mfma_f32_16x16x32_bf16 v[160:163], v[80:83], a[224:227], 0
    v_mfma_f32_16x16x32_bf16 v[164:167], v[80:83], a[232:235], 0
    v_cvt_pk_bf16_f32 v32, v128, v129
    v_cvt_pk_bf16_f32 v33, v130, v131
    v_mfma_f32_16x16x32_bf16 v[168:171], v[80:83], a[240:243], 0
    v_cvt_pk_bf16_f32 v34, v144, v145
    v_cvt_pk_bf16_f32 v35, v146, v147
    v_mfma_f32_16x16x32_bf16 v[172:175], v[80:83], a[248:251], 0
    buffer_store_dwordx4 v[32:35], v4, s[24:27], s76 offen sc1
    s_add_u32 s76, s76, 16384
    v_mfma_f32_16x16x32_bf16 v[160:163], v[84:87], a[228:231], v[160:163]
    v_cvt_pk_bf16_f32 v36, v132, v133
    v_cvt_pk_bf16_f32 v37, v134, v135
    v_mfma_f32_16x16x32_bf16 v[164:167], v[84:87], a[236:239], v[164:167]
    v_cvt_pk_bf16_f32 v38, v148, v149
    v_cvt_pk_bf16_f32 v39, v150, v151
    v_mfma_f32_16x16x32_bf16 v[168:171], v[84:87], a[244:247], v[168:171]
    buffer_store_dwordx4 v[36:39], v4, s[24:27], s77 offen sc1
    s_add_u32 s77, s77, 16384
    v_mfma_f32_16x16x32_bf16 v[172:175], v[84:87], a[252:255], v[172:175]
    v_cvt_pk_bf16_f32 v40, v136, v137
    v_cvt_pk_bf16_f32 v41, v138, v139
    v_mfma_f32_16x16x32_bf16 v[176:179], v[88:91], a[224:227], 0
    v_cvt_pk_bf16_f32 v42, v152, v153
    v_cvt_pk_bf16_f32 v43, v154, v155
    v_mfma_f32_16x16x32_bf16 v[180:183], v[88:91], a[232:235], 0
    buffer_store_dwordx4 v[40:43], v4, s[24:27], s78 offen sc1
    s_add_u32 s78, s78, 16384
    v_mfma_f32_16x16x32_bf16 v[184:187], v[88:91], a[240:243], 0
    v_cvt_pk_bf16_f32 v44, v140, v141
    v_cvt_pk_bf16_f32 v45, v142, v143
    v_mfma_f32_16x16x32_bf16 v[188:191], v[88:91], a[248:251], 0
    v_cvt_pk_bf16_f32 v46, v156, v157
    v_cvt_pk_bf16_f32 v47, v158, v159
    v_mfma_f32_16x16x32_bf16 v[176:179], v[92:95], a[228:231], v[176:179]
    buffer_store_dwordx4 v[44:47], v4, s[24:27], s79 offen sc1
    s_add_u32 s79, s79, 16384
    v_mfma_f32_16x16x32_bf16 v[180:183], v[92:95], a[236:239], v[180:183]
    v_mfma_f32_16x16x32_bf16 v[184:187], v[92:95], a[244:247], v[184:187]
    v_mfma_f32_16x16x32_bf16 v[188:191], v[92:95], a[252:255], v[188:191]
    v_mfma_f32_16x16x32_bf16 v[192:195], v[96:99], a[224:227], 0
    v_mfma_f32_16x16x32_bf16 v[196:199], v[96:99], a[232:235], 0
    v_cvt_pk_bf16_f32 v48, v160, v161
    v_cvt_pk_bf16_f32 v49, v162, v163
    v_mfma_f32_16x16x32_bf16 v[200:203], v[96:99], a[240:243], 0
    v_cvt_pk_bf16_f32 v50, v176, v177
    v_cvt_pk_bf16_f32 v51, v178, v179
    v_mfma_f32_16x16x32_bf16 v[204:207], v[96:99], a[248:251], 0
    buffer_store_dwordx4 v[48:51], v4, s[24:27], s76 offen sc1
    s_add_u32 s76, s76, 16384
    v_mfma_f32_16x16x32_bf16 v[192:195], v[100:103], a[228:231], v[192:195]
    v_cvt_pk_bf16_f32 v52, v164, v165
    v_cvt_pk_bf16_f32 v53, v166, v167
    v_mfma_f32_16x16x32_bf16 v[196:199], v[100:103], a[236:239], v[196:199]
    v_cvt_pk_bf16_f32 v54, v180, v181
    v_cvt_pk_bf16_f32 v55, v182, v183
    v_mfma_f32_16x16x32_bf16 v[200:203], v[100:103], a[244:247], v[200:203]
    buffer_store_dwordx4 v[52:55], v4, s[24:27], s77 offen sc1
    s_add_u32 s77, s77, 16384
    v_mfma_f32_16x16x32_bf16 v[204:207], v[100:103], a[252:255], v[204:207]
    v_cvt_pk_bf16_f32 v56, v168, v169
    v_cvt_pk_bf16_f32 v57, v170, v171
    v_mfma_f32_16x16x32_bf16 v[208:211], v[104:107], a[224:227], 0
    v_cvt_pk_bf16_f32 v58, v184, v185
    v_cvt_pk_bf16_f32 v59, v186, v187
    v_mfma_f32_16x16x32_bf16 v[212:215], v[104:107], a[232:235], 0
    buffer_store_dwordx4 v[56:59], v4, s[24:27], s78 offen sc1
    s_add_u32 s78, s78, 16384
    v_mfma_f32_16x16x32_bf16 v[216:219], v[104:107], a[240:243], 0
    v_cvt_pk_bf16_f32 v60, v172, v173
    v_cvt_pk_bf16_f32 v61, v174, v175
    v_mfma_f32_16x16x32_bf16 v[220:223], v[104:107], a[248:251], 0
    v_cvt_pk_bf16_f32 v62, v188, v189
    v_cvt_pk_bf16_f32 v63, v190, v191
    v_mfma_f32_16x16x32_bf16 v[208:211], v[108:111], a[228:231], v[208:211]
    buffer_store_dwordx4 v[60:63], v4, s[24:27], s79 offen sc1
    s_add_u32 s79, s79, 16384
    v_mfma_f32_16x16x32_bf16 v[212:215], v[108:111], a[236:239], v[212:215]
    v_mfma_f32_16x16x32_bf16 v[216:219], v[108:111], a[244:247], v[216:219]
    v_mfma_f32_16x16x32_bf16 v[220:223], v[108:111], a[252:255], v[220:223]
    v_mfma_f32_16x16x32_bf16 v[224:227], v[112:115], a[224:227], 0
    v_mfma_f32_16x16x32_bf16 v[228:231], v[112:115], a[232:235], 0
    v_cvt_pk_bf16_f32 v32, v192, v193
    v_cvt_pk_bf16_f32 v33, v194, v195
    v_mfma_f32_16x16x32_bf16 v[232:235], v[112:115], a[240:243], 0
    v_cvt_pk_bf16_f32 v34, v208, v209
    v_cvt_pk_bf16_f32 v35, v210, v211
    v_mfma_f32_16x16x32_bf16 v[236:239], v[112:115], a[248:251], 0
    buffer_store_dwordx4 v[32:35], v4, s[24:27], s76 offen sc1
    s_add_u32 s76, s76, 16384
    v_mfma_f32_16x16x32_bf16 v[224:227], v[116:119], a[228:231], v[224:227]
    v_cvt_pk_bf16_f32 v36, v196, v197
    v_cvt_pk_bf16_f32 v37, v198, v199
    v_mfma_f32_16x16x32_bf16 v[228:231], v[116:119], a[236:239], v[228:231]
    v_cvt_pk_bf16_f32 v38, v212, v213
    v_cvt_pk_bf16_f32 v39, v214, v215
    v_mfma_f32_16x16x32_bf16 v[232:235], v[116:119], a[244:247], v[232:235]
    buffer_store_dwordx4 v[36:39], v4, s[24:27], s77 offen sc1
    s_add_u32 s77, s77, 16384
    v_mfma_f32_16x16x32_bf16 v[236:239], v[116:119], a[252:255], v[236:239]
    v_cvt_pk_bf16_f32 v40, v200, v201
    v_cvt_pk_bf16_f32 v41, v202, v203
    v_mfma_f32_16x16x32_bf16 v[240:243], v[120:123], a[224:227], 0
    v_cvt_pk_bf16_f32 v42, v216, v217
    v_cvt_pk_bf16_f32 v43, v218, v219
    v_mfma_f32_16x16x32_bf16 v[244:247], v[120:123], a[232:235], 0
    buffer_store_dwordx4 v[40:43], v4, s[24:27], s78 offen sc1
    s_add_u32 s78, s78, 16384
    v_mfma_f32_16x16x32_bf16 v[248:251], v[120:123], a[240:243], 0
    v_cvt_pk_bf16_f32 v44, v204, v205
    v_cvt_pk_bf16_f32 v45, v206, v207
    v_mfma_f32_16x16x32_bf16 v[252:255], v[120:123], a[248:251], 0
    v_cvt_pk_bf16_f32 v46, v220, v221
    v_cvt_pk_bf16_f32 v47, v222, v223
    v_mfma_f32_16x16x32_bf16 v[240:243], v[124:127], a[228:231], v[240:243]
    buffer_store_dwordx4 v[44:47], v4, s[24:27], s79 offen sc1
    s_add_u32 s79, s79, 16384
    v_mfma_f32_16x16x32_bf16 v[244:247], v[124:127], a[236:239], v[244:247]
    v_mfma_f32_16x16x32_bf16 v[248:251], v[124:127], a[244:247], v[248:251]
    v_mfma_f32_16x16x32_bf16 v[252:255], v[124:127], a[252:255], v[252:255]
    v_cvt_pk_bf16_f32 v48, v224, v225
    v_cvt_pk_bf16_f32 v49, v226, v227
    s_nop 0
    v_cvt_pk_bf16_f32 v50, v240, v241
    v_cvt_pk_bf16_f32 v51, v242, v243
    buffer_store_dwordx4 v[48:51], v4, s[24:27], s76 offen sc1
    v_cvt_pk_bf16_f32 v52, v228, v229
    v_cvt_pk_bf16_f32 v53, v230, v231
    v_cvt_pk_bf16_f32 v54, v244, v245
    v_cvt_pk_bf16_f32 v55, v246, v247
    buffer_store_dwordx4 v[52:55], v4, s[24:27], s77 offen sc1
    v_cvt_pk_bf16_f32 v56, v232, v233
    v_cvt_pk_bf16_f32 v57, v234, v235
    v_cvt_pk_bf16_f32 v58, v248, v249
    v_cvt_pk_bf16_f32 v59, v250, v251
    buffer_store_dwordx4 v[56:59], v4, s[24:27], s78 offen sc1
    v_cvt_pk_bf16_f32 v60, v236, v237
    v_cvt_pk_bf16_f32 v61, v238, v239
    v_cvt_pk_bf16_f32 v62, v252, v253
    v_cvt_pk_bf16_f32 v63, v254, v255
    buffer_store_dwordx4 v[60:63], v4, s[24:27], s79 offen sc1
    s_waitcnt vmcnt(16)
    v_cmp_ne_u32 vcc, 1, v16
    s_cbranch_vccz Lok_18
    s_mov_b32 s3, 0
Lspin_19:
    buffer_load_dword v16, v17, s[44:47], 0 offen sc1
    s_waitcnt vmcnt(0)
    v_cmp_ne_u32 vcc, 1, v16
    s_add_u32 s3, s3, 1
    s_cmp_lt_u32 s3, 300000
    s_cbranch_vccz Lok_18
    s_cbranch_scc1 Lspin_19
Lok_18:
    v_lshrrev_b32 v24, 3, v0
    v_bfe_u32 v25, v0, 1, 2
    v_xor_b32 v25, v25, v2
    v_lshlrev_b32 v25, 5, v25
    v_lshl_add_u32 v25, v24, 10, v25
    v_and_b32 v24, 1, v0
    v_lshl_add_u32 v15, v24, 4, v25
    v_add_u32 v29, 7168, v15
    v_add_u32 v30, 7168, v29
    v_add_u32 v31, 7168, v30
    v_bfe_u32 v24, v0, 2, 3
    v_lshrrev_b32 v25, 5, v0
    v_lshlrev_b32 v25, 10, v25
    v_lshl_add_u32 v25, v24, 7, v25
    v_and_b32 v26, 3, v0
    v_lshl_add_u32 v25, v26, 3, v25
    v_add_u32 v25, s93, v25
    v_lshrrev_b32 v24, 1, v24
    v_xor_b32 v24, s4, v24
    v_lshl_add_u32 v10, v24, 5, v25
    v_xor_b32 v11, 32, v10
    v_xor_b32 v12, 64, v10
    v_xor_b32 v13, 0x60, v10
    s_and_b32 s86, s74, 4
    s_cselect_b32 s86, 28, 0
    s_mul_i32 s7, s4, 7
    s_add_u32 s7, s7, s86
    s_lshl_b32 s70, s7, 8
    s_add_u32 s70, s70, s73
    s_lshl_b32 s70, s70, 7
    s_and_b32 s71, s7, 1
    s_lshl_b32 s71, s71, 15
    s_lshl_b32 s86, s4, 11
    s_add_u32 s86, s86, 131072
    v_add_u32 v149, s86, v14
    v_cvt_f32_u32 v148, v2
    v_mov_b32 v146, 0x3e800000
    s_cmp_eq_u32 s74, 0
    s_cselect_b64 s[96:97], -1, 0
    s_cselect_b32 s87, 32, 64
    s_and_b32 s86, s4, 1
    s_lshl_b32 s86, s86, 4
    v_add_u32 v136, s86, v1
    v_mul_u32_u24 v137, s87, v136
    v_add_u32 v137, s74, v137
    s_lshr_b32 s88, s4, 1
    s_cselect_b64 s[98:99], -1, 0
    v_cmp_eq_u32 vcc, 0, v137
    v_cvt_f32_u32 v138, s88
    v_mul_f32 v138, 0xbe800000, v138
    v_cvt_f32_u32 v139, v137
    v_mul_f32 v139, 0x3a000000, v139
    s_and_b64 vcc, vcc, s[98:99]
    v_cndmask_b32 v139, v139, 0.5, vcc
    v_cndmask_b32 v138, v138, 0, vcc
    v_add_f32 v147, v148, v148
    v_fma_f32 v140, v139, v147, v138
    v_add_f32 v141, v146, v140
    v_cndmask_b32 v141, v141, v140, s[96:97]
    s_and_b32 vcc_lo, s96, 0xaaaaaaaa
    s_mov_b32 vcc_hi, vcc_lo
    s_andn2_b64 s[98:99], s[96:97], vcc
    v_cndmask_b32 v142, v139, 0, vcc
    v_cndmask_b32 v140, v140, v146, vcc
    v_cndmask_b32 v143, v139, 0, s[98:99]
    v_cndmask_b32 v141, v141, v146, s[98:99]
    v_fmamk_f32 v130, v142, 0x3f800000, v140
    v_fmamk_f32 v131, v143, 0x3f800000, v141
    v_fmamk_f32 v132, v142, 0x41000000, v140
    v_fmamk_f32 v133, v143, 0x41000000, v141
    v_fmamk_f32 v134, v142, 0x41100000, v140
    v_fmamk_f32 v135, v143, 0x41100000, v141
    v_cos_f32 v128, v140
    v_cos_f32 v129, v141
    v_cos_f32 v130, v130
    v_cos_f32 v131, v131
    v_cos_f32 v132, v132
    v_cos_f32 v133, v133
    v_cos_f32 v134, v134
    v_cos_f32 v135, v135
    v_cvt_pk_bf16_f32 v128, v128, v129
    v_cvt_pk_bf16_f32 v129, v130, v131
    v_cvt_pk_bf16_f32 v130, v132, v133
    v_cvt_pk_bf16_f32 v131, v134, v135
    ds_write_b128 v149, v[128:131] offset:0
    v_fmamk_f32 v128, v142, 0x41800000, v140
    v_fmamk_f32 v129, v143, 0x41800000, v141
    v_fmamk_f32 v130, v142, 0x41880000, v140
    v_fmamk_f32 v131, v143, 0x41880000, v141
    v_fmamk_f32 v132, v142, 0x41c00000, v140
    v_fmamk_f32 v133, v143, 0x41c00000, v141
    v_fmamk_f32 v134, v142, 0x41c80000, v140
    v_fmamk_f32 v135, v143, 0x41c80000, v141
    v_cos_f32 v128, v128
    v_cos_f32 v129, v129
    v_cos_f32 v130, v130
    v_cos_f32 v131, v131
    v_cos_f32 v132, v132
    v_cos_f32 v133, v133
    v_cos_f32 v134, v134
    v_cos_f32 v135, v135
    v_cvt_pk_bf16_f32 v128, v128, v129
    v_cvt_pk_bf16_f32 v129, v130, v131
    v_cvt_pk_bf16_f32 v130, v132, v133
    v_cvt_pk_bf16_f32 v131, v134, v135
    ds_write_b128 v149, v[128:131] offset:1024
    v_mov_b32 v24, 1
    s_waitcnt vmcnt(0)
    s_mov_b64 exec, 1
    buffer_store_dword v24, v0, s[24:27], s81 offen sc1
    s_mov_b64 exec, -1
    s_cmp_eq_u32 s74, 0
    s_cselect_b32 s87, 32, 64
    s_cselect_b64 s[90:91], 0xffff, 0
    s_and_b32 s86, s4, 1
    s_lshl_b32 s86, s86, 4
    v_lshrrev_b32 v27, 2, v0
    v_add_u32 v27, s86, v27
    v_mul_u32_u24 v27, s87, v27
    v_add_u32 v27, s74, v27
    v_cmp_eq_u32 vcc, 0, v27
    v_sub_u32 v28, 0x800, v27
    v_mov_b32 v26, 0x400
    s_cmp_lt_u32 s4, 2
    s_cselect_b64 s[96:97], -1, 0
    v_cndmask_b32 v28, v28, v26, vcc
    v_cndmask_b32 v27, v28, v27, s[96:97]
    v_mul_u32_u24 v27, 514, v27
    v_and_b32 v28, 48, v14
    s_lshl_b32 s88, s0, 6
    s_sub_u32 s88, s88, s1
    v_add3_u32 v20, v28, v27, s88
    s_cmp_eq_u32 s1, 0
    s_cbranch_scc1 Lev_20
    buffer_load_dword v40, v20, s[32:35], 0 offen offset:16
Lev_20:
    buffer_load_dwordx4 v[32:35], v20, s[32:35], 0 offen
    buffer_load_ushort v42, v27, s[32:35], 0 offen offset:512
    s_cmp_eq_u32 s1, 0
    s_cbranch_scc1 Lev_21
    buffer_load_dword v41, v20, s[36:39], 0 offen offset:16
Lev_21:
    buffer_load_dwordx4 v[36:39], v20, s[36:39], 0 offen
    buffer_load_ushort v43, v27, s[36:39], 0 offen offset:512
    s_lshl_b32 s86, s4, 11
    s_add_u32 s86, s86, 139264
    v_add_u32 v181, s86, v14
    v_cvt_f32_u32 v180, v2
    v_mov_b32 v178, 0x3e800000
    s_cmp_eq_u32 s74, 0
    s_cselect_b64 s[96:97], -1, 0
    s_cselect_b32 s87, 32, 64
    s_and_b32 vcc_lo, s96, 0xaaaaaaaa
    s_mov_b32 vcc_hi, vcc_lo
    s_andn2_b64 s[98:99], s[96:97], vcc
    s_lshl_b32 s86, s4, 3
    v_lshrrev_b32 v168, 1, v1
    v_add_u32 v168, s86, v168
    v_cvt_f32_u32 v169, v168
    v_mul_f32 v169, 0x3a000000, v169
    v_cvt_f32_u32 v170, s87
    v_mul_f32 v171, v169, v170
    v_cvt_f32_u32 v170, s74
    v_mul_f32 v172, v169, v170
    v_and_b32 v168, 1, v0
    v_cvt_f32_u32 v170, v168
    v_cndmask_b32 v170, v170, 0, s[96:97]
    v_fmac_f32 v172, v178, v170
    v_mul_f32 v170, 4.0, v180
    v_fmac_f32 v172, v171, v170
    v_sub_f32 v173, v172, v178
    v_cndmask_b32 v175, v171, 0, s[98:99]
    v_cndmask_b32 v176, v172, v178, s[98:99]
    v_cndmask_b32 v177, v173, v178, s[98:99]
    s_and_b64 s[98:99], s[98:99], 0xffff
    v_cndmask_b32 v174, v171, 0, vcc
    v_cndmask_b32 v172, v172, v178, vcc
    v_cndmask_b32 v173, v173, v178, vcc
    v_mul_f32 v169, 0x44800000, v169
    v_cndmask_b32 v169, v173, v169, s[98:99]
    v_fmamk_f32 v161, v175, 0x3f800000, v176
    v_fmamk_f32 v162, v174, 0x40000000, v172
    v_fmamk_f32 v163, v175, 0x40400000, v176
    v_fmamk_f32 v164, v174, 0x41800000, v172
    v_fmamk_f32 v165, v175, 0x41880000, v176
    v_fmamk_f32 v166, v174, 0x41900000, v172
    v_fmamk_f32 v167, v175, 0x41980000, v176
    v_cos_f32 v160, v172
    v_cos_f32 v161, v161
    v_cos_f32 v162, v162
    v_cos_f32 v163, v163
    v_cos_f32 v164, v164
    v_cos_f32 v165, v165
    v_cos_f32 v166, v166
    v_cos_f32 v167, v167
    v_cvt_pk_bf16_f32 v160, v160, v161
    v_cvt_pk_bf16_f32 v161, v162, v163
    v_cvt_pk_bf16_f32 v162, v164, v165
    v_cvt_pk_bf16_f32 v163, v166, v167
    ds_write_b128 v181, v[160:163] offset:0
    v_fmamk_f32 v161, v175, 0x3f800000, v177
    v_fmamk_f32 v162, v174, 0x40000000, v173
    v_fmamk_f32 v163, v175, 0x40400000, v177
    v_fmamk_f32 v164, v174, 0x41800000, v173
    v_fmamk_f32 v165, v175, 0x41880000, v177
    v_fmamk_f32 v166, v174, 0x41900000, v173
    v_fmamk_f32 v167, v175, 0x41980000, v177
    v_cos_f32 v160, v169
    v_cos_f32 v161, v161
    v_cos_f32 v162, v162
    v_cos_f32 v163, v163
    v_cos_f32 v164, v164
    v_cos_f32 v165, v165
    v_cos_f32 v166, v166
    v_cos_f32 v167, v167
    v_cvt_pk_bf16_f32 v160, v160, v161
    v_cvt_pk_bf16_f32 v161, v162, v163
    v_cvt_pk_bf16_f32 v162, v164, v165
    v_cvt_pk_bf16_f32 v163, v166, v167
    ds_write_b128 v181, v[160:163] offset:1024
    s_waitcnt lgkmcnt(0)
    s_barrier
    v_add_u32 v19, 131072, v14
    s_add_u32 s85, s70, 0
    ds_read_b128 a[224:227], v19 offset:0
    ds_read_b128 a[228:231], v19 offset:1024
    ds_read_b128 a[232:235], v19 offset:2048
    ds_read_b128 a[236:239], v19 offset:3072
    ds_read_b128 a[240:243], v19 offset:4096
    s_add_u32 m0, s93, 0
    ds_read_b128 a[244:247], v19 offset:5120
    ds_read_b128 a[248:251], v19 offset:6144
    ds_read_b128 a[252:255], v19 offset:7168
    ds_read_b128 a[192:195], v19 offset:8192
    ds_read_b128 a[196:199], v19 offset:9216
    ds_read_b128 a[200:203], v19 offset:10240
    buffer_load_dwordx4 v15, s[20:23], s85 offen offset:0 lds
    ds_read_b128 a[204:207], v19 offset:11264
    ds_read_b128 a[208:211], v19 offset:12288
    ds_read_b128 a[212:215], v19 offset:13312
    ds_read_b128 a[216:219], v19 offset:14336
    ds_read_b128 a[220:223], v19 offset:15360
    buffer_load_dwordx4 v29, s[20:23], s85 offen offset:1024 lds
    s_lshr_b32 s86, s0, 2
    s_lshl_b32 s86, s86, 8
    s_lshl_b32 s87, s4, 15
    s_add_u32 s86, s86, s87
    s_add_u32 s82, s86, 12652032
    v_lshrrev_b32 v17, 3, v0
    buffer_load_dwordx4 v30, s[20:23], s85 offen offset:2048 lds
    v_lshlrev_b32 v17, 12, v17
    v_bfe_u32 v28, v0, 2, 1
    v_lshl_add_u32 v17, v28, 7, v17
    s_lshl_b32 s76, s0, 1
    s_lshr_b32 s87, s4, 1
    buffer_load_dwordx4 v31, s[20:23], s85 offen offset:3072 lds
    s_add_u32 s76, s76, s87
    s_lshr_b32 s87, s74, 3
    s_lshl_b32 s87, s87, 4
    s_add_u32 s76, s76, s87
    s_lshl_b32 s76, s76, 3
    s_and_b32 s87, s74, 7
    s_add_u32 s85, s70, 32768
    s_add_u32 s76, s76, s87
    s_lshr_b32 s87, s74, 2
    s_xor_b32 s87, s87, s4
    s_and_b32 s87, s87, 1
    s_lshl1_add_u32 s76, s76, s87
    s_add_u32 m0, s93, 4096
    s_lshl_b32 s76, s76, 6
    s_add_u32 s76, s76, 10485760
    s_add_u32 s77, s76, 0x80000
    s_add_u32 s78, s76, 0x100000
    s_add_u32 s79, s76, 0x180000
    v_lshrrev_b32 v24, 1, v1
    buffer_load_dwordx4 v15, s[20:23], s85 offen offset:0 lds
    v_lshlrev_b32 v26, 16, v24
    v_and_b32 v25, 1, v0
    v_lshl_add_u32 v26, v25, 5, v26
    v_and_b32 v28, 1, v2
    v_lshl_add_u32 v26, v28, 19, v26
    buffer_load_dwordx4 v29, s[20:23], s85 offen offset:1024 lds
    v_lshrrev_b32 v28, 1, v2
    v_lshl_add_u32 v4, v28, 4, v26
    s_lshl2_add_u32 s86, s0, s4
    v_and_or_b32 v28, v0, 7, s86
    v_cmp_eq_u32 vcc, 0, v28
    v_bfe_u32 v28, v0, 3, 1
    buffer_load_dwordx4 v30, s[20:23], s85 offen offset:2048 lds
    v_xor_b32 v28, 1, v28
    v_lshl_or_b32 v18, v28, 31, 1.0
    s_lshl_b32 s86, s4, 5
    s_add_u32 s86, s86, 155648
    v_lshrrev_b32 v24, 3, v0
    buffer_load_dwordx4 v31, s[20:23], s85 offen offset:3072 lds
    v_cndmask_b32 v18, v18, 0, vcc
    v_lshl_add_u32 v19, v24, 8, s86
    v_lshl_add_u32 v19, v25, 7, v19
    v_bfe_u32 v25, v0, 1, 2
    v_lshl_add_u32 v19, v25, 3, v19
    s_waitcnt lgkmcnt(0)
    s_barrier
    s_lshl3_add_u32 s86, s75, s73
    s_lshl_b32 s86, s86, 1
    v_lshrrev_b32 v25, 5, v0
    v_add_u32 v236, s86, v25
    v_and_b32 v25, 3, v236
    v_lshrrev_b32 v26, 2, v236
    v_lshl_add_u32 v25, v25, 4, v26
    v_and_b32 v233, 0x1f0, v14
    v_lshl_add_u32 v232, v25, 15, v233
    v_lshl_add_u32 v232, s5, 10, v232
    buffer_load_dwordx4 v[216:219], v232, s[8:11], 0 offen offset:2048
    buffer_load_dwordx4 v[220:223], v232, s[8:11], 0 offen offset:2560
    buffer_load_dwordx4 v[224:227], v233, s[40:43], 0 offen
    buffer_load_dwordx4 v[228:231], v233, s[40:43], 0 offen offset:512
    s_mul_i32 s86, s4, 1280
    s_add_u32 s86, s86, 131072
    v_lshrrev_b32 v27, 2, v0
    v_lshl_add_u32 v28, v27, 4, v14
    v_add_u32 v28, s86, v28
    s_mov_b32 s88, 0x05040100
    s_mov_b32 s89, 0x07060302
    s_mov_b32 s96, 0x11111111
    s_mov_b32 s97, 0x11111111
    s_waitcnt vmcnt(12)
    v_alignbyte_b32 v32, v33, v32, s1
    v_alignbyte_b32 v33, v34, v33, s1
    v_alignbyte_b32 v34, v35, v34, s1
    v_alignbyte_b32 v35, v40, v35, s1
    v_perm_b32 v192, v33, v32, s88
    v_perm_b32 v193, v35, v34, s88
    v_perm_b32 v194, v33, v32, s89
    v_perm_b32 v195, v35, v34, s89
    ds_write_b128 v28, v[192:195] offset:0
    v_and_or_b32 v192, v192, s92, v42
    v_alignbyte_b32 v36, v37, v36, s1
    v_alignbyte_b32 v37, v38, v37, s1
    v_alignbyte_b32 v38, v39, v38, s1
    v_alignbyte_b32 v39, v41, v39, s1
    v_perm_b32 v196, v37, v36, s88
    v_perm_b32 v197, v39, v38, s88
    v_perm_b32 v198, v37, v36, s89
    v_perm_b32 v199, v39, v38, s89
    ds_write_b128 v28, v[196:199] offset:5120
    v_and_or_b32 v196, v196, s92, v43
    s_mov_b64 exec, s[96:97]
    ds_write_b64 v28, v[192:193] offset:64
    ds_write_b64 v28, v[196:197] offset:5184
    s_mov_b64 exec, -1
    buffer_load_dword v16, v17, s[24:27], s82 offen sc1
    s_or_b32 s87, s4, s0
    s_cselect_b32 s87, 4, 2
    s_lshl_b32 s86, s4, 4
    v_and_b32 v26, 3, v0
    v_cmp_eq_u32 vcc, s87, v26
    v_and_b32 v28, 1, v0
    v_lshl_add_u32 v28, v28, 3, s86
    v_lshrrev_b32 v27, 2, v0
    v_mul_u32_u24 v27, 80, v27
    v_cndmask_b32 v28, v28, 64, vcc
    s_mov_b32 s86, 131072
    v_add3_u32 v27, v27, v28, s86
    s_waitcnt lgkmcnt(0)
    s_barrier
    ds_read_b64_tr_b16 v[192:193], v27 offset:0
    ds_read_b64_tr_b16 v[194:195], v27 offset:2560
    ds_read_b64_tr_b16 v[196:197], v27 offset:5120
    ds_read_b64_tr_b16 v[198:199], v27 offset:7680
    ds_read_b64_tr_b16 v[200:201], v27 offset:1280
    ds_read_b64_tr_b16 v[202:203], v27 offset:3840
    ds_read_b64_tr_b16 v[204:205], v27 offset:6400
    ds_read_b64_tr_b16 v[206:207], v27 offset:8960
    s_lshl_b32 s86, s4, 11
    s_add_u32 s85, s70, 65536
    s_add_u32 s86, s86, 147456
    v_add_u32 v181, s86, v14
    v_cvt_f32_u32 v180, v2
    v_mov_b32 v178, 0x3e800000
    s_lshl_b32 s86, s4, 4
    v_add_u32 v168, s86, v1
    v_cvt_f32_u32 v168, v168
    v_mul_f32 v171, 0x3c800000, v168
    v_add_f32 v179, v180, v180
    v_mul_f32 v172, v171, v179
    v_sub_f32 v173, v172, v178
    v_mul_f32 v168, 0.5, v168
    s_mov_b64 s[98:99], 0xffff
    v_cndmask_b32 v168, v173, v168, s[98:99]
    v_fmamk_f32 v162, v171, 0x3f800000, v172
    v_fmamk_f32 v163, v171, 0x3f800000, v173
    v_fmamk_f32 v164, v171, 0x41000000, v172
    v_fmamk_f32 v165, v171, 0x41000000, v173
    v_fmamk_f32 v166, v171, 0x41100000, v172
    v_fmamk_f32 v167, v171, 0x41100000, v173
    v_cos_f32 v160, v172
    s_add_u32 m0, s93, 8192
    v_cos_f32 v161, v168
    v_cos_f32 v162, v162
    v_cos_f32 v163, v163
    v_cos_f32 v164, v164
    v_cos_f32 v165, v165
    v_cos_f32 v166, v166
    v_cos_f32 v167, v167
    v_cvt_pk_bf16_f32 v160, v160, v161
    v_cvt_pk_bf16_f32 v161, v162, v163
    v_cvt_pk_bf16_f32 v162, v164, v165
    v_cvt_pk_bf16_f32 v163, v166, v167
    ds_write_b128 v181, v[160:163] offset:0
    v_fmamk_f32 v160, v171, 0x41800000, v172
    v_fmamk_f32 v161, v171, 0x41800000, v173
    v_fmamk_f32 v162, v171, 0x41880000, v172
    v_fmamk_f32 v163, v171, 0x41880000, v173
    v_fmamk_f32 v164, v171, 0x41c00000, v172
    v_fmamk_f32 v165, v171, 0x41c00000, v173
    v_fmamk_f32 v166, v171, 0x41c80000, v172
    v_fmamk_f32 v167, v171, 0x41c80000, v173
    v_cos_f32 v160, v160
    buffer_load_dwordx4 v15, s[20:23], s85 offen offset:0 lds
    v_cos_f32 v161, v161
    v_cos_f32 v162, v162
    v_cos_f32 v163, v163
    v_cos_f32 v164, v164
    v_cos_f32 v165, v165
    v_cos_f32 v166, v166
    v_cos_f32 v167, v167
    v_cvt_pk_bf16_f32 v160, v160, v161
    v_cvt_pk_bf16_f32 v161, v162, v163
    v_cvt_pk_bf16_f32 v162, v164, v165
    v_cvt_pk_bf16_f32 v163, v166, v167
    ds_write_b128 v181, v[160:163] offset:1024
    s_waitcnt lgkmcnt(2)
    v_lshlrev_b32 v208, 16, v192
    v_lshlrev_b32 v209, 16, v194
    v_lshlrev_b32 v210, 16, v196
    v_lshlrev_b32 v211, 16, v198
    v_add_f32 v32, v208, v209
    v_add_f32 v40, v210, v211
    v_sub_f32 v48, v211, v210
    v_sub_f32 v56, v208, v209
    buffer_load_dwordx4 v29, s[20:23], s85 offen offset:1024 lds
    v_cndmask_b32 v20, v32, v209, s[90:91]
    v_cndmask_b32 v21, v40, v211, s[90:91]
    v_cndmask_b32 v32, v32, v208, s[90:91]
    v_cndmask_b32 v40, v40, v210, s[90:91]
    v_cndmask_b32 v48, v48, 0, s[90:91]
    v_cndmask_b32 v56, v56, 0, s[90:91]
    v_and_b32 v212, s92, v192
    v_and_b32 v213, s92, v194
    v_and_b32 v214, s92, v196
    v_and_b32 v215, s92, v198
    v_add_f32 v33, v212, v213
    v_add_f32 v41, v214, v215
    v_sub_f32 v49, v215, v214
    v_sub_f32 v57, v212, v213
    v_lshlrev_b32 v208, 16, v193
    v_lshlrev_b32 v209, 16, v195
    v_lshlrev_b32 v210, 16, v197
    v_lshlrev_b32 v211, 16, v199
    v_add_f32 v34, v208, v209
    v_add_f32 v42, v210, v211
    v_sub_f32 v50, v211, v210
    buffer_load_dwordx4 v30, s[20:23], s85 offen offset:2048 lds
    v_sub_f32 v58, v208, v209
    v_and_b32 v212, s92, v193
    v_and_b32 v213, s92, v195
    v_and_b32 v214, s92, v197
    v_and_b32 v215, s92, v199
    v_add_f32 v35, v212, v213
    v_add_f32 v43, v214, v215
    v_sub_f32 v51, v215, v214
    v_sub_f32 v59, v212, v213
    v_lshlrev_b32 v208, 16, v200
    v_lshlrev_b32 v209, 16, v202
    v_lshlrev_b32 v210, 16, v204
    v_lshlrev_b32 v211, 16, v206
    v_add_f32 v36, v208, v209
    v_add_f32 v44, v210, v211
    v_sub_f32 v52, v211, v210
    v_sub_f32 v60, v208, v209
    v_and_b32 v212, s92, v200
    v_and_b32 v213, s92, v202
    v_and_b32 v214, s92, v204
    v_and_b32 v215, s92, v206
    buffer_load_dwordx4 v31, s[20:23], s85 offen offset:3072 lds
    v_add_f32 v37, v212, v213
    v_add_f32 v45, v214, v215
    v_sub_f32 v53, v215, v214
    v_sub_f32 v61, v212, v213
    v_lshlrev_b32 v208, 16, v201
    v_lshlrev_b32 v209, 16, v203
    v_lshlrev_b32 v210, 16, v205
    v_lshlrev_b32 v211, 16, v207
    v_add_f32 v38, v208, v209
    v_add_f32 v46, v210, v211
    v_sub_f32 v54, v211, v210
    v_sub_f32 v62, v208, v209
    v_and_b32 v212, s92, v201
    v_and_b32 v213, s92, v203
    v_and_b32 v214, s92, v205
    v_and_b32 v215, s92, v207
    v_add_f32 v39, v212, v213
    v_add_f32 v47, v214, v215
    v_sub_f32 v55, v215, v214
    v_sub_f32 v63, v212, v213
    s_lshr_b32 s86, s74, 1
    s_lshl3_add_u32 s86, s86, s0
    s_lshl2_add_u32 s86, s86, s4
    s_lshl_b32 s86, s86, 7
    s_and_b32 s87, s74, 1
    s_add_u32 s86, s86, s87
    s_lshl_b32 s86, s86, 5
    s_add_u32 s86, s86, 8388608
    v_and_b32 v26, 62, v0
    v_lshl_add_u32 v26, v26, 4, v14
    v_add_u32 v25, 0x400, v26
    s_lshl_b32 s87, s4, 11
    s_add_u32 m0, s87, 155648
    s_waitcnt vmcnt(4)
    v_cmp_ne_u32 vcc, 1, v16
    s_cbranch_vccz Lok_22
    s_mov_b32 s3, 0
Lspin_23:
    buffer_load_dword v16, v17, s[24:27], s82 offen sc1
    s_waitcnt vmcnt(0)
    v_cmp_ne_u32 vcc, 1, v16
    s_add_u32 s3, s3, 1
    s_cmp_lt_u32 s3, 300000
    s_cbranch_vccz Lok_22
    s_cbranch_scc1 Lspin_23
Lok_22:
    buffer_load_dwordx4 v26, s[24:27], s86 offen sc1 lds
    buffer_load_dwordx4 v25, s[24:27], s86 offen offset:1024 sc1 lds
    v_lshlrev_b32 v240, 16, v216
    v_and_b32 v241, s92, v216
    v_lshlrev_b32 v248, 16, v224
    ds_read_b64_tr_b16 a[160:161], v10 offset:0
    v_and_b32 v249, s92, v224
    v_lshlrev_b32 v242, 16, v217
    v_and_b32 v243, s92, v217
    ds_read_b64_tr_b16 a[162:163], v10 offset:2048
    v_lshlrev_b32 v250, 16, v225
    v_and_b32 v251, s92, v225
    v_lshlrev_b32 v244, 16, v218
    ds_read_b64_tr_b16 a[164:165], v11 offset:0
    v_and_b32 v245, s92, v218
    v_lshlrev_b32 v252, 16, v226
    v_and_b32 v253, s92, v226
    ds_read_b64_tr_b16 a[166:167], v11 offset:2048
    v_lshlrev_b32 v246, 16, v219
    v_and_b32 v247, s92, v219
    v_lshlrev_b32 v254, 16, v227
    ds_read_b64_tr_b16 a[168:169], v12 offset:0
    v_and_b32 v255, s92, v227
    v_pk_mul_f32 v[240:241], v[240:241], v[248:249]
    v_pk_mul_f32 v[242:243], v[242:243], v[250:251]
    ds_read_b64_tr_b16 a[170:171], v12 offset:2048
    v_pk_mul_f32 v[244:245], v[244:245], v[252:253]
    v_pk_mul_f32 v[246:247], v[246:247], v[254:255]
    v_cvt_pk_bf16_f32 v216, v240, v241
    ds_read_b64_tr_b16 a[172:173], v13 offset:0
    v_cvt_pk_bf16_f32 v217, v242, v243
    v_cvt_pk_bf16_f32 v218, v244, v245
    v_cvt_pk_bf16_f32 v219, v246, v247
    ds_read_b64_tr_b16 a[174:175], v13 offset:2048
    v_lshlrev_b32 v240, 16, v220
    v_and_b32 v241, s92, v220
    v_lshlrev_b32 v248, 16, v228
    s_add_u32 s85, s70, 98304
    v_and_b32 v249, s92, v228
    v_lshlrev_b32 v242, 16, v221
    v_and_b32 v243, s92, v221
    s_add_u32 m0, s93, 12288
    v_lshlrev_b32 v250, 16, v229
    v_and_b32 v251, s92, v229
    v_lshlrev_b32 v244, 16, v222
    buffer_load_dwordx4 v15, s[20:23], s85 offen offset:0 lds
    v_and_b32 v245, s92, v222
    v_lshlrev_b32 v252, 16, v230
    v_and_b32 v253, s92, v230
    buffer_load_dwordx4 v29, s[20:23], s85 offen offset:1024 lds
    v_lshlrev_b32 v246, 16, v223
    v_and_b32 v247, s92, v223
    v_lshlrev_b32 v254, 16, v231
    buffer_load_dwordx4 v30, s[20:23], s85 offen offset:2048 lds
    v_and_b32 v255, s92, v231
    v_pk_mul_f32 v[240:241], v[240:241], v[248:249]
    v_pk_mul_f32 v[242:243], v[242:243], v[250:251]
    buffer_load_dwordx4 v31, s[20:23], s85 offen offset:3072 lds
    v_pk_mul_f32 v[244:245], v[244:245], v[252:253]
    v_pk_mul_f32 v[246:247], v[246:247], v[254:255]
    v_cvt_pk_bf16_f32 v220, v240, v241
    v_cvt_pk_bf16_f32 v221, v242, v243
    v_cvt_pk_bf16_f32 v222, v244, v245
    v_cvt_pk_bf16_f32 v223, v246, v247
    ds_read_b64_tr_b16 a[176:177], v10 offset:4096
    s_mov_b32 s3, 0x3f803f80
    v_dot2_f32_bf16 v232, v216, s3, 0
    v_dot2_f32_bf16 v233, v217, s3, 0
    ds_read_b64_tr_b16 a[178:179], v10 offset:6144
    v_dot2_f32_bf16 v234, v218, s3, 0
    v_dot2_f32_bf16 v235, v219, s3, 0
    v_dot2_f32_bf16 v232, v220, s3, v232
    ds_read_b64_tr_b16 a[180:181], v11 offset:4096
    v_dot2_f32_bf16 v233, v221, s3, v233
    v_dot2_f32_bf16 v234, v222, s3, v234
    v_dot2_f32_bf16 v235, v223, s3, v235
    ds_read_b64_tr_b16 a[182:183], v11 offset:6144
    v_lshlrev_b32 v236, 2, v236
    v_add_f32 v232, v232, v233
    v_add_f32 v234, v234, v235
    ds_read_b64_tr_b16 a[184:185], v12 offset:4096
    v_add_f32 v232, v232, v234
    s_nop 1
    v_add_f32_dpp v232, v232, v232 row_shr:1 row_mask:0xf bank_mask:0xf bound_ctrl:1
    s_nop 1
    v_add_f32_dpp v232, v232, v232 row_shr:2 row_mask:0xf bank_mask:0xf bound_ctrl:1
    ds_read_b64_tr_b16 a[186:187], v12 offset:6144
    s_nop 0
    v_add_f32_dpp v232, v232, v232 row_shr:4 row_mask:0xf bank_mask:0xf bound_ctrl:1
    s_nop 1
    v_add_f32_dpp v232, v232, v232 row_shr:8 row_mask:0xf bank_mask:0xf bound_ctrl:1
    s_nop 1
    v_add_f32_dpp v232, v232, v232 row_bcast:15 row_mask:0xa bank_mask:0xf
    ds_read_b64_tr_b16 a[188:189], v13 offset:4096
    v_cvt_pk_bf16_f32 v232, 0, v232
    v_mul_f32 v232, 0xbfb8aa3b, v232
    v_exp_f32 v232, v232
    ds_read_b64_tr_b16 a[190:191], v13 offset:6144
    v_add_f32 v232, 1.0, v232
    v_rcp_f32 v232, v232
    s_nop 0
    v_cvt_pk_bf16_f32 v232, 0, v232
    s_add_u32 s85, s70, 131072
    s_lshl_b32 s86, s5, 8
    s_add_u32 s86, s86, 12812288
    s_mov_b32 exec_lo, 0x80000000
    s_mov_b32 exec_hi, 0x80000000
    buffer_store_dword v232, v236, s[24:27], s86 offen sc1
    s_mov_b64 exec, -1
    s_lshl_b32 s83, s74, 8
    s_add_u32 s83, s83, s7
    s_add_u32 m0, s93, 0
    s_lshl_b32 s83, s83, 10
    s_xor_b32 s80, s83, 1048576
    s_andn2_b32 s87, s74, 4
    s_waitcnt lgkmcnt(8)
    s_lshl_b32 s87, s87, 5
    s_lshr_b32 s86, s7, 1
    s_add_u32 s86, s86, s87
    buffer_load_dwordx4 v15, s[20:23], s85 offen offset:0 lds
    s_lshl_b32 s86, s86, 7
    s_add_u32 s82, s86, 12648448
    v_lshrrev_b32 v24, 5, v0
    buffer_load_dwordx4 v29, s[20:23], s85 offen offset:1024 lds
    v_mul_u32_u24 v24, 16384, v24
    v_bfe_u32 v17, v0, 3, 2
    v_lshl_add_u32 v17, v17, 7, v24
    buffer_load_dwordx4 v30, s[20:23], s85 offen offset:2048 lds
    s_lshl3_add_u32 s81, s74, s73
    s_lshl_b32 s81, s81, 5
    buffer_load_dwordx4 v31, s[20:23], s85 offen offset:3072 lds
    s_add_u32 s81, s81, 12779520
    v_add_u32 v9, 147456, v14
    s_waitcnt vmcnt(9)
    s_barrier
    ds_read_b64_tr_b16 v[128:129], v19 offset:0
    ds_read_b64_tr_b16 v[130:131], v19 offset:2048
    ds_read_b64_tr_b16 v[132:133], v19 offset:4096
    ds_read_b64_tr_b16 v[134:135], v19 offset:6144
    s_waitcnt lgkmcnt(2)
    v_mfma_f32_16x16x32_bf16 v[136:139], a[224:227], v[128:131], 0
    ds_read_b64_tr_b16 a[0:1], v10 offset:8192
    v_mfma_f32_16x16x32_bf16 v[140:143], a[232:235], v[128:131], 0
    ds_read_b64_tr_b16 a[2:3], v10 offset:10240
    ds_read_b64_tr_b16 a[4:5], v11 offset:8192
    v_mfma_f32_16x16x32_bf16 v[144:147], a[240:243], v[128:131], 0
    ds_read_b64_tr_b16 a[6:7], v11 offset:10240
    ds_read_b64_tr_b16 a[8:9], v12 offset:8192
    v_mfma_f32_16x16x32_bf16 v[148:151], a[248:251], v[128:131], 0
    ds_read_b64_tr_b16 a[10:11], v12 offset:10240
    ds_read_b64_tr_b16 a[12:13], v13 offset:8192
    s_waitcnt lgkmcnt(7)
    v_mfma_f32_16x16x32_bf16 v[136:139], a[228:231], v[132:135], v[136:139]
    ds_read_b64_tr_b16 a[14:15], v13 offset:10240
    s_add_u32 s85, s70, 163840
    v_mfma_f32_16x16x32_bf16 v[140:143], a[236:239], v[132:135], v[140:143]
    s_add_u32 m0, s93, 4096
    v_mfma_f32_16x16x32_bf16 v[144:147], a[244:247], v[132:135], v[144:147]
    buffer_load_dwordx4 v15, s[20:23], s85 offen offset:0 lds
    buffer_load_dwordx4 v29, s[20:23], s85 offen offset:1024 lds
    v_mfma_f32_16x16x32_bf16 v[148:151], a[252:255], v[132:135], v[148:151]
    buffer_load_dwordx4 v30, s[20:23], s85 offen offset:2048 lds
    buffer_load_dwordx4 v31, s[20:23], s85 offen offset:3072 lds
    v_mov_b32 v19, 1
    ds_read_b128 a[224:227], v9 offset:0
    ds_read_b128 a[228:231], v9 offset:1024
    ds_read_b128 a[232:235], v9 offset:2048
    ds_read_b128 a[236:239], v9 offset:3072
    ds_read_b128 a[240:243], v9 offset:4096
    ds_read_b128 a[244:247], v9 offset:5120
    ds_read_b128 a[248:251], v9 offset:6144
    ds_read_b128 a[252:255], v9 offset:7168
    v_mul_f32_dpp v152, v136, v18 row_ror:8 row_mask:0xf bank_mask:0xf
    v_mul_f32_dpp v153, v137, v18 row_ror:8 row_mask:0xf bank_mask:0xf
    v_mul_f32_dpp v154, v138, v18 row_ror:8 row_mask:0xf bank_mask:0xf
    v_mul_f32_dpp v155, v139, v18 row_ror:8 row_mask:0xf bank_mask:0xf
    v_mul_f32_dpp v156, v140, v18 row_ror:8 row_mask:0xf bank_mask:0xf
    v_mul_f32_dpp v157, v141, v18 row_ror:8 row_mask:0xf bank_mask:0xf
    v_mul_f32_dpp v158, v142, v18 row_ror:8 row_mask:0xf bank_mask:0xf
    v_mul_f32_dpp v159, v143, v18 row_ror:8 row_mask:0xf bank_mask:0xf
    v_mul_f32_dpp v160, v144, v18 row_ror:8 row_mask:0xf bank_mask:0xf
    v_mul_f32_dpp v161, v145, v18 row_ror:8 row_mask:0xf bank_mask:0xf
    v_mul_f32_dpp v162, v146, v18 row_ror:8 row_mask:0xf bank_mask:0xf
    v_mul_f32_dpp v163, v147, v18 row_ror:8 row_mask:0xf bank_mask:0xf
    v_mul_f32_dpp v164, v148, v18 row_ror:8 row_mask:0xf bank_mask:0xf
    v_mul_f32_dpp v165, v149, v18 row_ror:8 row_mask:0xf bank_mask:0xf
    v_mul_f32_dpp v166, v150, v18 row_ror:8 row_mask:0xf bank_mask:0xf
    v_mul_f32_dpp v167, v151, v18 row_ror:8 row_mask:0xf bank_mask:0xf
    v_pk_mul_f32 v[168:169], v[32:33], v[136:137]
    v_pk_mul_f32 v[170:171], v[34:35], v[138:139]
    v_pk_mul_f32 v[172:173], v[36:37], v[140:141]
    v_pk_mul_f32 v[174:175], v[38:39], v[142:143]
    v_pk_mul_f32 v[176:177], v[48:49], v[136:137]
    v_pk_mul_f32 v[178:179], v[50:51], v[138:139]
    v_pk_mul_f32 v[180:181], v[52:53], v[140:141]
    v_pk_mul_f32 v[182:183], v[54:55], v[142:143]
    v_pk_fma_f32 v[168:169], v[40:41], v[152:153], v[168:169]
    v_pk_fma_f32 v[170:171], v[42:43], v[154:155], v[170:171]
    v_pk_fma_f32 v[172:173], v[44:45], v[156:157], v[172:173]
    v_pk_fma_f32 v[174:175], v[46:47], v[158:159], v[174:175]
    v_mov_b32 v32, v20
    v_mov_b32 v40, v21
    v_pk_fma_f32 v[176:177], v[56:57], v[152:153], v[176:177]
    v_pk_fma_f32 v[178:179], v[58:59], v[154:155], v[178:179]
    v_pk_fma_f32 v[180:181], v[60:61], v[156:157], v[180:181]
    v_pk_fma_f32 v[182:183], v[62:63], v[158:159], v[182:183]
    v_pk_fma_f32 v[168:169], v[48:49], v[144:145], v[168:169] neg_lo:[1,0,0] neg_hi:[1,0,0]
    v_pk_fma_f32 v[170:171], v[50:51], v[146:147], v[170:171] neg_lo:[1,0,0] neg_hi:[1,0,0]
    v_pk_fma_f32 v[172:173], v[52:53], v[148:149], v[172:173] neg_lo:[1,0,0] neg_hi:[1,0,0]
    v_pk_fma_f32 v[174:175], v[54:55], v[150:151], v[174:175] neg_lo:[1,0,0] neg_hi:[1,0,0]
    v_pk_fma_f32 v[176:177], v[32:33], v[144:145], v[176:177]
    v_pk_fma_f32 v[178:179], v[34:35], v[146:147], v[178:179]
    v_pk_fma_f32 v[180:181], v[36:37], v[148:149], v[180:181]
    v_pk_fma_f32 v[182:183], v[38:39], v[150:151], v[182:183]
    v_pk_fma_f32 v[168:169], v[56:57], v[160:161], v[168:169] neg_lo:[1,0,0] neg_hi:[1,0,0]
    v_pk_fma_f32 v[170:171], v[58:59], v[162:163], v[170:171] neg_lo:[1,0,0] neg_hi:[1,0,0]
    v_pk_fma_f32 v[172:173], v[60:61], v[164:165], v[172:173] neg_lo:[1,0,0] neg_hi:[1,0,0]
    v_pk_fma_f32 v[174:175], v[62:63], v[166:167], v[174:175] neg_lo:[1,0,0] neg_hi:[1,0,0]
    v_pk_fma_f32 v[176:177], v[40:41], v[160:161], v[176:177]
    v_pk_fma_f32 v[178:179], v[42:43], v[162:163], v[178:179]
    v_pk_fma_f32 v[180:181], v[44:45], v[164:165], v[180:181]
    v_pk_fma_f32 v[182:183], v[46:47], v[166:167], v[182:183]
    v_cvt_pk_bf16_f32 v184, v168, v169
    v_cvt_pk_bf16_f32 v185, v170, v171
    v_cvt_pk_bf16_f32 v186, v172, v173
    v_cvt_pk_bf16_f32 v187, v174, v175
    v_cvt_pk_bf16_f32 v188, v176, v177
    v_cvt_pk_bf16_f32 v189, v178, v179
    v_mfma_f32_16x16x32_bf16 v[136:139], v[184:187], a[192:195], 0
    v_cvt_pk_bf16_f32 v190, v180, v181
    v_cvt_pk_bf16_f32 v191, v182, v183
    v_mfma_f32_16x16x32_bf16 v[140:143], v[184:187], a[200:203], 0
    v_mfma_f32_16x16x32_bf16 v[144:147], v[184:187], a[208:211], 0
    v_mfma_f32_16x16x32_bf16 v[148:151], v[184:187], a[216:219], 0
    v_mfma_f32_16x16x32_bf16 v[136:139], v[188:191], a[196:199], v[136:139]
    v_mfma_f32_16x16x32_bf16 v[140:143], v[188:191], a[204:207], v[140:143]
    v_mfma_f32_16x16x32_bf16 v[144:147], v[188:191], a[212:215], v[144:147]
    v_mfma_f32_16x16x32_bf16 v[148:151], v[188:191], a[220:223], v[148:151]
    s_nop 4
    v_cvt_pk_bf16_f32 v128, v136, v137
    v_cvt_pk_bf16_f32 v129, v138, v139
    v_cvt_pk_bf16_f32 v130, v140, v141
    v_cvt_pk_bf16_f32 v131, v142, v143
    v_cvt_pk_bf16_f32 v132, v144, v145
    v_cvt_pk_bf16_f32 v133, v146, v147
    v_cvt_pk_bf16_f32 v134, v148, v149
    v_cvt_pk_bf16_f32 v135, v150, v151
    v_permlane16_swap_b32 v128, v130
    v_permlane16_swap_b32 v129, v131
    buffer_store_dwordx4 v[128:131], v4, s[24:27], s76 offen sc1
    v_permlane16_swap_b32 v132, v134
    v_permlane16_swap_b32 v133, v135
    buffer_store_dwordx4 v[132:135], v4, s[24:27], s78 offen sc1
    s_lshl_b32 s86, s73, 6
    s_lshl_b32 s87, s4, 4
    s_add_u32 s86, s86, s87
    v_add_u32 v154, s86, v1
    v_cvt_f32_u32 v154, v154
    v_mul_f32 v154, 0x3b000000, v154
    v_mul_f32 v152, 0x41800000, v154
    v_cos_f32 v152, v152
    v_and_b32 v156, 2, v2
    v_lshlrev_b32 v156, 2, v156
    v_cvt_f32_u32 v156, v156
    v_and_b32 v157, 1, v2
    v_cvt_f32_u32 v155, v157
    v_mul_f32 v155, 0x3e800000, v155
    v_fmac_f32 v155, v154, v156
    v_add_f32 v152, v152, v152
    v_and_b32 v156, v157, v0
    v_mov_b32 v153, v152
    v_lshl_or_b32 v156, v156, 31, 0.5
    s_add_u32 s85, s70, 196608
    v_fmamk_f32 v137, v154, 0x40000000, v155
    v_fmamk_f32 v138, v154, 0x40800000, v155
    v_fmamk_f32 v139, v154, 0x40c00000, v155
    v_fmamk_f32 v140, v154, 0x3f800000, v155
    v_fmamk_f32 v141, v154, 0x40400000, v155
    v_fmamk_f32 v142, v154, 0x40a00000, v155
    v_fmamk_f32 v143, v154, 0x40e00000, v155
    v_cos_f32 v136, v155
    v_cos_f32 v137, v137
    v_cos_f32 v138, v138
    v_cos_f32 v139, v139
    v_cos_f32 v140, v140
    v_cos_f32 v141, v141
    v_cos_f32 v142, v142
    v_cos_f32 v143, v143
    s_add_u32 m0, s93, 8192
    v_fmamk_f32 v144, v154, 0x41800000, v155
    v_fmamk_f32 v145, v154, 0x41900000, v155
    v_fmamk_f32 v146, v154, 0x41a00000, v155
    v_fmamk_f32 v147, v154, 0x41b00000, v155
    v_fmamk_f32 v148, v154, 0x41880000, v155
    v_fmamk_f32 v149, v154, 0x41980000, v155
    v_fmamk_f32 v150, v154, 0x41a80000, v155
    v_fmamk_f32 v151, v154, 0x41b80000, v155
    v_cos_f32 v144, v144
    v_cos_f32 v145, v145
    v_cos_f32 v146, v146
    v_cos_f32 v147, v147
    v_cos_f32 v148, v148
    v_cos_f32 v149, v149
    v_cos_f32 v150, v150
    v_cos_f32 v151, v151
    s_waitcnt lgkmcnt(8)
    v_cmp_gt_u32 vcc, 2, v2
    v_cvt_pk_bf16_f32 v68, v144, v145
    v_cvt_pk_bf16_f32 v69, v146, v147
    v_cvt_pk_bf16_f32 v70, v148, v149
    v_cvt_pk_bf16_f32 v71, v150, v151
    v_cndmask_b32 v156, v136, v156, vcc
    v_cvt_pk_bf16_f32 v64, v156, v137
    v_cvt_pk_bf16_f32 v65, v138, v139
    v_cvt_pk_bf16_f32 v66, v140, v141
    v_cvt_pk_bf16_f32 v67, v142, v143
    buffer_load_dwordx4 v15, s[20:23], s85 offen offset:0 lds
    v_pk_fma_f32 v[136:137], v[152:153], v[144:145], v[136:137] neg_lo:[0,0,1] neg_hi:[0,0,1]
    v_pk_fma_f32 v[138:139], v[152:153], v[146:147], v[138:139] neg_lo:[0,0,1] neg_hi:[0,0,1]
    v_pk_fma_f32 v[140:141], v[152:153], v[148:149], v[140:141] neg_lo:[0,0,1] neg_hi:[0,0,1]
    v_pk_fma_f32 v[142:143], v[152:153], v[150:151], v[142:143] neg_lo:[0,0,1] neg_hi:[0,0,1]
    v_cvt_pk_bf16_f32 v72, v136, v137
    v_cvt_pk_bf16_f32 v73, v138, v139
    v_cvt_pk_bf16_f32 v74, v140, v141
    v_cvt_pk_bf16_f32 v75, v142, v143
    buffer_load_dwordx4 v29, s[20:23], s85 offen offset:1024 lds
    v_pk_fma_f32 v[144:145], v[152:153], v[136:137], v[144:145] neg_lo:[0,0,1] neg_hi:[0,0,1]
    v_pk_fma_f32 v[146:147], v[152:153], v[138:139], v[146:147] neg_lo:[0,0,1] neg_hi:[0,0,1]
    v_pk_fma_f32 v[148:149], v[152:153], v[140:141], v[148:149] neg_lo:[0,0,1] neg_hi:[0,0,1]
    v_pk_fma_f32 v[150:151], v[152:153], v[142:143], v[150:151] neg_lo:[0,0,1] neg_hi:[0,0,1]
    v_cvt_pk_bf16_f32 v76, v144, v145
    v_cvt_pk_bf16_f32 v77, v146, v147
    v_cvt_pk_bf16_f32 v78, v148, v149
    v_cvt_pk_bf16_f32 v79, v150, v151
    buffer_load_dwordx4 v30, s[20:23], s85 offen offset:2048 lds
    v_pk_fma_f32 v[136:137], v[152:153], v[144:145], v[136:137] neg_lo:[0,0,1] neg_hi:[0,0,1]
    v_pk_fma_f32 v[138:139], v[152:153], v[146:147], v[138:139] neg_lo:[0,0,1] neg_hi:[0,0,1]
    v_pk_fma_f32 v[140:141], v[152:153], v[148:149], v[140:141] neg_lo:[0,0,1] neg_hi:[0,0,1]
    v_pk_fma_f32 v[142:143], v[152:153], v[150:151], v[142:143] neg_lo:[0,0,1] neg_hi:[0,0,1]
    v_cvt_pk_bf16_f32 v80, v136, v137
    v_cvt_pk_bf16_f32 v81, v138, v139
    v_cvt_pk_bf16_f32 v82, v140, v141
    v_cvt_pk_bf16_f32 v83, v142, v143
    buffer_load_dwordx4 v31, s[20:23], s85 offen offset:3072 lds
    v_pk_fma_f32 v[144:145], v[152:153], v[136:137], v[144:145] neg_lo:[0,0,1] neg_hi:[0,0,1]
    v_pk_fma_f32 v[146:147], v[152:153], v[138:139], v[146:147] neg_lo:[0,0,1] neg_hi:[0,0,1]
    v_pk_fma_f32 v[148:149], v[152:153], v[140:141], v[148:149] neg_lo:[0,0,1] neg_hi:[0,0,1]
    v_pk_fma_f32 v[150:151], v[152:153], v[142:143], v[150:151] neg_lo:[0,0,1] neg_hi:[0,0,1]
    v_cvt_pk_bf16_f32 v84, v144, v145
    v_cvt_pk_bf16_f32 v85, v146, v147
    v_cvt_pk_bf16_f32 v86, v148, v149
    v_cvt_pk_bf16_f32 v87, v150, v151
    s_waitcnt vmcnt(4)
    s_barrier
    s_cmp_lg_u32 s4, 0
    s_cbranch_scc1 Lnosig_24
    s_mov_b64 exec, 1
    buffer_store_dword v19, v0, s[24:27], s81 offen sc1
    s_mov_b64 exec, -1
Lnosig_24:
    v_pk_fma_f32 v[136:137], v[152:153], v[144:145], v[136:137] neg_lo:[0,0,1] neg_hi:[0,0,1]
    v_pk_fma_f32 v[138:139], v[152:153], v[146:147], v[138:139] neg_lo:[0,0,1] neg_hi:[0,0,1]
    v_pk_fma_f32 v[140:141], v[152:153], v[148:149], v[140:141] neg_lo:[0,0,1] neg_hi:[0,0,1]
    v_pk_fma_f32 v[142:143], v[152:153], v[150:151], v[142:143] neg_lo:[0,0,1] neg_hi:[0,0,1]
    v_cvt_pk_bf16_f32 v88, v136, v137
    v_cvt_pk_bf16_f32 v89, v138, v139
    v_cvt_pk_bf16_f32 v90, v140, v141
    v_cvt_pk_bf16_f32 v91, v142, v143
    v_pk_fma_f32 v[144:145], v[152:153], v[136:137], v[144:145] neg_lo:[0,0,1] neg_hi:[0,0,1]
    v_pk_fma_f32 v[146:147], v[152:153], v[138:139], v[146:147] neg_lo:[0,0,1] neg_hi:[0,0,1]
    v_pk_fma_f32 v[148:149], v[152:153], v[140:141], v[148:149] neg_lo:[0,0,1] neg_hi:[0,0,1]
    v_pk_fma_f32 v[150:151], v[152:153], v[142:143], v[150:151] neg_lo:[0,0,1] neg_hi:[0,0,1]
    v_cvt_pk_bf16_f32 v92, v144, v145
    v_cvt_pk_bf16_f32 v93, v146, v147
    v_cvt_pk_bf16_f32 v94, v148, v149
    v_cvt_pk_bf16_f32 v95, v150, v151
    v_pk_fma_f32 v[136:137], v[152:153], v[144:145], v[136:137] neg_lo:[0,0,1] neg_hi:[0,0,1]
    v_pk_fma_f32 v[138:139], v[152:153], v[146:147], v[138:139] neg_lo:[0,0,1] neg_hi:[0,0,1]
    v_pk_fma_f32 v[140:141], v[152:153], v[148:149], v[140:141] neg_lo:[0,0,1] neg_hi:[0,0,1]
    v_pk_fma_f32 v[142:143], v[152:153], v[150:151], v[142:143] neg_lo:[0,0,1] neg_hi:[0,0,1]
    v_cvt_pk_bf16_f32 v96, v136, v137
    v_cvt_pk_bf16_f32 v97, v138, v139
    v_cvt_pk_bf16_f32 v98, v140, v141
    v_cvt_pk_bf16_f32 v99, v142, v143
    v_pk_fma_f32 v[144:145], v[152:153], v[136:137], v[144:145] neg_lo:[0,0,1] neg_hi:[0,0,1]
    v_pk_fma_f32 v[146:147], v[152:153], v[138:139], v[146:147] neg_lo:[0,0,1] neg_hi:[0,0,1]
    v_pk_fma_f32 v[148:149], v[152:153], v[140:141], v[148:149] neg_lo:[0,0,1] neg_hi:[0,0,1]
    v_pk_fma_f32 v[150:151], v[152:153], v[142:143], v[150:151] neg_lo:[0,0,1] neg_hi:[0,0,1]
    v_cvt_pk_bf16_f32 v100, v144, v145
    v_cvt_pk_bf16_f32 v101, v146, v147
    v_cvt_pk_bf16_f32 v102, v148, v149
    v_cvt_pk_bf16_f32 v103, v150, v151
    v_pk_fma_f32 v[136:137], v[152:153], v[144:145], v[136:137] neg_lo:[0,0,1] neg_hi:[0,0,1]
    v_pk_fma_f32 v[138:139], v[152:153], v[146:147], v[138:139] neg_lo:[0,0,1] neg_hi:[0,0,1]
    v_pk_fma_f32 v[140:141], v[152:153], v[148:149], v[140:141] neg_lo:[0,0,1] neg_hi:[0,0,1]
    v_pk_fma_f32 v[142:143], v[152:153], v[150:151], v[142:143] neg_lo:[0,0,1] neg_hi:[0,0,1]
    v_cvt_pk_bf16_f32 v104, v136, v137
    v_cvt_pk_bf16_f32 v105, v138, v139
    v_cvt_pk_bf16_f32 v106, v140, v141
    v_cvt_pk_bf16_f32 v107, v142, v143
    v_pk_fma_f32 v[144:145], v[152:153], v[136:137], v[144:145] neg_lo:[0,0,1] neg_hi:[0,0,1]
    v_pk_fma_f32 v[146:147], v[152:153], v[138:139], v[146:147] neg_lo:[0,0,1] neg_hi:[0,0,1]
    v_pk_fma_f32 v[148:149], v[152:153], v[140:141], v[148:149] neg_lo:[0,0,1] neg_hi:[0,0,1]
    v_pk_fma_f32 v[150:151], v[152:153], v[142:143], v[150:151] neg_lo:[0,0,1] neg_hi:[0,0,1]
    v_cvt_pk_bf16_f32 v108, v144, v145
    v_cvt_pk_bf16_f32 v109, v146, v147
    v_cvt_pk_bf16_f32 v110, v148, v149
    v_cvt_pk_bf16_f32 v111, v150, v151
    v_pk_fma_f32 v[136:137], v[152:153], v[144:145], v[136:137] neg_lo:[0,0,1] neg_hi:[0,0,1]
    v_pk_fma_f32 v[138:139], v[152:153], v[146:147], v[138:139] neg_lo:[0,0,1] neg_hi:[0,0,1]
    v_pk_fma_f32 v[140:141], v[152:153], v[148:149], v[140:141] neg_lo:[0,0,1] neg_hi:[0,0,1]
    v_pk_fma_f32 v[142:143], v[152:153], v[150:151], v[142:143] neg_lo:[0,0,1] neg_hi:[0,0,1]
    v_cvt_pk_bf16_f32 v112, v136, v137
    v_cvt_pk_bf16_f32 v113, v138, v139
    v_cvt_pk_bf16_f32 v114, v140, v141
    v_cvt_pk_bf16_f32 v115, v142, v143
    v_pk_fma_f32 v[144:145], v[152:153], v[136:137], v[144:145] neg_lo:[0,0,1] neg_hi:[0,0,1]
    v_pk_fma_f32 v[146:147], v[152:153], v[138:139], v[146:147] neg_lo:[0,0,1] neg_hi:[0,0,1]
    v_pk_fma_f32 v[148:149], v[152:153], v[140:141], v[148:149] neg_lo:[0,0,1] neg_hi:[0,0,1]
    v_pk_fma_f32 v[150:151], v[152:153], v[142:143], v[150:151] neg_lo:[0,0,1] neg_hi:[0,0,1]
    v_cvt_pk_bf16_f32 v116, v144, v145
    v_cvt_pk_bf16_f32 v117, v146, v147
    v_cvt_pk_bf16_f32 v118, v148, v149
    v_cvt_pk_bf16_f32 v119, v150, v151
    v_pk_fma_f32 v[136:137], v[152:153], v[144:145], v[136:137] neg_lo:[0,0,1] neg_hi:[0,0,1]
    v_pk_fma_f32 v[138:139], v[152:153], v[146:147], v[138:139] neg_lo:[0,0,1] neg_hi:[0,0,1]
    v_pk_fma_f32 v[140:141], v[152:153], v[148:149], v[140:141] neg_lo:[0,0,1] neg_hi:[0,0,1]
    v_pk_fma_f32 v[142:143], v[152:153], v[150:151], v[142:143] neg_lo:[0,0,1] neg_hi:[0,0,1]
    v_cvt_pk_bf16_f32 v120, v136, v137
    v_cvt_pk_bf16_f32 v121, v138, v139
    v_cvt_pk_bf16_f32 v122, v140, v141
    v_cvt_pk_bf16_f32 v123, v142, v143
    v_pk_fma_f32 v[144:145], v[152:153], v[136:137], v[144:145] neg_lo:[0,0,1] neg_hi:[0,0,1]
    v_pk_fma_f32 v[146:147], v[152:153], v[138:139], v[146:147] neg_lo:[0,0,1] neg_hi:[0,0,1]
    v_pk_fma_f32 v[148:149], v[152:153], v[140:141], v[148:149] neg_lo:[0,0,1] neg_hi:[0,0,1]
    v_pk_fma_f32 v[150:151], v[152:153], v[142:143], v[150:151] neg_lo:[0,0,1] neg_hi:[0,0,1]
    v_cvt_pk_bf16_f32 v124, v144, v145
    v_cvt_pk_bf16_f32 v125, v146, v147
    v_cvt_pk_bf16_f32 v126, v148, v149
    v_cvt_pk_bf16_f32 v127, v150, v151
    buffer_load_dword v16, v17, s[24:27], s82 offen sc1
    s_waitcnt vmcnt(0)
    v_cmp_ne_u32 vcc, 1, v16
    s_cbranch_vccz Lok_25
    s_mov_b32 s3, 0
Lspin_26:
    buffer_load_dword v16, v17, s[24:27], s82 offen sc1
    s_waitcnt vmcnt(0)
    v_cmp_ne_u32 vcc, 1, v16
    s_add_u32 s3, s3, 1
    s_cmp_lt_u32 s3, 300000
    s_cbranch_vccz Lok_25
    s_cbranch_scc1 Lspin_26
Lok_25:
    s_add_u32 s94, s80, 0
    s_lshl_b32 s82, s4, 11
    s_add_u32 s82, s82, 12779520
    v_lshlrev_b32 v17, 5, v0
    s_lshl_b32 s88, s74, 16
    buffer_load_dwordx4 v[192:195], v14, s[24:27], s94 offen offset:0 sc1
    s_lshl_b32 s89, s4, 14
    s_add_u32 s88, s88, s89
    s_add_u32 s88, s88, 10485760
    buffer_load_dwordx4 v[196:199], v14, s[24:27], s94 offen offset:1024 sc1
    s_lshl_b32 s86, s74, 8
    s_add_u32 s86, s86, 12812288
    v_lshrrev_b32 v24, 1, v1
    v_lshlrev_b32 v24, 7, v24
    buffer_load_dwordx4 v[200:203], v14, s[24:27], s94 offen offset:2048 sc1
    v_and_b32 v25, 1, v0
    v_lshl_add_u32 v24, v25, 5, v24
    v_lshrrev_b32 v27, 1, v2
    buffer_load_dwordx4 v[204:207], v14, s[24:27], s94 offen offset:3072 sc1
    v_bfe_u32 v28, v0, 3, 1
    v_xor_b32 v28, v27, v28
    v_lshl_add_u32 v24, v28, 6, v24
    v_and_b32 v26, 1, v2
    s_add_u32 s94, s80, 4096
    v_lshl_add_u32 v5, v26, 4, v24
    v_lshrrev_b32 v24, 3, v0
    v_xor_b32 v25, v24, v0
    buffer_load_dwordx4 v[208:211], v14, s[24:27], s94 offen offset:0 sc1
    v_and_b32 v25, 7, v25
    v_lshlrev_b32 v24, 15, v24
    v_lshl_add_u32 v3, v25, 4, v24
    v_lshl_add_u32 v24, s4, 1, v27
    buffer_load_dwordx4 v[212:215], v14, s[24:27], s94 offen offset:1024 sc1
    v_xor_b32 v24, v24, v0
    v_and_b32 v24, 7, v24
    v_lshlrev_b32 v24, 4, v24
    buffer_load_dwordx4 v[216:219], v14, s[24:27], s94 offen offset:2048 sc1
    v_lshl_add_u32 v24, v1, 7, v24
    v_lshl_add_u32 v24, v26, 3, v24
    v_add_u32 v6, 155648, v24
    s_lshl_b32 s87, s4, 10
    s_add_u32 s94, s80, 65536
    s_add_u32 s87, s87, 155648
    v_add_u32 v7, s87, v14
    v_lshlrev_b32 v8, 4, v1
    buffer_load_dwordx4 v[220:223], v14, s[24:27], s94 offen offset:0 sc1
    s_lshl3_add_u32 s76, s74, s73
    s_lshl_b32 s76, s76, 7
    s_lshl_b32 s87, s4, 18
    s_add_u32 s76, s76, s87
    buffer_load_dwordx4 v[224:227], v14, s[24:27], s94 offen offset:1024 sc1
    s_add_u32 s77, s76, 0x100000
    s_xor_b32 s87, s4, 0
    s_mul_i32 s87, s87, 3072
    buffer_load_dwordx4 v[228:231], v14, s[24:27], s94 offen offset:2048 sc1
    s_add_u32 s87, s87, 77824
    v_add_u32 v32, s87, v14
    s_xor_b32 s87, s4, 1
    s_mul_i32 s87, s87, 3072
    buffer_load_dwordx4 v[232:235], v14, s[24:27], s94 offen offset:3072 sc1
    s_add_u32 s87, s87, 77824
    v_add_u32 v33, s87, v14
    s_xor_b32 s87, s4, 2
    s_add_u32 s94, s80, 69632
    s_mul_i32 s87, s87, 3072
    s_add_u32 s87, s87, 78848
    v_add_u32 v34, s87, v14
    s_xor_b32 s87, s4, 3
    buffer_load_dwordx4 v[236:239], v14, s[24:27], s94 offen offset:0 sc1
    s_mul_i32 s87, s87, 3072
    s_add_u32 s87, s87, 79872
    v_add_u32 v35, s87, v14
    s_lshl3_add_u32 s87, s74, s73
    s_lshl_b32 s81, s87, 7
    s_add_u32 s81, s81, 12820480
    s_lshl2_add_u32 s78, s87, s4
    s_lshl_b32 s78, s78, 12
    s_xor_b32 s79, s78, 524288
    s_add_u32 s78, s78, 13631488
    s_add_u32 s79, s79, 13631488
    ds_read_b64_tr_b16 a[16:17], v10 offset:12288
    ds_read_b64_tr_b16 a[18:19], v10 offset:14336
    ds_read_b64_tr_b16 a[20:21], v11 offset:12288
    ds_read_b64_tr_b16 a[22:23], v11 offset:14336
    ds_read_b64_tr_b16 a[24:25], v12 offset:12288
    ds_read_b64_tr_b16 a[26:27], v12 offset:14336
    ds_read_b64_tr_b16 a[28:29], v13 offset:12288
    ds_read_b64_tr_b16 a[30:31], v13 offset:14336
    ds_read_b64_tr_b16 a[32:33], v10 offset:0
    ds_read_b64_tr_b16 a[34:35], v10 offset:2048
    ds_read_b64_tr_b16 a[36:37], v11 offset:0
    ds_read_b64_tr_b16 a[38:39], v11 offset:2048
    ds_read_b64_tr_b16 a[40:41], v12 offset:0
    ds_read_b64_tr_b16 a[42:43], v12 offset:2048
    ds_read_b64_tr_b16 a[44:45], v13 offset:0
    ds_read_b64_tr_b16 a[46:47], v13 offset:2048
    ds_read_b64_tr_b16 a[48:49], v10 offset:4096
    ds_read_b64_tr_b16 a[50:51], v10 offset:6144
    ds_read_b64_tr_b16 a[52:53], v11 offset:4096
    ds_read_b64_tr_b16 a[54:55], v11 offset:6144
    ds_read_b64_tr_b16 a[56:57], v12 offset:4096
    ds_read_b64_tr_b16 a[58:59], v12 offset:6144
    ds_read_b64_tr_b16 a[60:61], v13 offset:4096
    ds_read_b64_tr_b16 a[62:63], v13 offset:6144
    ds_read_b64_tr_b16 a[64:65], v10 offset:8192
    ds_read_b64_tr_b16 a[66:67], v10 offset:10240
    ds_read_b64_tr_b16 a[68:69], v11 offset:8192
    ds_read_b64_tr_b16 a[70:71], v11 offset:10240
    ds_read_b64_tr_b16 a[72:73], v12 offset:8192
    ds_read_b64_tr_b16 a[74:75], v12 offset:10240
    ds_read_b64_tr_b16 a[76:77], v13 offset:8192
    ds_read_b64_tr_b16 a[78:79], v13 offset:10240
    s_waitcnt vmcnt(11)
    v_mfma_f32_16x16x32_bf16 v[128:131], a[160:163], v[192:195], 0
    v_mfma_f32_16x16x32_bf16 v[144:147], a[164:167], v[192:195], 0
    buffer_load_dwordx4 v[240:243], v14, s[24:27], s94 offen offset:1024 sc1
    v_mfma_f32_16x16x32_bf16 v[160:163], a[168:171], v[192:195], 0
    v_mfma_f32_16x16x32_bf16 v[176:179], a[172:175], v[192:195], 0
    s_waitcnt vmcnt(11)
    v_mfma_f32_16x16x32_bf16 v[128:131], a[176:179], v[196:199], v[128:131]
    buffer_load_dwordx4 v[244:247], v14, s[24:27], s94 offen offset:2048 sc1
    v_mfma_f32_16x16x32_bf16 v[144:147], a[180:183], v[196:199], v[144:147]
    v_mfma_f32_16x16x32_bf16 v[160:163], a[184:187], v[196:199], v[160:163]
    v_mfma_f32_16x16x32_bf16 v[176:179], a[188:191], v[196:199], v[176:179]
    s_waitcnt vmcnt(11)
    v_mfma_f32_16x16x32_bf16 v[128:131], a[0:3], v[200:203], v[128:131]
    s_add_u32 s94, s80, 131072
    buffer_load_dwordx4 v[248:251], v14, s[24:27], s94 offen offset:0 sc1
    v_mfma_f32_16x16x32_bf16 v[144:147], a[4:7], v[200:203], v[144:147]
    v_mfma_f32_16x16x32_bf16 v[160:163], a[8:11], v[200:203], v[160:163]
    v_mfma_f32_16x16x32_bf16 v[176:179], a[12:15], v[200:203], v[176:179]
    s_waitcnt vmcnt(11)
    s_waitcnt lgkmcnt(14)
    v_mfma_f32_16x16x32_bf16 v[128:131], a[16:19], v[204:207], v[128:131]
    buffer_load_dwordx4 v[252:255], v14, s[24:27], s94 offen offset:1024 sc1
    v_mfma_f32_16x16x32_bf16 v[144:147], a[20:23], v[204:207], v[144:147]
    v_mfma_f32_16x16x32_bf16 v[160:163], a[24:27], v[204:207], v[160:163]
    v_mfma_f32_16x16x32_bf16 v[176:179], a[28:31], v[204:207], v[176:179]
    s_waitcnt vmcnt(11)
    v_mfma_f32_16x16x32_bf16 v[128:131], a[32:35], v[208:211], v[128:131]
    buffer_load_dwordx4 v[192:195], v14, s[24:27], s94 offen offset:2048 sc1
    v_mfma_f32_16x16x32_bf16 v[144:147], a[36:39], v[208:211], v[144:147]
    v_mfma_f32_16x16x32_bf16 v[160:163], a[40:43], v[208:211], v[160:163]
    v_mfma_f32_16x16x32_bf16 v[176:179], a[44:47], v[208:211], v[176:179]
    s_waitcnt vmcnt(11)
    v_mfma_f32_16x16x32_bf16 v[128:131], a[48:51], v[212:215], v[128:131]
    buffer_load_dwordx4 v[196:199], v14, s[24:27], s94 offen offset:3072 sc1
    s_waitcnt lgkmcnt(12)
    v_mfma_f32_16x16x32_bf16 v[144:147], a[52:55], v[212:215], v[144:147]
    s_waitcnt lgkmcnt(10)
    v_mfma_f32_16x16x32_bf16 v[160:163], a[56:59], v[212:215], v[160:163]
    s_waitcnt lgkmcnt(8)
    v_mfma_f32_16x16x32_bf16 v[176:179], a[60:63], v[212:215], v[176:179]
    s_waitcnt vmcnt(11)
    s_waitcnt lgkmcnt(4)
    v_mfma_f32_16x16x32_bf16 v[144:147], a[68:71], v[216:219], v[144:147]
    s_add_u32 s94, s80, 135168
    buffer_load_dwordx4 v[200:203], v14, s[24:27], s94 offen offset:0 sc1
    s_waitcnt lgkmcnt(2)
    v_mfma_f32_16x16x32_bf16 v[160:163], a[72:75], v[216:219], v[160:163]
    s_waitcnt lgkmcnt(0)
    v_mfma_f32_16x16x32_bf16 v[176:179], a[76:79], v[216:219], v[176:179]
    v_mfma_f32_16x16x32_bf16 v[128:131], a[64:67], v[216:219], v[128:131]
    s_waitcnt vmcnt(11)
    v_mfma_f32_16x16x32_bf16 v[132:135], a[160:163], v[220:223], 0
    buffer_load_dwordx4 v[204:207], v14, s[24:27], s94 offen offset:1024 sc1
    v_mfma_f32_16x16x32_bf16 v[148:151], a[164:167], v[220:223], 0
    v_mfma_f32_16x16x32_bf16 v[164:167], a[168:171], v[220:223], 0
    ds_write_b128 v33, v[144:147] offset:53248
    v_mfma_f32_16x16x32_bf16 v[180:183], a[172:175], v[220:223], 0
    s_waitcnt vmcnt(11)
    v_mfma_f32_16x16x32_bf16 v[132:135], a[176:179], v[224:227], v[132:135]
    buffer_load_dwordx4 v[208:211], v14, s[24:27], s94 offen offset:2048 sc1
    v_mfma_f32_16x16x32_bf16 v[148:151], a[180:183], v[224:227], v[148:151]
    v_mfma_f32_16x16x32_bf16 v[164:167], a[184:187], v[224:227], v[164:167]
    v_mfma_f32_16x16x32_bf16 v[180:183], a[188:191], v[224:227], v[180:183]
    s_waitcnt vmcnt(11)
    ds_write_b128 v34, v[160:163] offset:53248
    v_mfma_f32_16x16x32_bf16 v[132:135], a[0:3], v[228:231], v[132:135]
    s_add_u32 s94, s80, 196608
    buffer_load_dwordx4 v[212:215], v14, s[24:27], s94 offen offset:0 sc1
    v_mfma_f32_16x16x32_bf16 v[148:151], a[4:7], v[228:231], v[148:151]
    v_mfma_f32_16x16x32_bf16 v[164:167], a[8:11], v[228:231], v[164:167]
    v_mfma_f32_16x16x32_bf16 v[180:183], a[12:15], v[228:231], v[180:183]
    s_waitcnt vmcnt(11)
    v_mfma_f32_16x16x32_bf16 v[132:135], a[16:19], v[232:235], v[132:135]
    buffer_load_dwordx4 v[216:219], v14, s[24:27], s94 offen offset:1024 sc1
    v_mfma_f32_16x16x32_bf16 v[148:151], a[20:23], v[232:235], v[148:151]
    ds_write_b128 v35, v[176:179] offset:53248
    v_mfma_f32_16x16x32_bf16 v[164:167], a[24:27], v[232:235], v[164:167]
    s_barrier
    v_mfma_f32_16x16x32_bf16 v[180:183], a[28:31], v[232:235], v[180:183]
    s_waitcnt vmcnt(11)
    v_mfma_f32_16x16x32_bf16 v[132:135], a[32:35], v[236:239], v[132:135]
    buffer_load_dwordx4 v[220:223], v14, s[24:27], s94 offen offset:2048 sc1
    v_mfma_f32_16x16x32_bf16 v[148:151], a[36:39], v[236:239], v[148:151]
    v_mfma_f32_16x16x32_bf16 v[164:167], a[40:43], v[236:239], v[164:167]
    v_mfma_f32_16x16x32_bf16 v[180:183], a[44:47], v[236:239], v[180:183]
    s_waitcnt vmcnt(11)
    v_mfma_f32_16x16x32_bf16 v[132:135], a[48:51], v[240:243], v[132:135]
    buffer_load_dwordx4 v[224:227], v14, s[24:27], s94 offen offset:3072 sc1
    buffer_load_dword v16, v17, s[24:27], s82 offen sc1
    v_mfma_f32_16x16x32_bf16 v[148:151], a[52:55], v[240:243], v[148:151]
    v_mfma_f32_16x16x32_bf16 v[164:167], a[56:59], v[240:243], v[164:167]
    v_mfma_f32_16x16x32_bf16 v[180:183], a[60:63], v[240:243], v[180:183]
    s_waitcnt vmcnt(12)
    v_mfma_f32_16x16x32_bf16 v[148:151], a[68:71], v[244:247], v[148:151]
    s_add_u32 s94, s80, 200704
    buffer_load_dwordx4 v[228:231], v14, s[24:27], s94 offen offset:0 sc1
    v_mfma_f32_16x16x32_bf16 v[164:167], a[72:75], v[244:247], v[164:167]
    v_mfma_f32_16x16x32_bf16 v[180:183], a[76:79], v[244:247], v[180:183]
    v_mfma_f32_16x16x32_bf16 v[132:135], a[64:67], v[244:247], v[132:135]
    s_waitcnt vmcnt(12)
    v_mfma_f32_16x16x32_bf16 v[136:139], a[160:163], v[248:251], 0
    buffer_load_dwordx4 v[232:235], v14, s[24:27], s94 offen offset:1024 sc1
    v_mfma_f32_16x16x32_bf16 v[152:155], a[164:167], v[248:251], 0
    v_mfma_f32_16x16x32_bf16 v[168:171], a[168:171], v[248:251], 0
    ds_write_b128 v33, v[148:151] offset:0
    v_mfma_f32_16x16x32_bf16 v[184:187], a[172:175], v[248:251], 0
    s_waitcnt vmcnt(12)
    v_mfma_f32_16x16x32_bf16 v[136:139], a[176:179], v[252:255], v[136:139]
    buffer_load_dwordx4 v[236:239], v14, s[24:27], s94 offen offset:2048 sc1
    ds_write_b128 v34, v[164:167] offset:0
    v_mfma_f32_16x16x32_bf16 v[152:155], a[180:183], v[252:255], v[152:155]
    v_mfma_f32_16x16x32_bf16 v[168:171], a[184:187], v[252:255], v[168:171]
    ds_write_b128 v35, v[180:183] offset:0
    v_mfma_f32_16x16x32_bf16 v[184:187], a[188:191], v[252:255], v[184:187]
    s_waitcnt vmcnt(12)
    v_mfma_f32_16x16x32_bf16 v[136:139], a[0:3], v[192:195], v[136:139]
    s_add_u32 s94, s83, 0
    buffer_load_dwordx4 v[240:243], v14, s[24:27], s94 offen offset:0 sc1
    v_mfma_f32_16x16x32_bf16 v[152:155], a[4:7], v[192:195], v[152:155]
    v_mfma_f32_16x16x32_bf16 v[168:171], a[8:11], v[192:195], v[168:171]
    s_waitcnt lgkmcnt(0)
    s_barrier
    v_mfma_f32_16x16x32_bf16 v[184:187], a[12:15], v[192:195], v[184:187]
    s_waitcnt vmcnt(12)
    ds_read_b128 v[144:147], v32 offset:53248
    v_mfma_f32_16x16x32_bf16 v[136:139], a[16:19], v[196:199], v[136:139]
    buffer_load_dwordx4 v[244:247], v14, s[24:27], s94 offen offset:1024 sc1
    ds_read_b128 v[160:163], v32 offset:54272
    v_mfma_f32_16x16x32_bf16 v[152:155], a[20:23], v[196:199], v[152:155]
    ds_read_b128 v[176:179], v32 offset:55296
    v_mfma_f32_16x16x32_bf16 v[168:171], a[24:27], v[196:199], v[168:171]
    ds_read_b128 v[148:151], v32 offset:0
    v_mfma_f32_16x16x32_bf16 v[184:187], a[28:31], v[196:199], v[184:187]
    s_waitcnt vmcnt(12)
    ds_read_b128 v[164:167], v32 offset:1024
    v_mfma_f32_16x16x32_bf16 v[136:139], a[32:35], v[200:203], v[136:139]
    buffer_load_dwordx4 v[248:251], v14, s[24:27], s94 offen offset:2048 sc1
    ds_read_b128 v[180:183], v32 offset:2048
    v_mfma_f32_16x16x32_bf16 v[152:155], a[36:39], v[200:203], v[152:155]
    v_mfma_f32_16x16x32_bf16 v[168:171], a[40:43], v[200:203], v[168:171]
    s_waitcnt lgkmcnt(3)
    v_add_f32 v128, v128, v144
    v_mfma_f32_16x16x32_bf16 v[184:187], a[44:47], v[200:203], v[184:187]
    s_waitcnt vmcnt(12)
    v_add_f32 v129, v129, v145
    v_mfma_f32_16x16x32_bf16 v[136:139], a[48:51], v[204:207], v[136:139]
    buffer_load_dwordx4 v[252:255], v14, s[24:27], s94 offen offset:3072 sc1
    v_add_f32 v130, v130, v146
    v_mfma_f32_16x16x32_bf16 v[152:155], a[52:55], v[204:207], v[152:155]
    v_add_f32 v131, v131, v147
    v_add_f32 v160, v160, v176
    v_mfma_f32_16x16x32_bf16 v[168:171], a[56:59], v[204:207], v[168:171]
    v_add_f32 v161, v161, v177
    v_add_f32 v162, v162, v178
    v_mfma_f32_16x16x32_bf16 v[184:187], a[60:63], v[204:207], v[184:187]
    s_waitcnt vmcnt(12)
    v_add_f32 v163, v163, v179
    v_mfma_f32_16x16x32_bf16 v[152:155], a[68:71], v[208:211], v[152:155]
    s_add_u32 s94, s83, 4096
    buffer_load_dwordx4 v[192:195], v14, s[24:27], s94 offen offset:0 sc1
    v_mfma_f32_16x16x32_bf16 v[168:171], a[72:75], v[208:211], v[168:171]
    v_add_f32 v128, v128, v160
    v_add_f32 v129, v129, v161
    v_mfma_f32_16x16x32_bf16 v[184:187], a[76:79], v[208:211], v[184:187]
    v_add_f32 v130, v130, v162
    v_add_f32 v131, v131, v163
    v_mfma_f32_16x16x32_bf16 v[136:139], a[64:67], v[208:211], v[136:139]
    s_waitcnt vmcnt(12)
    v_cvt_pk_bf16_f32 v24, v128, v129
    v_mfma_f32_16x16x32_bf16 v[140:143], a[160:163], v[212:215], 0
    buffer_load_dwordx4 v[196:199], v14, s[24:27], s94 offen offset:1024 sc1
    v_cvt_pk_bf16_f32 v25, v130, v131
    v_mfma_f32_16x16x32_bf16 v[156:159], a[164:167], v[212:215], 0
    s_waitcnt lgkmcnt(0)
    v_add_f32 v132, v132, v148
    v_mfma_f32_16x16x32_bf16 v[172:175], a[168:171], v[212:215], 0
    v_add_f32 v133, v133, v149
    v_add_f32 v134, v134, v150
    v_mfma_f32_16x16x32_bf16 v[188:191], a[172:175], v[212:215], 0
    s_waitcnt vmcnt(12)
    v_add_f32 v135, v135, v151
    v_mfma_f32_16x16x32_bf16 v[140:143], a[176:179], v[216:219], v[140:143]
    buffer_load_dwordx4 v[200:203], v14, s[24:27], s94 offen offset:2048 sc1
    v_add_f32 v164, v164, v180
    v_mfma_f32_16x16x32_bf16 v[156:159], a[180:183], v[216:219], v[156:159]
    v_add_f32 v165, v165, v181
    v_add_f32 v166, v166, v182
    v_mfma_f32_16x16x32_bf16 v[172:175], a[184:187], v[216:219], v[172:175]
    v_add_f32 v167, v167, v183
    v_add_f32 v132, v132, v164
    v_mfma_f32_16x16x32_bf16 v[188:191], a[188:191], v[216:219], v[188:191]
    s_waitcnt vmcnt(12)
    v_add_f32 v133, v133, v165
    v_mfma_f32_16x16x32_bf16 v[140:143], a[0:3], v[220:223], v[140:143]
    s_waitcnt vmcnt(10)
    v_cmp_ne_u32 vcc, 1, v16
    s_cbranch_vccz Lok_27
    s_mov_b32 s3, 0
Lspin_28:
    buffer_load_dword v16, v17, s[24:27], s82 offen sc1
    s_waitcnt vmcnt(0)
    v_cmp_ne_u32 vcc, 1, v16
    s_add_u32 s3, s3, 1
    s_cmp_lt_u32 s3, 300000
    s_cbranch_vccz Lok_27
    s_cbranch_scc1 Lspin_28
Lok_27:
    v_mfma_f32_16x16x32_bf16 v[156:159], a[4:7], v[220:223], v[156:159]
    s_xor_b32 s82, s81, 4096
    s_add_u32 m0, s89, 0
    v_mfma_f32_16x16x32_bf16 v[172:175], a[8:11], v[220:223], v[172:175]
    v_add_f32 v134, v134, v166
    v_add_f32 v135, v135, v167
    v_mfma_f32_16x16x32_bf16 v[188:191], a[12:15], v[220:223], v[188:191]
    buffer_load_dwordx4 v14, s[24:27], s88 offen offset:0 sc1 lds
    v_mfma_f32_16x16x32_bf16 v[140:143], a[16:19], v[224:227], v[140:143]
    v_cvt_pk_bf16_f32 v26, v132, v133
    v_cvt_pk_bf16_f32 v27, v134, v135
    v_mfma_f32_16x16x32_bf16 v[156:159], a[20:23], v[224:227], v[156:159]
    buffer_load_dwordx4 v14, s[24:27], s88 offen offset:1024 sc1 lds
    buffer_store_dwordx4 v[24:27], v14, s[24:27], s79 offen offset:0 sc1
    v_mfma_f32_16x16x32_bf16 v[172:175], a[24:27], v[224:227], v[172:175]
    ds_write_b128 v33, v[152:155] offset:12288
    v_mfma_f32_16x16x32_bf16 v[188:191], a[28:31], v[224:227], v[188:191]
    s_waitcnt vmcnt(12)
    buffer_load_dwordx4 v14, s[24:27], s88 offen offset:2048 sc1 lds
    v_mfma_f32_16x16x32_bf16 v[140:143], a[32:35], v[228:231], v[140:143]
    ds_write_b128 v34, v[168:171] offset:12288
    v_mfma_f32_16x16x32_bf16 v[156:159], a[36:39], v[228:231], v[156:159]
    buffer_load_dwordx4 v14, s[24:27], s88 offen offset:3072 sc1 lds
    ds_write_b128 v35, v[184:187] offset:12288
    v_mfma_f32_16x16x32_bf16 v[172:175], a[40:43], v[228:231], v[172:175]
    v_mov_b32 v17, 0
    s_add_u32 s94, s83, 65536
    v_mfma_f32_16x16x32_bf16 v[188:191], a[44:47], v[228:231], v[188:191]
    s_waitcnt vmcnt(13)
    buffer_load_dwordx4 v[204:207], v14, s[24:27], s94 offen offset:0 sc1
    v_mfma_f32_16x16x32_bf16 v[140:143], a[48:51], v[232:235], v[140:143]
    buffer_load_dwordx4 v[208:211], v14, s[24:27], s94 offen offset:1024 sc1
    v_mfma_f32_16x16x32_bf16 v[156:159], a[52:55], v[232:235], v[156:159]
    buffer_load_dwordx4 v[212:215], v14, s[24:27], s94 offen offset:2048 sc1
    v_mfma_f32_16x16x32_bf16 v[172:175], a[56:59], v[232:235], v[172:175]
    v_mfma_f32_16x16x32_bf16 v[188:191], a[60:63], v[232:235], v[188:191]
    s_waitcnt vmcnt(15)
    v_mfma_f32_16x16x32_bf16 v[156:159], a[68:71], v[236:239], v[156:159]
    buffer_load_dwordx4 v[216:219], v14, s[24:27], s94 offen offset:3072 sc1
    v_mfma_f32_16x16x32_bf16 v[172:175], a[72:75], v[236:239], v[172:175]
    v_mfma_f32_16x16x32_bf16 v[188:191], a[76:79], v[236:239], v[188:191]
    v_mfma_f32_16x16x32_bf16 v[140:143], a[64:67], v[236:239], v[140:143]
    s_waitcnt vmcnt(15)
    v_mfma_f32_16x16x32_bf16 v[128:131], a[160:163], v[240:243], 0
    s_add_u32 m0, s89, 4096
    v_mfma_f32_16x16x32_bf16 v[144:147], a[164:167], v[240:243], 0
    s_add_u32 s88, s88, 4096
    v_mfma_f32_16x16x32_bf16 v[160:163], a[168:171], v[240:243], 0
    ds_write_b128 v33, v[156:159] offset:24576
    v_mfma_f32_16x16x32_bf16 v[176:179], a[172:175], v[240:243], 0
    s_waitcnt vmcnt(14)
    buffer_load_dwordx4 v14, s[24:27], s88 offen offset:0 sc1 lds
    v_mfma_f32_16x16x32_bf16 v[128:131], a[176:179], v[244:247], v[128:131]
    ds_write_b128 v34, v[172:175] offset:24576
    v_mfma_f32_16x16x32_bf16 v[144:147], a[180:183], v[244:247], v[144:147]
    buffer_load_dwordx4 v14, s[24:27], s88 offen offset:1024 sc1 lds
    v_mfma_f32_16x16x32_bf16 v[160:163], a[184:187], v[244:247], v[160:163]
    buffer_load_dwordx4 v14, s[24:27], s88 offen offset:2048 sc1 lds
    ds_write_b128 v35, v[188:191] offset:24576
    v_mfma_f32_16x16x32_bf16 v[176:179], a[188:191], v[244:247], v[176:179]
    s_waitcnt vmcnt(16)
    v_mfma_f32_16x16x32_bf16 v[128:131], a[0:3], v[248:251], v[128:131]
    buffer_load_dwordx4 v14, s[24:27], s88 offen offset:3072 sc1 lds
    v_mfma_f32_16x16x32_bf16 v[144:147], a[4:7], v[248:251], v[144:147]
    s_add_u32 s94, s83, 69632
    buffer_load_dwordx4 v[220:223], v14, s[24:27], s94 offen offset:0 sc1
    v_mfma_f32_16x16x32_bf16 v[160:163], a[8:11], v[248:251], v[160:163]
    s_waitcnt lgkmcnt(0)
    s_barrier
    v_mfma_f32_16x16x32_bf16 v[176:179], a[12:15], v[248:251], v[176:179]
    s_waitcnt vmcnt(17)
    ds_read_b128 v[152:155], v32 offset:12288
    v_mfma_f32_16x16x32_bf16 v[128:131], a[16:19], v[252:255], v[128:131]
    ds_read_b128 v[168:171], v32 offset:13312
    v_mfma_f32_16x16x32_bf16 v[144:147], a[20:23], v[252:255], v[144:147]
    ds_read_b128 v[184:187], v32 offset:14336
    v_mfma_f32_16x16x32_bf16 v[160:163], a[24:27], v[252:255], v[160:163]
    ds_read_b128 v[156:159], v32 offset:24576
    v_mfma_f32_16x16x32_bf16 v[176:179], a[28:31], v[252:255], v[176:179]
    s_waitcnt vmcnt(16)
    ds_read_b128 v[172:175], v32 offset:25600
    v_mfma_f32_16x16x32_bf16 v[128:131], a[32:35], v[192:195], v[128:131]
    ds_read_b128 v[188:191], v32 offset:26624
    v_mfma_f32_16x16x32_bf16 v[144:147], a[36:39], v[192:195], v[144:147]
    v_mfma_f32_16x16x32_bf16 v[160:163], a[40:43], v[192:195], v[160:163]
    s_waitcnt lgkmcnt(3)
    v_add_f32 v136, v136, v152
    v_mfma_f32_16x16x32_bf16 v[176:179], a[44:47], v[192:195], v[176:179]
    s_waitcnt vmcnt(15)
    v_add_f32 v137, v137, v153
    v_mfma_f32_16x16x32_bf16 v[128:131], a[48:51], v[196:199], v[128:131]
    buffer_load_dwordx4 v[224:227], v14, s[24:27], s94 offen offset:1024 sc1
    v_add_f32 v138, v138, v154
    v_mfma_f32_16x16x32_bf16 v[144:147], a[52:55], v[196:199], v[144:147]
    v_add_f32 v139, v139, v155
    v_add_f32 v168, v168, v184
    v_mfma_f32_16x16x32_bf16 v[160:163], a[56:59], v[196:199], v[160:163]
    v_add_f32 v169, v169, v185
    v_add_f32 v170, v170, v186
    v_mfma_f32_16x16x32_bf16 v[176:179], a[60:63], v[196:199], v[176:179]
    s_waitcnt vmcnt(15)
    v_add_f32 v171, v171, v187
    v_mfma_f32_16x16x32_bf16 v[144:147], a[68:71], v[200:203], v[144:147]
    s_add_u32 m0, s89, 8192
    v_add_f32 v136, v136, v168
    v_mfma_f32_16x16x32_bf16 v[160:163], a[72:75], v[200:203], v[160:163]
    s_add_u32 s88, s88, 4096
    v_add_f32 v137, v137, v169
    v_mfma_f32_16x16x32_bf16 v[176:179], a[76:79], v[200:203], v[176:179]
    v_add_f32 v138, v138, v170
    v_add_f32 v139, v139, v171
    v_cvt_pk_bf16_f32 v28, v136, v137
    v_cvt_pk_bf16_f32 v29, v138, v139
    v_mfma_f32_16x16x32_bf16 v[128:131], a[64:67], v[200:203], v[128:131]
    s_waitcnt vmcnt(9)
    buffer_load_dwordx4 v14, s[24:27], s88 offen offset:0 sc1 lds
    v_mfma_f32_16x16x32_bf16 v[132:135], a[160:163], v[204:207], 0
    s_barrier
    s_waitcnt lgkmcnt(0)
    v_mfma_f32_16x16x32_bf16 v[148:151], a[164:167], v[204:207], 0
    ds_read_b128 a[80:83], v5 offset:0
    buffer_load_dwordx4 v14, s[24:27], s88 offen offset:1024 sc1 lds
    v_add_f32 v140, v140, v156
    v_add_f32 v141, v141, v157
    v_add_f32 v142, v142, v158
    v_add_f32 v143, v143, v159
    v_add_f32 v172, v172, v188
    v_add_f32 v173, v173, v189
    v_mfma_f32_16x16x32_bf16 v[164:167], a[168:171], v[204:207], 0
    ds_read_b128 a[84:87], v5 offset:16384
    buffer_load_dwordx4 v14, s[24:27], s88 offen offset:2048 sc1 lds
    v_mfma_f32_16x16x32_bf16 v[180:183], a[172:175], v[204:207], 0
    s_waitcnt vmcnt(11)
    ds_read_b128 a[88:91], v5 offset:32768
    v_mfma_f32_16x16x32_bf16 v[132:135], a[176:179], v[208:211], v[132:135]
    ds_read_b128 a[92:95], v5 offset:49152
    buffer_load_dwordx4 v14, s[24:27], s88 offen offset:3072 sc1 lds
    v_mfma_f32_16x16x32_bf16 v[148:151], a[180:183], v[208:211], v[148:151]
    ds_read_b128 a[96:99], v5 offset:1024
    buffer_load_dwordx4 v[228:231], v14, s[24:27], s94 offen offset:2048 sc1
    v_mfma_f32_16x16x32_bf16 v[164:167], a[184:187], v[208:211], v[164:167]
    ds_read_b128 a[100:103], v5 offset:17408
    v_add_f32 v174, v174, v190
    v_add_f32 v175, v175, v191
    v_add_f32 v140, v140, v172
    v_add_f32 v141, v141, v173
    v_mfma_f32_16x16x32_bf16 v[180:183], a[188:191], v[208:211], v[180:183]
    s_waitcnt vmcnt(12)
    ds_read_b128 a[104:107], v5 offset:33792
    v_mfma_f32_16x16x32_bf16 v[132:135], a[0:3], v[212:215], v[132:135]
    ds_read_b128 a[108:111], v5 offset:50176
    v_add_f32 v142, v142, v174
    v_add_f32 v143, v143, v175
    v_mfma_f32_16x16x32_bf16 v[148:151], a[4:7], v[212:215], v[148:151]
    ds_read_b128 a[112:115], v5 offset:2048
    v_cvt_pk_bf16_f32 v30, v140, v141
    v_mfma_f32_16x16x32_bf16 v[164:167], a[8:11], v[212:215], v[164:167]
    s_waitcnt lgkmcnt(7)
    ds_read_b128 a[116:119], v5 offset:18432
    v_mfma_f32_16x16x32_bf16 v[48:51], a[80:83], v[64:67], 0
    ds_read_b128 a[120:123], v5 offset:34816
    v_cvt_pk_bf16_f32 v31, v142, v143
    buffer_store_dwordx4 v[28:31], v14, s[24:27], s79 offen offset:1024 sc1
    v_mfma_f32_16x16x32_bf16 v[52:55], a[84:87], v[64:67], 0
    ds_read_b128 a[124:127], v5 offset:51200
    buffer_load_dwordx4 v[20:23], v8, s[24:27], s86 offen sc1
    v_mfma_f32_16x16x32_bf16 v[180:183], a[12:15], v[212:215], v[180:183]
    s_waitcnt lgkmcnt(8)
    ds_write_b128 v33, v[144:147] offset:53248
    ds_write_b128 v34, v[160:163] offset:53248
    ds_write_b128 v35, v[176:179] offset:53248
    v_mfma_f32_16x16x32_bf16 v[56:59], a[88:91], v[64:67], 0
    ds_read_b128 a[128:131], v5 offset:3072
    v_mfma_f32_16x16x32_bf16 v[60:63], a[92:95], v[64:67], 0
    s_waitcnt vmcnt(13)
    ds_read_b128 a[132:135], v5 offset:19456
    v_mfma_f32_16x16x32_bf16 v[132:135], a[16:19], v[216:219], v[132:135]
    s_waitcnt lgkmcnt(11)
    s_add_u32 s94, s83, 131072
    v_mfma_f32_16x16x32_bf16 v[48:51], a[96:99], v[68:71], v[48:51]
    ds_read_b128 a[136:139], v5 offset:35840
    buffer_load_dwordx4 v[232:235], v14, s[24:27], s94 offen offset:0 sc1
    v_mfma_f32_16x16x32_bf16 v[52:55], a[100:103], v[68:71], v[52:55]
    ds_read_b128 a[140:143], v5 offset:52224
    v_mfma_f32_16x16x32_bf16 v[148:151], a[20:23], v[216:219], v[148:151]
    s_waitcnt lgkmcnt(11)
    s_waitcnt vmcnt(10)
    s_barrier
    v_mfma_f32_16x16x32_bf16 v[56:59], a[104:107], v[68:71], v[56:59]
    ds_read_b128 a[80:83], v5 offset:4096
    s_add_u32 m0, s89, 12288
    v_mfma_f32_16x16x32_bf16 v[60:63], a[108:111], v[68:71], v[60:63]
    ds_read_b128 a[84:87], v5 offset:20480
    s_add_u32 s88, s88, 4096
    v_mfma_f32_16x16x32_bf16 v[164:167], a[24:27], v[216:219], v[164:167]
    s_waitcnt lgkmcnt(11)
    v_mfma_f32_16x16x32_bf16 v[48:51], a[112:115], v[72:75], v[48:51]
    ds_read_b128 a[88:91], v5 offset:36864
    buffer_load_dwordx4 v14, s[24:27], s88 offen offset:0 sc1 lds
    v_mfma_f32_16x16x32_bf16 v[52:55], a[116:119], v[72:75], v[52:55]
    ds_read_b128 a[92:95], v5 offset:53248
    v_mfma_f32_16x16x32_bf16 v[180:183], a[28:31], v[216:219], v[180:183]
    s_waitcnt lgkmcnt(11)
    buffer_load_dwordx4 v14, s[24:27], s88 offen offset:1024 sc1 lds
    v_mfma_f32_16x16x32_bf16 v[56:59], a[120:123], v[72:75], v[56:59]
    ds_read_b128 a[96:99], v5 offset:5120
    buffer_load_dwordx4 v14, s[24:27], s88 offen offset:2048 sc1 lds
    v_mfma_f32_16x16x32_bf16 v[60:63], a[124:127], v[72:75], v[60:63]
    s_waitcnt vmcnt(12)
    ds_read_b128 a[100:103], v5 offset:21504
    v_mfma_f32_16x16x32_bf16 v[132:135], a[32:35], v[220:223], v[132:135]
    s_waitcnt lgkmcnt(8)
    buffer_load_dwordx4 v14, s[24:27], s88 offen offset:3072 sc1 lds
    v_mfma_f32_16x16x32_bf16 v[48:51], a[128:131], v[76:79], v[48:51]
    ds_read_b128 a[104:107], v5 offset:37888
    buffer_load_dwordx4 v[236:239], v14, s[24:27], s94 offen offset:1024 sc1
    v_mfma_f32_16x16x32_bf16 v[52:55], a[132:135], v[76:79], v[52:55]
    ds_read_b128 a[108:111], v5 offset:54272
    v_mfma_f32_16x16x32_bf16 v[148:151], a[36:39], v[220:223], v[148:151]
    s_waitcnt lgkmcnt(8)
    v_mfma_f32_16x16x32_bf16 v[56:59], a[136:139], v[76:79], v[56:59]
    ds_read_b128 a[112:115], v5 offset:6144
    v_mfma_f32_16x16x32_bf16 v[60:63], a[140:143], v[76:79], v[60:63]
    ds_read_b128 a[116:119], v5 offset:22528
    v_mfma_f32_16x16x32_bf16 v[164:167], a[40:43], v[220:223], v[164:167]
    s_waitcnt lgkmcnt(8)
    v_mfma_f32_16x16x32_bf16 v[48:51], a[80:83], v[80:83], v[48:51]
    ds_read_b128 a[120:123], v5 offset:38912
    v_mfma_f32_16x16x32_bf16 v[52:55], a[84:87], v[80:83], v[52:55]
    ds_read_b128 a[124:127], v5 offset:55296
    v_mfma_f32_16x16x32_bf16 v[180:183], a[44:47], v[220:223], v[180:183]
    s_waitcnt lgkmcnt(8)
    v_mfma_f32_16x16x32_bf16 v[56:59], a[88:91], v[80:83], v[56:59]
    ds_read_b128 a[128:131], v5 offset:7168
    v_mfma_f32_16x16x32_bf16 v[60:63], a[92:95], v[80:83], v[60:63]
    s_waitcnt vmcnt(13)
    ds_read_b128 a[132:135], v5 offset:23552
    v_mfma_f32_16x16x32_bf16 v[132:135], a[48:51], v[224:227], v[132:135]
    s_waitcnt lgkmcnt(8)
    buffer_load_dwordx4 v[240:243], v14, s[24:27], s94 offen offset:2048 sc1
    v_mfma_f32_16x16x32_bf16 v[48:51], a[96:99], v[84:87], v[48:51]
    ds_read_b128 a[136:139], v5 offset:39936
    s_waitcnt vmcnt(8)
    s_barrier
    s_cmp_lg_u32 s4, 0
    s_cbranch_scc1 Lnop_29
    s_mov_b64 exec, 1
    buffer_store_dword v19, v0, s[24:27], s81 offen sc1
    s_mov_b64 exec, -1
Lnop_29:
    v_mfma_f32_16x16x32_bf16 v[52:55], a[100:103], v[84:87], v[52:55]
    ds_read_b128 a[140:143], v5 offset:56320
    v_mfma_f32_16x16x32_bf16 v[148:151], a[52:55], v[224:227], v[148:151]
    s_waitcnt lgkmcnt(8)
    s_barrier
    v_mfma_f32_16x16x32_bf16 v[56:59], a[104:107], v[84:87], v[56:59]
    ds_read_b128 a[80:83], v5 offset:8192
    v_mfma_f32_16x16x32_bf16 v[60:63], a[108:111], v[84:87], v[60:63]
    ds_read_b128 a[84:87], v5 offset:24576
    v_mfma_f32_16x16x32_bf16 v[164:167], a[56:59], v[224:227], v[164:167]
    s_waitcnt lgkmcnt(8)
    v_mfma_f32_16x16x32_bf16 v[48:51], a[112:115], v[88:91], v[48:51]
    ds_read_b128 a[88:91], v5 offset:40960
    v_mfma_f32_16x16x32_bf16 v[52:55], a[116:119], v[88:91], v[52:55]
    ds_read_b128 a[92:95], v5 offset:57344
    v_mfma_f32_16x16x32_bf16 v[180:183], a[60:63], v[224:227], v[180:183]
    s_waitcnt lgkmcnt(8)
    v_mfma_f32_16x16x32_bf16 v[56:59], a[120:123], v[88:91], v[56:59]
    ds_read_b128 a[96:99], v5 offset:9216
    v_mfma_f32_16x16x32_bf16 v[60:63], a[124:127], v[88:91], v[60:63]
    ds_read_b128 a[100:103], v5 offset:25600
    v_mfma_f32_16x16x32_bf16 v[148:151], a[68:71], v[228:231], v[148:151]
    s_waitcnt lgkmcnt(8)
    buffer_load_dwordx4 v[244:247], v14, s[24:27], s94 offen offset:3072 sc1
    v_mfma_f32_16x16x32_bf16 v[48:51], a[128:131], v[92:95], v[48:51]
    ds_read_b128 a[104:107], v5 offset:41984
    v_mfma_f32_16x16x32_bf16 v[52:55], a[132:135], v[92:95], v[52:55]
    ds_read_b128 a[108:111], v5 offset:58368
    v_mfma_f32_16x16x32_bf16 v[164:167], a[72:75], v[228:231], v[164:167]
    s_waitcnt lgkmcnt(8)
    v_mfma_f32_16x16x32_bf16 v[56:59], a[136:139], v[92:95], v[56:59]
    ds_read_b128 a[112:115], v5 offset:10240
    v_mfma_f32_16x16x32_bf16 v[60:63], a[140:143], v[92:95], v[60:63]
    ds_read_b128 a[116:119], v5 offset:26624
    v_mfma_f32_16x16x32_bf16 v[180:183], a[76:79], v[228:231], v[180:183]
    s_waitcnt lgkmcnt(8)
    v_mfma_f32_16x16x32_bf16 v[48:51], a[80:83], v[96:99], v[48:51]
    ds_read_b128 a[120:123], v5 offset:43008
    v_mfma_f32_16x16x32_bf16 v[52:55], a[84:87], v[96:99], v[52:55]
    ds_read_b128 a[124:127], v5 offset:59392
    s_add_u32 s94, s83, 135168
    v_mfma_f32_16x16x32_bf16 v[132:135], a[64:67], v[228:231], v[132:135]
    s_waitcnt lgkmcnt(8)
    buffer_load_dwordx4 v[248:251], v14, s[24:27], s94 offen offset:0 sc1
    v_mfma_f32_16x16x32_bf16 v[56:59], a[88:91], v[96:99], v[56:59]
    ds_read_b128 a[128:131], v5 offset:11264
    v_mfma_f32_16x16x32_bf16 v[60:63], a[92:95], v[96:99], v[60:63]
    s_waitcnt vmcnt(8)
    ds_read_b128 a[132:135], v5 offset:27648
    v_mfma_f32_16x16x32_bf16 v[136:139], a[160:163], v[232:235], 0
    s_waitcnt lgkmcnt(8)
    buffer_load_dwordx4 v[252:255], v14, s[24:27], s94 offen offset:1024 sc1
    ds_write_b128 v33, v[148:151] offset:0
    v_mfma_f32_16x16x32_bf16 v[48:51], a[96:99], v[100:103], v[48:51]
    ds_read_b128 a[136:139], v5 offset:44032
    v_mfma_f32_16x16x32_bf16 v[52:55], a[100:103], v[100:103], v[52:55]
    ds_read_b128 a[140:143], v5 offset:60416
    ds_write_b128 v34, v[164:167] offset:0
    v_mfma_f32_16x16x32_bf16 v[152:155], a[164:167], v[232:235], 0
    s_waitcnt lgkmcnt(10)
    s_waitcnt vmcnt(5)
    s_barrier
    v_mfma_f32_16x16x32_bf16 v[56:59], a[104:107], v[100:103], v[56:59]
    ds_read_b128 a[80:83], v5 offset:12288
    buffer_load_dwordx4 v[192:195], v14, s[24:27], s94 offen offset:2048 sc1
    ds_write_b128 v35, v[180:183] offset:0
    v_mfma_f32_16x16x32_bf16 v[60:63], a[108:111], v[100:103], v[60:63]
    ds_read_b128 a[84:87], v5 offset:28672
    v_mfma_f32_16x16x32_bf16 v[168:171], a[168:171], v[232:235], 0
    s_waitcnt lgkmcnt(11)
    v_mfma_f32_16x16x32_bf16 v[48:51], a[112:115], v[104:107], v[48:51]
    ds_read_b128 a[88:91], v5 offset:45056
    v_mfma_f32_16x16x32_bf16 v[52:55], a[116:119], v[104:107], v[52:55]
    ds_read_b128 a[92:95], v5 offset:61440
    s_waitcnt lgkmcnt(3)
    s_barrier
    v_mfma_f32_16x16x32_bf16 v[184:187], a[172:175], v[232:235], 0
    ds_read_b128 v[144:147], v32 offset:53248
    v_mfma_f32_16x16x32_bf16 v[56:59], a[120:123], v[104:107], v[56:59]
    ds_read_b128 a[96:99], v5 offset:13312
    v_mfma_f32_16x16x32_bf16 v[60:63], a[124:127], v[104:107], v[60:63]
    s_waitcnt vmcnt(5)
    ds_read_b128 a[100:103], v5 offset:29696
    v_mfma_f32_16x16x32_bf16 v[136:139], a[176:179], v[236:239], v[136:139]
    ds_read_b128 v[160:163], v32 offset:54272
    v_mfma_f32_16x16x32_bf16 v[48:51], a[128:131], v[108:111], v[48:51]
    ds_read_b128 a[104:107], v5 offset:46080
    v_mfma_f32_16x16x32_bf16 v[52:55], a[132:135], v[108:111], v[52:55]
    ds_read_b128 a[108:111], v5 offset:62464
    buffer_load_dword v16, v17, s[24:27], s82 offen sc1
    v_mfma_f32_16x16x32_bf16 v[152:155], a[180:183], v[236:239], v[152:155]
    ds_read_b128 v[176:179], v32 offset:55296
    ds_read_b128 v[148:151], v32 offset:0
    ds_read_b128 v[164:167], v32 offset:1024
    ds_read_b128 v[180:183], v32 offset:2048
    v_mfma_f32_16x16x32_bf16 v[56:59], a[136:139], v[108:111], v[56:59]
    ds_read_b128 a[112:115], v5 offset:14336
    s_add_u32 s94, s83, 196608
    v_mfma_f32_16x16x32_bf16 v[60:63], a[140:143], v[108:111], v[60:63]
    ds_read_b128 a[116:119], v5 offset:30720
    buffer_load_dwordx4 v[196:199], v14, s[24:27], s94 offen offset:0 sc1
    v_mfma_f32_16x16x32_bf16 v[168:171], a[184:187], v[236:239], v[168:171]
    s_waitcnt lgkmcnt(14)
    s_waitcnt lgkmcnt(5)
    v_mfma_f32_16x16x32_bf16 v[48:51], a[80:83], v[112:115], v[48:51]
    ds_read_b128 a[120:123], v5 offset:47104
    v_add_f32 v128, v128, v144
    v_mfma_f32_16x16x32_bf16 v[52:55], a[84:87], v[112:115], v[52:55]
    ds_read_b128 a[124:127], v5 offset:63488
    buffer_load_dwordx4 v[200:203], v14, s[24:27], s94 offen offset:1024 sc1
    v_mfma_f32_16x16x32_bf16 v[184:187], a[188:191], v[236:239], v[184:187]
    v_add_f32 v129, v129, v145
    v_mfma_f32_16x16x32_bf16 v[56:59], a[88:91], v[112:115], v[56:59]
    ds_read_b128 a[128:131], v5 offset:15360
    v_add_f32 v130, v130, v146
    v_add_f32 v131, v131, v147
    v_add_f32 v160, v160, v176
    v_add_f32 v161, v161, v177
    v_mfma_f32_16x16x32_bf16 v[60:63], a[92:95], v[112:115], v[60:63]
    s_waitcnt vmcnt(7)
    ds_read_b128 a[132:135], v5 offset:31744
    v_mfma_f32_16x16x32_bf16 v[136:139], a[0:3], v[240:243], v[136:139]
    buffer_load_dwordx4 v[204:207], v14, s[24:27], s94 offen offset:2048 sc1
    v_mfma_f32_16x16x32_bf16 v[48:51], a[96:99], v[116:119], v[48:51]
    ds_read_b128 a[136:139], v5 offset:48128
    v_add_f32 v162, v162, v178
    v_add_f32 v163, v163, v179
    v_mfma_f32_16x16x32_bf16 v[52:55], a[100:103], v[116:119], v[52:55]
    ds_read_b128 a[140:143], v5 offset:64512
    v_add_f32 v128, v128, v160
    v_add_f32 v129, v129, v161
    v_mfma_f32_16x16x32_bf16 v[152:155], a[4:7], v[240:243], v[152:155]
    v_add_f32 v130, v130, v162
    v_add_f32 v131, v131, v163
    v_mfma_f32_16x16x32_bf16 v[56:59], a[104:107], v[116:119], v[56:59]
    buffer_load_dwordx4 v[208:211], v14, s[24:27], s94 offen offset:3072 sc1
    s_waitcnt lgkmcnt(8)
    v_mfma_f32_16x16x32_bf16 v[60:63], a[108:111], v[116:119], v[60:63]
    v_add_f32 v132, v132, v148
    v_add_f32 v133, v133, v149
    v_mfma_f32_16x16x32_bf16 v[168:171], a[8:11], v[240:243], v[168:171]
    s_waitcnt lgkmcnt(6)
    v_add_f32 v134, v134, v150
    v_mfma_f32_16x16x32_bf16 v[48:51], a[112:115], v[120:123], v[48:51]
    v_add_f32 v135, v135, v151
    v_add_f32 v164, v164, v180
    v_mfma_f32_16x16x32_bf16 v[52:55], a[116:119], v[120:123], v[52:55]
    s_add_u32 s94, s83, 200704
    buffer_load_dwordx4 v[212:215], v14, s[24:27], s94 offen offset:0 sc1
    v_mfma_f32_16x16x32_bf16 v[184:187], a[12:15], v[240:243], v[184:187]
    s_waitcnt lgkmcnt(4)
    v_add_f32 v165, v165, v181
    v_mfma_f32_16x16x32_bf16 v[56:59], a[120:123], v[120:123], v[56:59]
    v_add_f32 v166, v166, v182
    v_add_f32 v167, v167, v183
    v_mfma_f32_16x16x32_bf16 v[60:63], a[124:127], v[120:123], v[60:63]
    s_waitcnt vmcnt(9)
    v_add_f32 v132, v132, v164
    v_add_f32 v133, v133, v165
    v_mfma_f32_16x16x32_bf16 v[136:139], a[16:19], v[244:247], v[136:139]
    s_waitcnt lgkmcnt(2)
    buffer_load_dwordx4 v[216:219], v14, s[24:27], s94 offen offset:1024 sc1
    v_mfma_f32_16x16x32_bf16 v[48:51], a[128:131], v[124:127], v[48:51]
    v_add_f32 v134, v134, v166
    v_add_f32 v135, v135, v167
    v_mfma_f32_16x16x32_bf16 v[52:55], a[132:135], v[124:127], v[52:55]
    s_waitcnt vmcnt(6)
    v_cmp_ne_u32 vcc, 1, v16
    s_cbranch_vccz Lok_30
    s_mov_b32 s3, 0
Lspin_31:
    buffer_load_dword v16, v17, s[24:27], s82 offen sc1
    s_waitcnt vmcnt(0)
    v_cmp_ne_u32 vcc, 1, v16
    s_add_u32 s3, s3, 1
    s_cmp_lt_u32 s3, 300000
    s_cbranch_vccz Lok_30
    s_cbranch_scc1 Lspin_31
Lok_30:
    v_mfma_f32_16x16x32_bf16 v[152:155], a[20:23], v[244:247], v[152:155]
    s_waitcnt lgkmcnt(0)
    buffer_load_dwordx4 v[24:27], v14, s[24:27], s78 offen offset:0 sc1
    v_mfma_f32_16x16x32_bf16 v[56:59], a[136:139], v[124:127], v[56:59]
    buffer_load_dwordx4 v[220:223], v14, s[24:27], s94 offen offset:2048 sc1
    buffer_load_dwordx4 v[28:31], v14, s[24:27], s78 offen offset:1024 sc1
    v_mfma_f32_16x16x32_bf16 v[60:63], a[140:143], v[124:127], v[60:63]
    v_mfma_f32_16x16x32_bf16 v[168:171], a[24:27], v[244:247], v[168:171]
    v_mfma_f32_16x16x32_bf16 v[184:187], a[28:31], v[244:247], v[184:187]
    v_mfma_f32_16x16x32_bf16 v[136:139], a[32:35], v[248:251], v[136:139]
    v_mfma_f32_16x16x32_bf16 v[152:155], a[36:39], v[248:251], v[152:155]
    v_cvt_pk_bf16_f32 v36, v48, v49
    v_cvt_pk_bf16_f32 v37, v50, v51
    v_mfma_f32_16x16x32_bf16 v[168:171], a[40:43], v[248:251], v[168:171]
    v_cvt_pk_bf16_f32 v38, v52, v53
    v_cvt_pk_bf16_f32 v39, v54, v55
    v_mfma_f32_16x16x32_bf16 v[184:187], a[44:47], v[248:251], v[184:187]
    v_cvt_pk_bf16_f32 v40, v56, v57
    v_mfma_f32_16x16x32_bf16 v[136:139], a[48:51], v[252:255], v[136:139]
    v_cvt_pk_bf16_f32 v41, v58, v59
    v_cvt_pk_bf16_f32 v42, v60, v61
    v_mfma_f32_16x16x32_bf16 v[152:155], a[52:55], v[252:255], v[152:155]
    v_cvt_pk_bf16_f32 v43, v62, v63
    v_mfma_f32_16x16x32_bf16 v[168:171], a[56:59], v[252:255], v[168:171]
    v_mfma_f32_16x16x32_bf16 v[184:187], a[60:63], v[252:255], v[184:187]
    v_mfma_f32_16x16x32_bf16 v[152:155], a[68:71], v[192:195], v[152:155]
    v_mfma_f32_16x16x32_bf16 v[64:67], v[36:39], a[224:227], 0
    v_mul_f32 v80, 0x36000000, v20
    v_mul_f32 v81, 0x36000000, v21
    v_mfma_f32_16x16x32_bf16 v[68:71], v[36:39], a[232:235], 0
    v_mul_f32 v82, 0x36000000, v22
    v_mul_f32 v83, 0x36000000, v23
    v_mfma_f32_16x16x32_bf16 v[72:75], v[36:39], a[240:243], 0
    v_sub_f32 v20, 1.0, v20
    v_sub_f32 v21, 1.0, v21
    v_mfma_f32_16x16x32_bf16 v[76:79], v[36:39], a[248:251], 0
    v_sub_f32 v22, 1.0, v22
    v_sub_f32 v23, 1.0, v23
    v_mfma_f32_16x16x32_bf16 v[64:67], v[40:43], a[228:231], v[64:67]
    v_mfma_f32_16x16x32_bf16 v[68:71], v[40:43], a[236:239], v[68:71]
    v_mfma_f32_16x16x32_bf16 v[72:75], v[40:43], a[244:247], v[72:75]
    v_mfma_f32_16x16x32_bf16 v[76:79], v[40:43], a[252:255], v[76:79]
    v_mfma_f32_16x16x32_bf16 v[168:171], a[72:75], v[192:195], v[168:171]
    v_mfma_f32_16x16x32_bf16 v[184:187], a[76:79], v[192:195], v[184:187]
    s_nop 2
    v_mul_f32 v64, v80, v64
    v_mul_f32 v65, v80, v65
    v_mfma_f32_16x16x32_bf16 v[136:139], a[64:67], v[192:195], v[136:139]
    s_waitcnt vmcnt(8)
    v_mul_f32 v66, v80, v66
    v_mfma_f32_16x16x32_bf16 v[140:143], a[160:163], v[196:199], 0
    v_mul_f32 v67, v80, v67
    v_mul_f32 v68, v81, v68
    v_mfma_f32_16x16x32_bf16 v[156:159], a[164:167], v[196:199], 0
    v_mul_f32 v69, v81, v69
    v_mul_f32 v70, v81, v70
    v_mfma_f32_16x16x32_bf16 v[172:175], a[168:171], v[196:199], 0
    ds_write_b128 v33, v[152:155] offset:12288
    v_mul_f32 v71, v81, v71
    v_mfma_f32_16x16x32_bf16 v[188:191], a[172:175], v[196:199], 0
    s_waitcnt vmcnt(7)
    v_mul_f32 v72, v82, v72
    v_mfma_f32_16x16x32_bf16 v[140:143], a[176:179], v[200:203], v[140:143]
    ds_write_b128 v34, v[168:171] offset:12288
    v_mul_f32 v73, v82, v73
    v_mfma_f32_16x16x32_bf16 v[156:159], a[180:183], v[200:203], v[156:159]
    v_mul_f32 v74, v82, v74
    v_mul_f32 v75, v82, v75
    v_mfma_f32_16x16x32_bf16 v[172:175], a[184:187], v[200:203], v[172:175]
    ds_write_b128 v35, v[184:187] offset:12288
    v_mul_f32 v76, v83, v76
    v_mfma_f32_16x16x32_bf16 v[188:191], a[188:191], v[200:203], v[188:191]
    s_waitcnt vmcnt(6)
    v_mul_f32 v77, v83, v77
    v_mfma_f32_16x16x32_bf16 v[140:143], a[0:3], v[204:207], v[140:143]
    v_mul_f32 v78, v83, v78
    v_mul_f32 v79, v83, v79
    v_mfma_f32_16x16x32_bf16 v[156:159], a[4:7], v[204:207], v[156:159]
    s_waitcnt vmcnt(2)
    v_lshlrev_b32 v88, 16, v24
    v_and_b32 v24, s92, v24
    v_mfma_f32_16x16x32_bf16 v[172:175], a[8:11], v[204:207], v[172:175]
    s_waitcnt lgkmcnt(0)
    s_barrier
    v_mfma_f32_16x16x32_bf16 v[188:191], a[12:15], v[204:207], v[188:191]
    ds_read_b128 v[152:155], v32 offset:12288
    v_mfma_f32_16x16x32_bf16 v[140:143], a[16:19], v[208:211], v[140:143]
    ds_read_b128 v[168:171], v32 offset:13312
    v_fmac_f32 v64, v20, v88
    v_mfma_f32_16x16x32_bf16 v[156:159], a[20:23], v[208:211], v[156:159]
    ds_read_b128 v[184:187], v32 offset:14336
    v_fmac_f32 v65, v20, v24
    v_mfma_f32_16x16x32_bf16 v[172:175], a[24:27], v[208:211], v[172:175]
    v_lshlrev_b32 v89, 16, v25
    v_and_b32 v25, s92, v25
    v_mfma_f32_16x16x32_bf16 v[188:191], a[28:31], v[208:211], v[188:191]
    v_fmac_f32 v66, v20, v89
    v_mfma_f32_16x16x32_bf16 v[140:143], a[32:35], v[212:215], v[140:143]
    v_fmac_f32 v67, v20, v25
    v_lshlrev_b32 v90, 16, v26
    v_mfma_f32_16x16x32_bf16 v[156:159], a[36:39], v[212:215], v[156:159]
    v_and_b32 v26, s92, v26
    v_fmac_f32 v68, v21, v90
    v_fmac_f32 v69, v21, v26
    v_lshlrev_b32 v91, 16, v27
    v_and_b32 v27, s92, v27
    v_fmac_f32 v70, v21, v91
    v_fmac_f32 v71, v21, v27
    v_fma_f32 v128, v128, v20, v64
    v_fma_f32 v129, v129, v20, v65
    v_fma_f32 v130, v130, v20, v66
    v_fma_f32 v131, v131, v20, v67
    v_cvt_pk_bf16_f32 v56, v128, v129
    v_cvt_pk_bf16_f32 v57, v130, v131
    ds_write_b64 v6, v[56:57] offset:0
    v_fma_f32 v132, v132, v21, v68
    v_mfma_f32_16x16x32_bf16 v[172:175], a[40:43], v[212:215], v[172:175]
    s_waitcnt lgkmcnt(1)
    v_add_f32 v136, v136, v152
    v_mfma_f32_16x16x32_bf16 v[188:191], a[44:47], v[212:215], v[188:191]
    v_add_f32 v137, v137, v153
    v_mfma_f32_16x16x32_bf16 v[140:143], a[48:51], v[216:219], v[140:143]
    v_add_f32 v138, v138, v154
    v_add_f32 v139, v139, v155
    v_mfma_f32_16x16x32_bf16 v[156:159], a[52:55], v[216:219], v[156:159]
    v_add_f32 v168, v168, v184
    v_add_f32 v169, v169, v185
    v_mfma_f32_16x16x32_bf16 v[172:175], a[56:59], v[216:219], v[172:175]
    v_add_f32 v170, v170, v186
    v_add_f32 v171, v171, v187
    v_mfma_f32_16x16x32_bf16 v[188:191], a[60:63], v[216:219], v[188:191]
    s_waitcnt vmcnt(1)
    v_add_f32 v136, v136, v168
    v_mfma_f32_16x16x32_bf16 v[156:159], a[68:71], v[220:223], v[156:159]
    v_add_f32 v137, v137, v169
    v_add_f32 v138, v138, v170
    v_mfma_f32_16x16x32_bf16 v[172:175], a[72:75], v[220:223], v[172:175]
    v_add_f32 v139, v139, v171
    v_fma_f32 v133, v133, v21, v69
    v_fma_f32 v134, v134, v21, v70
    v_mfma_f32_16x16x32_bf16 v[188:191], a[76:79], v[220:223], v[188:191]
    v_fma_f32 v135, v135, v21, v71
    v_cvt_pk_bf16_f32 v58, v132, v133
    v_mfma_f32_16x16x32_bf16 v[140:143], a[64:67], v[220:223], v[140:143]
    v_cvt_pk_bf16_f32 v59, v134, v135
    ds_write_b64 v6, v[58:59] offset:2048
    ds_write_b128 v33, v[156:159] offset:24576
    s_waitcnt vmcnt(0)
    v_lshlrev_b32 v92, 16, v28
    v_and_b32 v28, s92, v28
    v_fmac_f32 v72, v22, v92
    v_fmac_f32 v73, v22, v28
    v_lshlrev_b32 v93, 16, v29
    v_and_b32 v29, s92, v29
    ds_write_b128 v34, v[172:175] offset:24576
    v_fmac_f32 v74, v22, v93
    v_fmac_f32 v75, v22, v29
    v_lshlrev_b32 v94, 16, v30
    v_and_b32 v30, s92, v30
    v_fmac_f32 v76, v23, v94
    ds_write_b128 v35, v[188:191] offset:24576
    v_fmac_f32 v77, v23, v30
    v_lshlrev_b32 v95, 16, v31
    v_and_b32 v31, s92, v31
    v_fmac_f32 v78, v23, v95
    v_fmac_f32 v79, v23, v31
    s_waitcnt lgkmcnt(0)
    s_barrier
    ds_read_b128 v[156:159], v32 offset:24576
    ds_read_b128 v[172:175], v32 offset:25600
    ds_read_b128 v[188:191], v32 offset:26624
    ds_read_b128 v[36:39], v7
    v_fma_f32 v136, v136, v22, v72
    v_fma_f32 v137, v137, v22, v73
    v_fma_f32 v138, v138, v22, v74
    v_fma_f32 v139, v139, v22, v75
    v_cvt_pk_bf16_f32 v60, v136, v137
    v_cvt_pk_bf16_f32 v61, v138, v139
    ds_write_b64 v6, v[60:61] offset:4096
    s_waitcnt lgkmcnt(4)
    v_pk_add_f32 v[140:141], v[140:141], v[156:157]
    v_pk_add_f32 v[142:143], v[142:143], v[158:159]
    s_waitcnt lgkmcnt(2)
    v_pk_add_f32 v[172:173], v[172:173], v[188:189]
    v_pk_add_f32 v[174:175], v[174:175], v[190:191]
    v_pk_add_f32 v[140:141], v[140:141], v[172:173]
    v_pk_add_f32 v[142:143], v[142:143], v[174:175]
    s_waitcnt lgkmcnt(1)
    buffer_store_dwordx4 v[36:39], v3, s[28:31], s76 offen sc1
    v_fma_f32 v140, v140, v23, v76
    v_fma_f32 v141, v141, v23, v77
    v_fma_f32 v142, v142, v23, v78
    v_fma_f32 v143, v143, v23, v79
    v_cvt_pk_bf16_f32 v62, v140, v141
    v_cvt_pk_bf16_f32 v63, v142, v143
    ds_write_b64 v6, v[62:63] offset:6144
    s_waitcnt lgkmcnt(0)
    s_barrier
    ds_read_b128 v[40:43], v7 offset:4096
    s_waitcnt lgkmcnt(0)
    buffer_store_dwordx4 v[40:43], v3, s[28:31], s77 offen sc1
    s_endpgm
L_end:
    s_endpgm
.section .rodata,"a"
.p2align 6
.amdhsa_kernel gated_mix__spectral_gfnet__glu_gated_reglu__prompt_kernel
  .amdhsa_next_free_vgpr 512
  .amdhsa_next_free_sgpr 102
  .amdhsa_accum_offset 256
  .amdhsa_group_segment_fixed_size 0
  .amdhsa_kernarg_size 88
  .amdhsa_user_sgpr_count 2
  .amdhsa_user_sgpr_kernarg_segment_ptr 1
  .amdhsa_system_sgpr_workgroup_id_x 1
  .amdhsa_float_denorm_mode_32 3
.end_amdhsa_kernel
```
